```python
import torch

def _softmax(x, axis=-1):
    return torch.softmax(x, dim=axis)

def _gelu(x):
    return torch.nn.functional.gelu(x, approximate='tanh')

def _silu(x):
    return torch.nn.functional.silu(x)

def _sigmoid(x):
    return torch.sigmoid(x)

def _layernorm(x, axis=-1, eps=1e-05):
    m = x.mean(dim=axis, keepdim=True)
    v = x.var(dim=axis, keepdim=True, unbiased=False)
    return (x - m) / torch.sqrt(v + eps)

def _scatter_add(tgt, idx, src, axis=0):
    return tgt.clone().index_add_(axis, idx, src)

def _segment_sum(src, seg, n):
    out = torch.zeros((n,) + src.shape[1:], dtype=src.dtype)
    return out.index_add_(0, seg, src)

def _pad(x, pw):
    flat = tuple((v for pair in reversed(pw) for v in pair))
    return torch.nn.functional.pad(x, flat)
kernel_name = 'adaLN_cond__sliding_block_cached__geglu_ffn__prompt'

def setup_inputs():

    _w = lambda a: (lambda t: t.to(torch.bfloat16) if t.is_floating_point() else t)(torch.as_tensor(a))

    def _A_setup():
        B, Sq, D = (1, 2048, 512)
        Hq, Hkv, Sk, Dh = (32, 8, 2048, 128)
        assert Hq % Hkv == 0, (Hq, Hkv)
        return {'x': _w((lambda *s: torch.randn(*s, dtype=torch.bfloat16) * 0.1)(B, Sq, D)), 'k_cache': _w((lambda *s: torch.randn(*s, dtype=torch.bfloat16) * 0.8)(B, Hkv, Sk, Dh)), 'v_cache': _w((lambda *s: torch.randn(*s, dtype=torch.bfloat16) * 1.6)(B, Hkv, Sk, Dh)), 'wq': _w((lambda *s: torch.randn(*s, dtype=torch.bfloat16) * 0.8)(D, Hq * Dh) * D ** (-0.5)), 'wo': _w((lambda *s: torch.randn(*s, dtype=torch.bfloat16) * 1.6)(Hq * Dh, D) * (Hq * Dh) ** (-0.5))}
    _A_in = _A_setup()

    def _B_setup():
        B, S, D, F = (1, 2048, 512, 1792)
        return {'x': _w((lambda *s: torch.randn(*s, dtype=torch.bfloat16) * 0.1)(B, S, D)), 'w_gate': _w((lambda *s: torch.randn(*s, dtype=torch.bfloat16) * 0.2)(D, F)), 'w_up': _w((lambda *s: torch.randn(*s, dtype=torch.bfloat16) * 0.2)(D, F)), 'w_down': _w((lambda *s: torch.randn(*s, dtype=torch.bfloat16) * 0.2)(F, D))}
    _B_in = _B_setup()
    return {'A_x': _A_in['x'], 'A_k_cache': _A_in['k_cache'], 'A_v_cache': _A_in['v_cache'], 'A_wq': _A_in['wq'], 'A_wo': _A_in['wo'], 'B_x': _B_in['x'], 'B_w_gate': _B_in['w_gate'], 'B_w_up': _B_in['w_up'], 'B_w_down': _B_in['w_down'], 'c': _w((lambda *s: torch.randn(*s, dtype=torch.bfloat16) * 0.8)(1, 512) * 8.0), 'w_mod': _w((lambda *s: torch.randn(*s, dtype=torch.bfloat16) * 0.8)(512, 6 * 512) * 512 ** (-0.5) * 8.0)}

def reference(A_x, A_k_cache, A_v_cache, A_wq, A_wo, B_x, B_w_gate, B_w_up, B_w_down, c, w_mod):

    def _A_ref(x, k_cache, v_cache, wq, wo):
        B, Sq, D = x.shape
        Hq, Dh = (32, 128)
        Hkv, Sk = (k_cache.shape[1], k_cache.shape[2])
        W = min(4096, max(256, Sk // 4))
        rep = Hq // Hkv
        q = (lambda x, *d: x.permute(*d))((x @ wq).reshape(B, Sq, Hq, Dh), 0, 2, 1, 3)
        k = (lambda x, n, axis: torch.repeat_interleave(x, n, dim=axis))(k_cache[:, :, Sk - W:, :], rep, axis=1)
        v = (lambda x, n, axis: torch.repeat_interleave(x, n, dim=axis))(v_cache[:, :, Sk - W:, :], rep, axis=1)
        scores = torch.einsum('bhqd,bhkd->bhqk', q, k) * Dh ** (-0.5)
        p = _softmax(scores, axis=-1)
        o = torch.einsum('bhqk,bhkd->bhqd', p, v)
        return (lambda x, *d: x.permute(*d))(o, 0, 2, 1, 3).reshape(B, Sq, Hq * Dh) @ wo

    def _B_ref(x, w_gate, w_up, w_down):
        return _gelu(x @ w_gate) * (x @ w_up) @ w_down
    x = A_x
    mod = (_silu(c) @ w_mod).reshape(c.shape[0], 6, 1, -1)
    sa, ca, ga, sb, cb, gb = (mod[:, 0].clone(), mod[:, 1].clone(), mod[:, 2].clone(), mod[:, 3].clone(), mod[:, 4].clone(), mod[:, 5].clone())
    h = _layernorm(x, axis=-1) * (1 + ca) + sa
    x = x + ga * _A_ref(h, A_k_cache, A_v_cache, A_wq, A_wo)
    h = _layernorm(x, axis=-1) * (1 + cb) + sb
    x = x + gb * _B_ref(h, B_w_gate, B_w_up, B_w_down)
    return x
```

```asm
; @launch kernel=adaLN_cond__sliding_block_cached__geglu_ffn__prompt_kernel grid=(256,1,1) block=(256,1,1) lds=163840
.amdgcn_target "amdgcn-amd-amdhsa--gfx950"
.text
.globl adaLN_cond__sliding_block_cached__geglu_ffn__prompt_kernel
.p2align 12
.p2align 8
.type adaLN_cond__sliding_block_cached__geglu_ffn__prompt_kernel,@function
adaLN_cond__sliding_block_cached__geglu_ffn__prompt_kernel:
    s_cmp_ge_u32 s2, 256
    s_cbranch_scc1 END_attn
    s_mov_b32 s39, 0
    s_getpc_b64 s[56:57]
PCREF:
    s_lshr_b32 s33, s2, 3
    s_lshl_b32 s33, s33, 12
    v_lshlrev_b32 v108, 4, v0
    v_add_u32_e64 v108, s33, v108
    v_min_u32 v108, CODE_END-PCREF-16, v108
    global_load_dwordx4 a[252:255], v108, s[56:57]
    v_lshrrev_b32 v220, 6, v0
    s_nop 0
    v_readfirstlane_b32 s28, v220
    v_and_b32 v220, 63, v0
RESTART:
    s_load_dwordx4 s[8:11], s[0:1], 72
    s_load_dwordx2 s[4:5], s[0:1], 0
    s_load_dwordx4 s[68:71], s[0:1], 96
    s_load_dwordx8 s[40:47], s[0:1], 8
    v_lshl_add_u32 v99, s28, 6, v220
    v_and_b32 v100, 1, v99
    v_lshrrev_b32 v101, 1, v99
    v_mul_u32_u24 v102, 6144, v101
    v_lshl_add_u32 v102, v100, 4, v102
    v_lshlrev_b32 v103, 1, v101
    v_lshrrev_b32 v104, 4, v99
    v_lshlrev_b32_e64 v104, 6, v104
    v_lshl_add_u32 v104, v100, 5, v104
    s_lshr_b32 s33, s2, 3
    s_and_b32 s32, s2, 7
    s_lshl_b32 s7, s32, 3
    s_add_u32 s7, s7, s33
    s_lshl_b32 s51, s32, 4
    s_add_u32 s51, s51, s33
    s_add_u32 s51, s51, 56
    s_cmp_lt_u32 s2, 64
    s_cselect_b32 s7, s7, s51
    s_cmp_lt_u32 s2, 192
    s_cselect_b32 s7, s7, 255
    s_cmp_lt_u32 s7, 64
    s_cselect_b32 s53, s39, 1
    s_lshl_b32 s31, s7, 5
    v_lshlrev_b32_e64 v216, 4, v220
    s_and_b32 s29, s2, 3
    s_lshl_b32 s29, s29, 1
    s_lshr_b32 s32, s2, 7
    s_add_u32 s29, s29, s32
    s_bfe_u32 s50, s2, 0x40003
    s_and_b32 s30, s2, 7
    s_lshr_b32 s30, s30, 2
    s_lshl_b32 s30, s30, 4
    s_add_u32 s30, s30, s50
    s_lshl_b32 s50, s50, 1
    s_and_b32 s6, s50, 7
    s_lshr_b32 s59, s50, 3
    v_bfe_u32 v227, v220, 2, 3
    v_lshrrev_b32 v228, 5, v220
    v_lshlrev_b32_e64 v228, 2, v228
    v_and_or_b32 v228, v220, 3, v228
    v_lshlrev_b32_e64 v233, 10, v227
    v_lshl_add_u32 v233, v228, 4, v233
    v_add_u32 v234, 8192, v233
    s_lshl_b32 s48, s30, 16
    s_lshl_b32 s51, s28, 8
    s_add_u32 s48, s48, s51
    s_add_u32 s49, s48, 16384
    s_add_u32 s56, s48, 32768
    s_add_u32 s57, s48, 49152
    s_waitcnt lgkmcnt(0)
    s_mov_b32 s12, s10
    s_and_b32 s13, s11, 0xffff
    s_mov_b32 s14, 0x300000
    s_mov_b32 s15, 0x20000
    s_mov_b32 s20, s8
    s_and_b32 s21, s9, 0xffff
    s_mov_b32 s22, 0x400
    s_mov_b32 s23, 0x20000
    s_mov_b32 s16, s4
    s_nop 0
    s_and_b32 s17, s5, 0xffff
    s_mov_b32 s18, 0x200000
    s_mov_b32 s19, 0x20000
    buffer_load_ushort v80, v103, s[20:23], 0 offen offset:0
    buffer_load_ushort v81, v103, s[20:23], 0 offen offset:256
    buffer_load_ushort v82, v103, s[20:23], 0 offen offset:512
    buffer_load_ushort v83, v103, s[20:23], 0 offen offset:768
    s_mov_b32 s24, s70
    s_and_b32 s25, s71, 0xffff
    s_mov_b32 s26, 0x10000000
    s_mov_b32 s27, 0x20000
    s_lshl_b32 s63, s28, 10
    s_add_u32 s63, s63, 0x18000
    v_lshrrev_b32 v241, 5, v220
    v_lshlrev_b32 v240, 7, v227
    v_lshl_add_u32 v240, v241, 12, v240
    v_and_b32_e64 v241, 3, v220
    v_lshl_add_u32 v240, v241, 4, v240
    buffer_load_dwordx4 v[236:239], v240, s[24:27], s63 offen sc1
    v_lshlrev_b32 v109, 2, v220
    s_lshl_b32 s62, s7, 7
    s_add_u32 s62, s62, 0x18000
    buffer_load_dword v110, v109, s[24:27], s62 offen sc1
    s_xor_b32 s61, s28, 3
    s_or_b32 s61, s61, s39
    s_cmp_lg_u32 s61, 0
    s_cbranch_scc1 NOZERO
    v_lshlrev_b32 v111, 15, v220
    v_mov_b32_e64 v107, 0
    s_lshl_b32 s32, s2, 7
    s_add_u32 s32, s32, 0x20000
    s_mov_b64 exec, 15
    buffer_store_dword v107, v111, s[24:27], s32 offen sc1
    s_mov_b64 exec, -1
NOZERO:
    s_cmp_eq_u32 s53, 0
    s_cbranch_scc1 PLOAD
    buffer_load_dwordx4 v[128:131], v233, s[16:19], s48 offen offset:0
    buffer_load_dwordx4 v[132:135], v233, s[16:19], s48 offen offset:128
    buffer_load_dwordx4 v[136:139], v234, s[16:19], s48 offen offset:0
    buffer_load_dwordx4 v[140:143], v234, s[16:19], s48 offen offset:128
    buffer_load_dwordx4 v[144:147], v233, s[16:19], s49 offen offset:0
    buffer_load_dwordx4 v[148:151], v233, s[16:19], s49 offen offset:128
    buffer_load_dwordx4 v[152:155], v234, s[16:19], s49 offen offset:0
    buffer_load_dwordx4 v[156:159], v234, s[16:19], s49 offen offset:128
    buffer_load_dwordx4 v[160:163], v233, s[16:19], s56 offen offset:0
    buffer_load_dwordx4 v[164:167], v233, s[16:19], s56 offen offset:128
    buffer_load_dwordx4 v[168:171], v234, s[16:19], s56 offen offset:0
    buffer_load_dwordx4 v[172:175], v234, s[16:19], s56 offen offset:128
    buffer_load_dwordx4 v[176:179], v233, s[16:19], s57 offen offset:0
    buffer_load_dwordx4 v[180:183], v233, s[16:19], s57 offen offset:128
    buffer_load_dwordx4 v[184:187], v234, s[16:19], s57 offen offset:0
    buffer_load_dwordx4 v[188:191], v234, s[16:19], s57 offen offset:128
    s_branch PJOIN
PLOAD:
    s_mov_b32 s32, s31
    buffer_load_dwordx4 v[64:67], v102, s[12:15], s32 offen
    s_add_u32 s32, s32, 786432
    buffer_load_dwordx4 v[68:71], v102, s[12:15], s32 offen
    s_add_u32 s32, s32, 786432
    buffer_load_dwordx4 v[72:75], v102, s[12:15], s32 offen
    s_add_u32 s32, s32, 786432
    buffer_load_dwordx4 v[76:79], v102, s[12:15], s32 offen
PJOIN:
    s_lshl_b32 s54, s28, 8
    s_lshl_b32 s52, s28, 11
    v_lshrrev_b32 v221, 4, v220
    v_and_b32 v223, 15, v220
    v_lshlrev_b32 v222, 2, v221
    v_xor_b32 v222, v222, v223
    v_lshlrev_b32_e64 v222, 4, v222
    s_lshl_b32 s32, s29, 10
    s_add_u32 s32, s32, s54
    v_lshl_add_u32 v208, v221, 13, v222
    v_add_u32_e64 v208, s32, v208
    v_add_u32 v209, 31744, v208
    v_add_u32 v210, 63488, v208
    v_add_u32 v211, 95232, v208
    s_lshl_b32 s34, s28, 14
    s_add_u32 s34, s34, 98304
    s_add_u32 s72, s6, 0
    s_and_b32 s72, s72, 7
    s_lshl_b32 s72, s72, 17
    s_add_u32 s73, s6, 1
    s_and_b32 s73, s73, 7
    s_lshl_b32 s73, s73, 17
    s_add_u32 s74, s6, 2
    s_and_b32 s74, s74, 7
    s_lshl_b32 s74, s74, 17
    s_add_u32 s75, s6, 3
    s_and_b32 s75, s75, 7
    s_lshl_b32 s75, s75, 17
    s_add_u32 s76, s6, 4
    s_and_b32 s76, s76, 7
    s_lshl_b32 s76, s76, 17
    s_add_u32 s77, s6, 5
    s_and_b32 s77, s77, 7
    s_lshl_b32 s77, s77, 17
    s_add_u32 s78, s6, 6
    s_and_b32 s78, s78, 7
    s_lshl_b32 s78, s78, 17
    s_add_u32 s79, s6, 7
    s_and_b32 s79, s79, 7
    s_lshl_b32 s79, s79, 17
    s_lshl_b32 s55, s59, 20
    s_mov_b32 s8, s44
    s_and_b32 s9, s45, 0xffff
    s_mov_b32 s10, 0x400000
    s_mov_b32 s11, 0x20000
    v_lshrrev_b32 v223, 1, v228
    v_subrev_u32 v223, s6, v223
    v_and_b32 v224, 1, v228
    v_and_b32_e64 v225, 1, v223
    v_lshl_add_u32 v225, v225, 1, v224
    v_lshlrev_b32 v225, 1, v225
    v_xor_b32 v225, v225, v227
    v_lshlrev_b32_e64 v224, 9, v224
    v_lshl_add_u32 v224, v225, 4, v224
    s_sub_u32 s33, s28, s59
    s_and_b32 s33, s33, 3
    s_lshl_b32 s33, s33, 13
    s_add_u32 s33, s33, 32768
    v_add_u32 v224, s33, v224
    v_add_u32 v225, 0, v223
    v_and_b32 v225, 7, v225
    v_lshl_add_u32 v231, v225, 10, v224
    v_add_u32 v225, 4, v223
    v_and_b32 v225, 7, v225
    v_lshl_add_u32 v232, v225, 10, v224
    s_lshl_b32 s51, s28, 10
    v_lshlrev_b32 v235, 5, v228
    v_add_u32 v235, s51, v235
    v_lshrrev_b32 v252, 2, v220
    v_lshlrev_b32 v252, 6, v252
    v_add_u32 v252, s51, v252
    v_lshlrev_b32_e64 v253, 6, v227
    v_lshl_add_u32 v255, s28, 9, v253
    v_lshl_add_u32 v253, v228, 3, v253
    v_lshl_add_u32 v254, v228, 3, v255
    v_bfe_u32 v223, v220, 2, 2
    v_and_b32 v224, 1, v220
    v_lshlrev_b32 v224, 1, v224
    v_bfe_u32 v227, v220, 1, 1
    v_or_b32_e64 v224, v224, v227
    v_bfe_u32 v225, v220, 4, 1
    v_lshrrev_b32_e64 v226, 5, v220
    v_lshl_add_u32 v230, v225, 2, v224
    v_lshlrev_b32_e64 v230, 3, v230
    v_lshl_add_u32 v227, v226, 3, v223
    v_lshl_add_u32 v227, v227, 8, v230
    v_add_u32 v227, s34, v227
    v_xor_b32 v228, 0, v223
    v_lshl_add_u32 v204, v228, 6, v227
    v_xor_b32_e64 v228, 1, v223
    v_lshl_add_u32 v205, v228, 6, v227
    v_xor_b32_e64 v228, 2, v223
    v_lshl_add_u32 v206, v228, 6, v227
    v_xor_b32_e64 v228, 3, v223
    v_lshl_add_u32 v207, v228, 6, v227
    v_lshl_add_u32 v227, v226, 2, v223
    v_lshl_add_u32 v227, v227, 8, v230
    v_add_u32 v227, 32768, v227
    v_xor_b32_e64 v228, 0, v223
    v_lshl_add_u32 v200, v228, 6, v227
    v_xor_b32_e64 v228, 1, v223
    v_lshl_add_u32 v201, v228, 6, v227
    v_xor_b32_e64 v228, 2, v223
    v_lshl_add_u32 v202, v228, 6, v227
    v_xor_b32_e64 v228, 3, v223
    v_lshl_add_u32 v203, v228, 6, v227
    v_and_b32 v227, 31, v220
    v_and_b32 v228, 15, v220
    v_xor_b32 v228, v228, v226
    v_lshlrev_b32 v227, 8, v227
    v_lshl_add_u32 v192, v228, 4, v227
    v_xor_b32 v193, 32, v192
    v_xor_b32 v194, 64, v192
    v_xor_b32 v195, 96, v192
    v_xor_b32 v196, 128, v192
    v_xor_b32 v197, 160, v192
    v_xor_b32 v198, 192, v192
    v_xor_b32 v199, 224, v192
    v_mov_b32 v217, 0
    v_mov_b32 v218, 0
    v_lshl_add_u32 v214, v221, 8, v222
    s_and_b32 s33, s28, 1
    s_lshl_b32 s33, s33, 3
    v_or_b32 v227, s33, v221
    v_and_b32 v228, 15, v220
    v_xor_b32 v227, v227, v228
    v_lshlrev_b32 v212, 8, v221
    v_lshl_add_u32 v212, v227, 4, v212
    v_xor_b32_e64 v213, 64, v212
    s_lshl_b32 s33, s29, 19
    s_add_u32 s33, s33, s52
    s_add_u32 s33, s33, 393216
    v_add_u32 v212, s33, v212
    v_add_u32 v213, s33, v213
    v_add_u32 v214, s33, v214
    v_lshlrev_b32 v227, 5, v226
    v_xor_b32_e64 v215, v227, v216
    v_add_u32 v215, 32768, v215
    v_xor_b32_e64 v219, 64, v215
    s_mov_b32 s58, 0xffff0000
    s_mov_b32 s20, s68
    s_and_b32 s21, s69, 0xffff
    s_mov_b32 s22, 0x100
    s_mov_b32 s23, 0x20000
    s_sub_u32 s32, s7, 0
    s_cmp_ge_u32 s32, 64
    s_cselect_b32 s32, 1, s39
    s_cmp_lg_u32 s32, 0
    s_cbranch_scc1 NOGEMVA
    s_mov_b32 s33, 0xbfb8aa3b
    s_waitcnt vmcnt(9)
    v_lshlrev_b32 v80, 16, v80
    s_waitcnt vmcnt(8)
    v_lshlrev_b32 v81, 16, v81
    s_waitcnt vmcnt(7)
    v_lshlrev_b32 v82, 16, v82
    s_waitcnt vmcnt(6)
    v_lshlrev_b32 v83, 16, v83
    v_mul_f32 v88, s33, v80
    v_mul_f32 v89, s33, v81
    v_mul_f32 v90, s33, v82
    v_mul_f32 v91, s33, v83
    v_exp_f32 v88, v88
    v_exp_f32 v89, v89
    v_exp_f32 v90, v90
    v_exp_f32 v91, v91
    v_add_f32 v88, 1.0, v88
    v_add_f32 v89, 1.0, v89
    v_add_f32 v90, 1.0, v90
    v_add_f32 v91, 1.0, v91
    v_rcp_f32 v88, v88
    v_rcp_f32 v89, v89
    v_rcp_f32 v90, v90
    v_rcp_f32 v91, v91
    v_mul_f32 v80, v80, v88
    v_mul_f32 v81, v81, v89
    v_mul_f32 v82, v82, v90
    v_mul_f32 v83, v83, v91
    v_cvt_pk_bf16_f32 v112, 0, v80
    v_cvt_pk_bf16_f32 v114, 0, v81
    v_cvt_pk_bf16_f32 v116, 0, v82
    v_cvt_pk_bf16_f32 v118, 0, v83
    s_waitcnt vmcnt(3)
    v_lshlrev_b32 v120, 16, v64
    v_and_b32_e64 v121, s58, v64
    v_pk_mul_f32 v[88:89], v[120:121], v[112:113] op_sel_hi:[1,0]
    v_lshlrev_b32 v122, 16, v65
    v_and_b32 v123, s58, v65
    v_pk_mul_f32 v[90:91], v[122:123], v[112:113] op_sel_hi:[1,0]
    v_lshlrev_b32 v120, 16, v66
    v_and_b32 v121, s58, v66
    v_pk_mul_f32 v[92:93], v[120:121], v[112:113] op_sel_hi:[1,0]
    v_lshlrev_b32 v122, 16, v67
    v_and_b32 v123, s58, v67
    v_pk_mul_f32 v[94:95], v[122:123], v[112:113] op_sel_hi:[1,0]
    s_waitcnt vmcnt(2)
    v_lshlrev_b32 v120, 16, v68
    v_and_b32_e64 v121, s58, v68
    v_pk_fma_f32 v[88:89], v[120:121], v[114:115], v[88:89] op_sel_hi:[1,0,1]
    v_lshlrev_b32 v122, 16, v69
    v_and_b32 v123, s58, v69
    v_pk_fma_f32 v[90:91], v[122:123], v[114:115], v[90:91] op_sel_hi:[1,0,1]
    v_lshlrev_b32 v120, 16, v70
    v_and_b32 v121, s58, v70
    v_pk_fma_f32 v[92:93], v[120:121], v[114:115], v[92:93] op_sel_hi:[1,0,1]
    v_lshlrev_b32 v122, 16, v71
    v_and_b32 v123, s58, v71
    v_pk_fma_f32 v[94:95], v[122:123], v[114:115], v[94:95] op_sel_hi:[1,0,1]
    s_waitcnt vmcnt(1)
    v_lshlrev_b32 v120, 16, v72
    v_and_b32_e64 v121, s58, v72
    v_pk_fma_f32 v[88:89], v[120:121], v[116:117], v[88:89] op_sel_hi:[1,0,1]
    v_lshlrev_b32 v122, 16, v73
    v_and_b32 v123, s58, v73
    v_pk_fma_f32 v[90:91], v[122:123], v[116:117], v[90:91] op_sel_hi:[1,0,1]
    v_lshlrev_b32 v120, 16, v74
    v_and_b32 v121, s58, v74
    v_pk_fma_f32 v[92:93], v[120:121], v[116:117], v[92:93] op_sel_hi:[1,0,1]
    v_lshlrev_b32 v122, 16, v75
    v_and_b32 v123, s58, v75
    v_pk_fma_f32 v[94:95], v[122:123], v[116:117], v[94:95] op_sel_hi:[1,0,1]
    s_waitcnt vmcnt(0)
    v_lshlrev_b32 v120, 16, v76
    v_and_b32_e64 v121, s58, v76
    v_pk_fma_f32 v[88:89], v[120:121], v[118:119], v[88:89] op_sel_hi:[1,0,1]
    v_lshlrev_b32 v122, 16, v77
    v_and_b32 v123, s58, v77
    v_pk_fma_f32 v[90:91], v[122:123], v[118:119], v[90:91] op_sel_hi:[1,0,1]
    v_lshlrev_b32 v120, 16, v78
    v_and_b32 v121, s58, v78
    v_pk_fma_f32 v[92:93], v[120:121], v[118:119], v[92:93] op_sel_hi:[1,0,1]
    v_lshlrev_b32 v122, 16, v79
    v_and_b32 v123, s58, v79
    v_pk_fma_f32 v[94:95], v[122:123], v[118:119], v[94:95] op_sel_hi:[1,0,1]
    v_add_f32_dpp v88, v88, v88 quad_perm:[2,3,0,1] row_mask:0xf bank_mask:0xf
    v_add_f32_dpp v89, v89, v89 quad_perm:[2,3,0,1] row_mask:0xf bank_mask:0xf
    v_add_f32_dpp v90, v90, v90 quad_perm:[2,3,0,1] row_mask:0xf bank_mask:0xf
    v_add_f32_dpp v91, v91, v91 quad_perm:[2,3,0,1] row_mask:0xf bank_mask:0xf
    v_add_f32_dpp v92, v92, v92 quad_perm:[2,3,0,1] row_mask:0xf bank_mask:0xf
    v_add_f32_dpp v93, v93, v93 quad_perm:[2,3,0,1] row_mask:0xf bank_mask:0xf
    v_add_f32_dpp v94, v94, v94 quad_perm:[2,3,0,1] row_mask:0xf bank_mask:0xf
    v_add_f32_dpp v95, v95, v95 quad_perm:[2,3,0,1] row_mask:0xf bank_mask:0xf
    v_add_f32_dpp v88, v88, v88 row_ror:4 row_mask:0xf bank_mask:0xf
    v_add_f32_dpp v89, v89, v89 row_ror:4 row_mask:0xf bank_mask:0xf
    v_add_f32_dpp v90, v90, v90 row_ror:4 row_mask:0xf bank_mask:0xf
    v_add_f32_dpp v91, v91, v91 row_ror:4 row_mask:0xf bank_mask:0xf
    v_add_f32_dpp v92, v92, v92 row_ror:4 row_mask:0xf bank_mask:0xf
    v_add_f32_dpp v93, v93, v93 row_ror:4 row_mask:0xf bank_mask:0xf
    v_add_f32_dpp v94, v94, v94 row_ror:4 row_mask:0xf bank_mask:0xf
    v_add_f32_dpp v95, v95, v95 row_ror:4 row_mask:0xf bank_mask:0xf
    v_add_f32_dpp v88, v88, v88 row_ror:8 row_mask:0xf bank_mask:0xf
    v_add_f32_dpp v89, v89, v89 row_ror:8 row_mask:0xf bank_mask:0xf
    v_add_f32_dpp v90, v90, v90 row_ror:8 row_mask:0xf bank_mask:0xf
    v_add_f32_dpp v91, v91, v91 row_ror:8 row_mask:0xf bank_mask:0xf
    v_add_f32_dpp v92, v92, v92 row_ror:8 row_mask:0xf bank_mask:0xf
    v_add_f32_dpp v93, v93, v93 row_ror:8 row_mask:0xf bank_mask:0xf
    v_add_f32_dpp v94, v94, v94 row_ror:8 row_mask:0xf bank_mask:0xf
    v_add_f32_dpp v95, v95, v95 row_ror:8 row_mask:0xf bank_mask:0xf
    ds_write_b128 v104, v[88:91] offset:20480
    ds_write_b128 v104, v[92:95] offset:20496
    v_lshlrev_b32_e64 v105, 2, v220
    s_lshr_b32 s32, s7, 5
    s_cmp_eq_u32 s32, 1
    s_cselect_b32 s33, 1.0, 0
    s_cmp_eq_u32 s32, 4
    s_cselect_b32 s33, 1.0, s33
    s_cmp_lt_u32 s32, 2
    s_cselect_b32 s51, 0x3e0293ee, 1.0
    s_lshl_b32 s32, s7, 6
    s_waitcnt lgkmcnt(0)
    s_barrier
    s_cmp_lg_u32 s28, 3
    s_cbranch_scc1 PWAIT
    ds_read_b32 v88, v105 offset:20480
    ds_read_b32 v89, v105 offset:20736
    ds_read_b32 v90, v105 offset:20992
    ds_read_b32 v91, v105 offset:21248
    s_waitcnt lgkmcnt(2)
    v_add_f32 v88, v88, v89
    s_waitcnt lgkmcnt(0)
    v_add_f32 v90, v90, v91
    v_add_f32 v88, v88, v90
    v_mov_b32 v89, v88
    s_nop 1
    v_permlane16_swap_b32 v88, v89
    v_add_f32 v88, v88, v89
    v_mov_b32 v89, v88
    s_nop 1
    v_permlane32_swap_b32 v88, v89
    v_add_f32 v88, v88, v89
    v_cvt_pk_bf16_f32 v88, 0, v88
    v_add_f32 v88, s33, v88
    v_mul_f32 v88, s51, v88
    s_mov_b64 exec, 0xffff
    v_not_b32_e64 v110, v110
    v_bfi_b32 v88, 1, v110, v88
    buffer_store_dword v88, v109, s[24:27], s62 offen sc1
    s_mov_b64 exec, -1
PWAIT:
    s_barrier
    buffer_load_dwordx4 v[128:131], v233, s[16:19], s48 offen offset:0
    buffer_load_dwordx4 v[132:135], v233, s[16:19], s48 offen offset:128
    buffer_load_dwordx4 v[136:139], v234, s[16:19], s48 offen offset:0
    buffer_load_dwordx4 v[140:143], v234, s[16:19], s48 offen offset:128
    buffer_load_dwordx4 v[144:147], v233, s[16:19], s49 offen offset:0
    buffer_load_dwordx4 v[148:151], v233, s[16:19], s49 offen offset:128
    buffer_load_dwordx4 v[152:155], v234, s[16:19], s49 offen offset:0
    buffer_load_dwordx4 v[156:159], v234, s[16:19], s49 offen offset:128
    buffer_load_dwordx4 v[160:163], v233, s[16:19], s56 offen offset:0
    buffer_load_dwordx4 v[164:167], v233, s[16:19], s56 offen offset:128
    buffer_load_dwordx4 v[168:171], v234, s[16:19], s56 offen offset:0
    buffer_load_dwordx4 v[172:175], v234, s[16:19], s56 offen offset:128
    buffer_load_dwordx4 v[176:179], v233, s[16:19], s57 offen offset:0
    buffer_load_dwordx4 v[180:183], v233, s[16:19], s57 offen offset:128
    buffer_load_dwordx4 v[184:187], v234, s[16:19], s57 offen offset:0
    buffer_load_dwordx4 v[188:191], v234, s[16:19], s57 offen offset:128
NOGEMVA:
    s_mov_b64 exec, 0
    s_cmp_eq_u32 s28, 0
    s_cbranch_scc1 STUB0
    s_cmp_eq_u32 s28, 1
    s_cbranch_scc1 STUB1
    s_cmp_eq_u32 s28, 2
    s_cbranch_scc1 STUB2
    s_branch STUB3
WARM_RET:
    s_mov_b64 exec, -1
    s_mov_b32 s3, 0x3f803f80
    s_load_dwordx4 s[64:67], s[0:1], 48
    s_load_dwordx2 s[4:5], s[0:1], 64
    s_waitcnt vmcnt(9)
    v_accvgpr_write_b32 a240, v80
    s_waitcnt vmcnt(8)
    v_accvgpr_write_b32 a241, v81
    s_waitcnt vmcnt(7)
    v_accvgpr_write_b32 a242, v82
    s_waitcnt vmcnt(6)
    s_nop 0
    v_accvgpr_write_b32 a243, v83
    v_accvgpr_write_b32 a244, v104
    v_dot2_f32_bf16 v0, v128, s3, 0
    v_dot2_f32_bf16 v1, v128, v128, 0
    v_dot2_f32_bf16 v0, v129, s3, v0
    v_dot2_f32_bf16 v1, v129, v129, v1
    v_dot2_f32_bf16 v0, v130, s3, v0
    v_dot2_f32_bf16 v1, v130, v130, v1
    v_dot2_f32_bf16 v0, v131, s3, v0
    v_dot2_f32_bf16 v1, v131, v131, v1
    v_dot2_f32_bf16 v0, v132, s3, v0
    v_dot2_f32_bf16 v1, v132, v132, v1
    v_dot2_f32_bf16 v0, v133, s3, v0
    v_dot2_f32_bf16 v1, v133, v133, v1
    v_dot2_f32_bf16 v0, v134, s3, v0
    v_dot2_f32_bf16 v1, v134, v134, v1
    v_dot2_f32_bf16 v0, v135, s3, v0
    v_dot2_f32_bf16 v1, v135, v135, v1
    v_dot2_f32_bf16 v2, v136, s3, 0
    v_dot2_f32_bf16 v3, v136, v136, 0
    v_dot2_f32_bf16 v2, v137, s3, v2
    v_dot2_f32_bf16 v3, v137, v137, v3
    v_dot2_f32_bf16 v2, v138, s3, v2
    v_dot2_f32_bf16 v3, v138, v138, v3
    v_dot2_f32_bf16 v2, v139, s3, v2
    v_dot2_f32_bf16 v3, v139, v139, v3
    v_dot2_f32_bf16 v2, v140, s3, v2
    v_dot2_f32_bf16 v3, v140, v140, v3
    v_dot2_f32_bf16 v2, v141, s3, v2
    v_dot2_f32_bf16 v3, v141, v141, v3
    v_dot2_f32_bf16 v2, v142, s3, v2
    v_dot2_f32_bf16 v3, v142, v142, v3
    v_dot2_f32_bf16 v2, v143, s3, v2
    v_dot2_f32_bf16 v3, v143, v143, v3
    v_dot2_f32_bf16 v4, v144, s3, 0
    v_dot2_f32_bf16 v5, v144, v144, 0
    v_dot2_f32_bf16 v4, v145, s3, v4
    v_dot2_f32_bf16 v5, v145, v145, v5
    v_dot2_f32_bf16 v4, v146, s3, v4
    v_dot2_f32_bf16 v5, v146, v146, v5
    v_dot2_f32_bf16 v4, v147, s3, v4
    v_dot2_f32_bf16 v5, v147, v147, v5
    v_dot2_f32_bf16 v4, v148, s3, v4
    v_dot2_f32_bf16 v5, v148, v148, v5
    v_dot2_f32_bf16 v4, v149, s3, v4
    v_dot2_f32_bf16 v5, v149, v149, v5
    v_dot2_f32_bf16 v4, v150, s3, v4
    v_dot2_f32_bf16 v5, v150, v150, v5
    v_dot2_f32_bf16 v4, v151, s3, v4
    v_dot2_f32_bf16 v5, v151, v151, v5
    v_dot2_f32_bf16 v6, v152, s3, 0
    v_dot2_f32_bf16 v7, v152, v152, 0
    v_dot2_f32_bf16 v6, v153, s3, v6
    v_dot2_f32_bf16 v7, v153, v153, v7
    v_dot2_f32_bf16 v6, v154, s3, v6
    v_dot2_f32_bf16 v7, v154, v154, v7
    v_dot2_f32_bf16 v6, v155, s3, v6
    v_dot2_f32_bf16 v7, v155, v155, v7
    v_dot2_f32_bf16 v6, v156, s3, v6
    v_dot2_f32_bf16 v7, v156, v156, v7
    v_dot2_f32_bf16 v6, v157, s3, v6
    v_dot2_f32_bf16 v7, v157, v157, v7
    v_dot2_f32_bf16 v6, v158, s3, v6
    v_dot2_f32_bf16 v7, v158, v158, v7
    v_dot2_f32_bf16 v6, v159, s3, v6
    v_dot2_f32_bf16 v7, v159, v159, v7
    s_waitcnt vmcnt(0)
    s_add_u32 s32, s55, s72
    s_add_u32 m0, s34, 0
    s_nop 0
    buffer_load_dwordx4 v208, s[8:11], s32 offen lds
    buffer_load_dwordx4 v209, s[8:11], s32 offen offset:1024 lds
    buffer_load_dwordx4 v210, s[8:11], s32 offen offset:2048 lds
    buffer_load_dwordx4 v211, s[8:11], s32 offen offset:3072 lds
    s_add_u32 s32, s55, s73
    s_add_u32 m0, s34, 4096
    s_nop 0
    buffer_load_dwordx4 v208, s[8:11], s32 offen lds
    buffer_load_dwordx4 v209, s[8:11], s32 offen offset:1024 lds
    buffer_load_dwordx4 v210, s[8:11], s32 offen offset:2048 lds
    buffer_load_dwordx4 v211, s[8:11], s32 offen offset:3072 lds
    s_sub_u32 s32, s7, 64
    s_cmp_ge_u32 s32, 128
    s_cbranch_scc1 NOLATE
    s_mov_b32 s32, s31
    s_nop 0
    buffer_load_dwordx4 a[224:227], v102, s[12:15], s32 offen
    s_add_u32 s32, s32, 786432
    buffer_load_dwordx4 a[228:231], v102, s[12:15], s32 offen
    s_add_u32 s32, s32, 786432
    buffer_load_dwordx4 a[232:235], v102, s[12:15], s32 offen
    s_add_u32 s32, s32, 786432
    buffer_load_dwordx4 a[236:239], v102, s[12:15], s32 offen
NOLATE:
    s_mov_b32 s12, s40
    s_nop 0
    s_and_b32 s13, s41, 0xffff
    s_mov_b32 s14, 0x400000
    s_mov_b32 s15, 0x20000
    v_dot2_f32_bf16 v8, v160, s3, 0
    v_dot2_f32_bf16 v9, v160, v160, 0
    v_dot2_f32_bf16 v8, v161, s3, v8
    v_dot2_f32_bf16 v9, v161, v161, v9
    v_dot2_f32_bf16 v8, v162, s3, v8
    v_dot2_f32_bf16 v9, v162, v162, v9
    v_dot2_f32_bf16 v8, v163, s3, v8
    v_dot2_f32_bf16 v9, v163, v163, v9
    v_dot2_f32_bf16 v8, v164, s3, v8
    v_dot2_f32_bf16 v9, v164, v164, v9
    v_dot2_f32_bf16 v8, v165, s3, v8
    v_dot2_f32_bf16 v9, v165, v165, v9
    v_dot2_f32_bf16 v8, v166, s3, v8
    v_dot2_f32_bf16 v9, v166, v166, v9
    v_dot2_f32_bf16 v8, v167, s3, v8
    v_dot2_f32_bf16 v9, v167, v167, v9
    v_dot2_f32_bf16 v10, v168, s3, 0
    v_dot2_f32_bf16 v11, v168, v168, 0
    v_dot2_f32_bf16 v10, v169, s3, v10
    v_dot2_f32_bf16 v11, v169, v169, v11
    v_dot2_f32_bf16 v10, v170, s3, v10
    v_dot2_f32_bf16 v11, v170, v170, v11
    v_dot2_f32_bf16 v10, v171, s3, v10
    v_dot2_f32_bf16 v11, v171, v171, v11
    v_dot2_f32_bf16 v10, v172, s3, v10
    v_dot2_f32_bf16 v11, v172, v172, v11
    v_dot2_f32_bf16 v10, v173, s3, v10
    v_dot2_f32_bf16 v11, v173, v173, v11
    v_dot2_f32_bf16 v10, v174, s3, v10
    v_dot2_f32_bf16 v11, v174, v174, v11
    v_dot2_f32_bf16 v10, v175, s3, v10
    v_dot2_f32_bf16 v11, v175, v175, v11
    v_dot2_f32_bf16 v12, v176, s3, 0
    v_dot2_f32_bf16 v13, v176, v176, 0
    v_dot2_f32_bf16 v12, v177, s3, v12
    v_dot2_f32_bf16 v13, v177, v177, v13
    v_dot2_f32_bf16 v12, v178, s3, v12
    v_dot2_f32_bf16 v13, v178, v178, v13
    v_dot2_f32_bf16 v12, v179, s3, v12
    v_dot2_f32_bf16 v13, v179, v179, v13
    v_dot2_f32_bf16 v12, v180, s3, v12
    v_dot2_f32_bf16 v13, v180, v180, v13
    v_dot2_f32_bf16 v12, v181, s3, v12
    v_dot2_f32_bf16 v13, v181, v181, v13
    v_dot2_f32_bf16 v12, v182, s3, v12
    v_dot2_f32_bf16 v13, v182, v182, v13
    v_dot2_f32_bf16 v12, v183, s3, v12
    v_dot2_f32_bf16 v13, v183, v183, v13
    v_dot2_f32_bf16 v14, v184, s3, 0
    v_dot2_f32_bf16 v15, v184, v184, 0
    v_dot2_f32_bf16 v14, v185, s3, v14
    v_dot2_f32_bf16 v15, v185, v185, v15
    v_dot2_f32_bf16 v14, v186, s3, v14
    v_dot2_f32_bf16 v15, v186, v186, v15
    v_dot2_f32_bf16 v14, v187, s3, v14
    v_dot2_f32_bf16 v15, v187, v187, v15
    v_dot2_f32_bf16 v14, v188, s3, v14
    v_dot2_f32_bf16 v15, v188, v188, v15
    v_dot2_f32_bf16 v14, v189, s3, v14
    v_dot2_f32_bf16 v15, v189, v189, v15
    v_dot2_f32_bf16 v14, v190, s3, v14
    v_dot2_f32_bf16 v15, v190, v190, v15
    v_dot2_f32_bf16 v14, v191, s3, v14
    v_dot2_f32_bf16 v15, v191, v191, v15
    s_nop 2
    s_nop 0
    v_add_f32_dpp v0, v0, v0 quad_perm:[1,0,3,2] row_mask:0xf bank_mask:0xf
    v_add_f32_dpp v1, v1, v1 quad_perm:[1,0,3,2] row_mask:0xf bank_mask:0xf
    v_add_f32_dpp v2, v2, v2 quad_perm:[1,0,3,2] row_mask:0xf bank_mask:0xf
    v_add_f32_dpp v3, v3, v3 quad_perm:[1,0,3,2] row_mask:0xf bank_mask:0xf
    v_add_f32_dpp v4, v4, v4 quad_perm:[1,0,3,2] row_mask:0xf bank_mask:0xf
    v_add_f32_dpp v5, v5, v5 quad_perm:[1,0,3,2] row_mask:0xf bank_mask:0xf
STUB0:
    s_cbranch_execz STUB4
    s_nop 0
    v_add_f32_dpp v6, v6, v6 quad_perm:[1,0,3,2] row_mask:0xf bank_mask:0xf
    v_add_f32_dpp v7, v7, v7 quad_perm:[1,0,3,2] row_mask:0xf bank_mask:0xf
    v_add_f32_dpp v8, v8, v8 quad_perm:[1,0,3,2] row_mask:0xf bank_mask:0xf
    v_add_f32_dpp v9, v9, v9 quad_perm:[1,0,3,2] row_mask:0xf bank_mask:0xf
    v_add_f32_dpp v10, v10, v10 quad_perm:[1,0,3,2] row_mask:0xf bank_mask:0xf
    v_add_f32_dpp v11, v11, v11 quad_perm:[1,0,3,2] row_mask:0xf bank_mask:0xf
    v_add_f32_dpp v12, v12, v12 quad_perm:[1,0,3,2] row_mask:0xf bank_mask:0xf
    v_add_f32_dpp v13, v13, v13 quad_perm:[1,0,3,2] row_mask:0xf bank_mask:0xf
    v_add_f32_dpp v14, v14, v14 quad_perm:[1,0,3,2] row_mask:0xf bank_mask:0xf
    v_add_f32_dpp v15, v15, v15 quad_perm:[1,0,3,2] row_mask:0xf bank_mask:0xf
    v_add_f32_dpp v0, v0, v0 quad_perm:[2,3,0,1] row_mask:0xf bank_mask:0xf
    v_add_f32_dpp v1, v1, v1 quad_perm:[2,3,0,1] row_mask:0xf bank_mask:0xf
    v_add_f32_dpp v2, v2, v2 quad_perm:[2,3,0,1] row_mask:0xf bank_mask:0xf
    v_add_f32_dpp v3, v3, v3 quad_perm:[2,3,0,1] row_mask:0xf bank_mask:0xf
    v_add_f32_dpp v4, v4, v4 quad_perm:[2,3,0,1] row_mask:0xf bank_mask:0xf
    v_add_f32_dpp v5, v5, v5 quad_perm:[2,3,0,1] row_mask:0xf bank_mask:0xf
    v_add_f32_dpp v6, v6, v6 quad_perm:[2,3,0,1] row_mask:0xf bank_mask:0xf
    v_add_f32_dpp v7, v7, v7 quad_perm:[2,3,0,1] row_mask:0xf bank_mask:0xf
    v_add_f32_dpp v8, v8, v8 quad_perm:[2,3,0,1] row_mask:0xf bank_mask:0xf
    v_add_f32_dpp v9, v9, v9 quad_perm:[2,3,0,1] row_mask:0xf bank_mask:0xf
    v_add_f32_dpp v10, v10, v10 quad_perm:[2,3,0,1] row_mask:0xf bank_mask:0xf
    v_add_f32_dpp v11, v11, v11 quad_perm:[2,3,0,1] row_mask:0xf bank_mask:0xf
    v_add_f32_dpp v12, v12, v12 quad_perm:[2,3,0,1] row_mask:0xf bank_mask:0xf
    v_add_f32_dpp v13, v13, v13 quad_perm:[2,3,0,1] row_mask:0xf bank_mask:0xf
    v_add_f32_dpp v14, v14, v14 quad_perm:[2,3,0,1] row_mask:0xf bank_mask:0xf
    v_add_f32_dpp v15, v15, v15 quad_perm:[2,3,0,1] row_mask:0xf bank_mask:0xf
    ds_write_b128 v252, v[0:3] offset:0
    ds_write_b128 v252, v[4:7] offset:16
    ds_write_b128 v252, v[8:11] offset:32
    ds_write_b128 v252, v[12:15] offset:48
    s_waitcnt lgkmcnt(0)
    s_barrier
    ds_read_b64 v[16:17], v253 offset:0
    ds_read_b64 v[18:19], v253 offset:512
    ds_read_b64 v[20:21], v253 offset:1024
    ds_read_b64 v[22:23], v253 offset:1536
    ds_read_b64 v[24:25], v253 offset:2048
    ds_read_b64 v[26:27], v253 offset:2560
    ds_read_b64 v[28:29], v253 offset:3072
    ds_read_b64 v[30:31], v253 offset:3584
    s_waitcnt lgkmcnt(6)
    v_pk_add_f32 v[16:17], v[16:17], v[18:19]
    s_waitcnt lgkmcnt(4)
    v_pk_add_f32 v[20:21], v[20:21], v[22:23]
    s_waitcnt lgkmcnt(2)
    v_pk_add_f32 v[24:25], v[24:25], v[26:27]
    s_waitcnt lgkmcnt(0)
    v_pk_add_f32 v[28:29], v[28:29], v[30:31]
    v_pk_add_f32 v[16:17], v[16:17], v[20:21]
    v_pk_add_f32 v[24:25], v[24:25], v[28:29]
    v_pk_add_f32 v[16:17], v[16:17], v[24:25]
    v_mul_f32 v16, 0xbb000000, v16
    v_mul_f32 v17, 0x3b000000, v17
    v_fma_f32 v17, -v16, v16, v17
    v_max_f32_e64 v17, 0, v17
    v_add_f32 v17, 0x3727c5ac, v17
    v_rsq_f32 v17, v17
    s_nop 0
    v_mul_f32_e64 v16, v16, v17
    ds_write_b64 v254, v[16:17] offset:4096
    ds_read_b128 v[112:115], v255 offset:4096
    ds_read_b128 v[116:119], v255 offset:4112
    ds_read_b128 v[120:123], v255 offset:4128
    ds_read_b128 v[124:127], v255 offset:4144
    ds_read_b64 v[244:245], v255 offset:4152
    v_lshlrev_b32 v0, 16, v128
    v_and_b32 v1, s58, v128
    v_lshlrev_b32 v2, 16, v129
    v_and_b32 v3, s58, v129
    v_lshlrev_b32 v4, 16, v130
    v_and_b32 v5, s58, v130
    v_lshlrev_b32 v6, 16, v131
    v_and_b32 v7, s58, v131
    v_lshlrev_b32 v8, 16, v132
    v_and_b32 v9, s58, v132
    v_lshlrev_b32 v10, 16, v133
    v_and_b32 v11, s58, v133
    v_lshlrev_b32 v12, 16, v134
    v_and_b32 v13, s58, v134
    v_lshlrev_b32 v14, 16, v135
    v_and_b32_e64 v15, s58, v135
    s_waitcnt lgkmcnt(4)
    v_pk_fma_f32 v[0:1], v[0:1], v[112:113], v[112:113] op_sel:[0,1,0] op_sel_hi:[1,1,0]
    v_pk_fma_f32 v[2:3], v[2:3], v[112:113], v[112:113] op_sel:[0,1,0] op_sel_hi:[1,1,0]
    v_pk_fma_f32 v[4:5], v[4:5], v[112:113], v[112:113] op_sel:[0,1,0] op_sel_hi:[1,1,0]
    v_pk_fma_f32 v[6:7], v[6:7], v[112:113], v[112:113] op_sel:[0,1,0] op_sel_hi:[1,1,0]
    v_pk_fma_f32 v[8:9], v[8:9], v[112:113], v[112:113] op_sel:[0,1,0] op_sel_hi:[1,1,0]
    v_pk_fma_f32 v[10:11], v[10:11], v[112:113], v[112:113] op_sel:[0,1,0] op_sel_hi:[1,1,0]
    v_pk_fma_f32 v[12:13], v[12:13], v[112:113], v[112:113] op_sel:[0,1,0] op_sel_hi:[1,1,0]
    v_pk_fma_f32 v[14:15], v[14:15], v[112:113], v[112:113] op_sel:[0,1,0] op_sel_hi:[1,1,0]
    v_lshlrev_b32 v16, 16, v136
    v_and_b32 v17, s58, v136
    v_lshlrev_b32 v18, 16, v137
    v_and_b32 v19, s58, v137
    v_lshlrev_b32 v20, 16, v138
    v_and_b32 v21, s58, v138
    v_lshlrev_b32 v22, 16, v139
    v_and_b32 v23, s58, v139
    v_lshlrev_b32 v24, 16, v140
    v_and_b32 v25, s58, v140
    v_lshlrev_b32 v26, 16, v141
    v_and_b32 v27, s58, v141
    v_lshlrev_b32 v28, 16, v142
    v_and_b32 v29, s58, v142
    v_lshlrev_b32 v30, 16, v143
    v_and_b32 v31, s58, v143
    v_pk_fma_f32 v[16:17], v[16:17], v[114:115], v[114:115] op_sel:[0,1,0] op_sel_hi:[1,1,0]
    v_pk_fma_f32 v[18:19], v[18:19], v[114:115], v[114:115] op_sel:[0,1,0] op_sel_hi:[1,1,0]
    v_pk_fma_f32 v[20:21], v[20:21], v[114:115], v[114:115] op_sel:[0,1,0] op_sel_hi:[1,1,0]
    v_pk_fma_f32 v[22:23], v[22:23], v[114:115], v[114:115] op_sel:[0,1,0] op_sel_hi:[1,1,0]
    v_pk_fma_f32 v[24:25], v[24:25], v[114:115], v[114:115] op_sel:[0,1,0] op_sel_hi:[1,1,0]
    v_pk_fma_f32 v[26:27], v[26:27], v[114:115], v[114:115] op_sel:[0,1,0] op_sel_hi:[1,1,0]
    v_pk_fma_f32 v[28:29], v[28:29], v[114:115], v[114:115] op_sel:[0,1,0] op_sel_hi:[1,1,0]
    v_pk_fma_f32 v[30:31], v[30:31], v[114:115], v[114:115] op_sel:[0,1,0] op_sel_hi:[1,1,0]
    v_lshlrev_b32 v32, 16, v144
    v_and_b32 v33, s58, v144
    v_lshlrev_b32 v34, 16, v145
    v_and_b32 v35, s58, v145
    v_lshlrev_b32 v36, 16, v146
    v_and_b32 v37, s58, v146
    v_lshlrev_b32 v38, 16, v147
    v_and_b32 v39, s58, v147
    v_lshlrev_b32 v40, 16, v148
    v_and_b32 v41, s58, v148
    v_lshlrev_b32 v42, 16, v149
    v_and_b32 v43, s58, v149
    v_lshlrev_b32 v44, 16, v150
    v_and_b32 v45, s58, v150
    v_lshlrev_b32 v46, 16, v151
    v_and_b32_e64 v47, s58, v151
    s_waitcnt lgkmcnt(3)
    v_pk_fma_f32 v[32:33], v[32:33], v[116:117], v[116:117] op_sel:[0,1,0] op_sel_hi:[1,1,0]
    v_pk_fma_f32 v[34:35], v[34:35], v[116:117], v[116:117] op_sel:[0,1,0] op_sel_hi:[1,1,0]
    v_pk_fma_f32 v[36:37], v[36:37], v[116:117], v[116:117] op_sel:[0,1,0] op_sel_hi:[1,1,0]
    v_pk_fma_f32 v[38:39], v[38:39], v[116:117], v[116:117] op_sel:[0,1,0] op_sel_hi:[1,1,0]
    v_pk_fma_f32 v[40:41], v[40:41], v[116:117], v[116:117] op_sel:[0,1,0] op_sel_hi:[1,1,0]
    v_pk_fma_f32 v[42:43], v[42:43], v[116:117], v[116:117] op_sel:[0,1,0] op_sel_hi:[1,1,0]
    v_pk_fma_f32 v[44:45], v[44:45], v[116:117], v[116:117] op_sel:[0,1,0] op_sel_hi:[1,1,0]
    v_pk_fma_f32 v[46:47], v[46:47], v[116:117], v[116:117] op_sel:[0,1,0] op_sel_hi:[1,1,0]
    v_lshlrev_b32 v48, 16, v152
    v_and_b32 v49, s58, v152
    v_lshlrev_b32 v50, 16, v153
    v_and_b32 v51, s58, v153
    v_lshlrev_b32 v52, 16, v154
    v_and_b32 v53, s58, v154
    v_lshlrev_b32 v54, 16, v155
    v_and_b32 v55, s58, v155
    v_lshlrev_b32 v56, 16, v156
    v_and_b32 v57, s58, v156
    v_lshlrev_b32 v58, 16, v157
    v_and_b32 v59, s58, v157
    v_lshlrev_b32 v60, 16, v158
    v_and_b32 v61, s58, v158
    v_lshlrev_b32 v62, 16, v159
    v_and_b32 v63, s58, v159
    v_pk_fma_f32 v[48:49], v[48:49], v[118:119], v[118:119] op_sel:[0,1,0] op_sel_hi:[1,1,0]
    v_pk_fma_f32 v[50:51], v[50:51], v[118:119], v[118:119] op_sel:[0,1,0] op_sel_hi:[1,1,0]
    v_pk_fma_f32 v[52:53], v[52:53], v[118:119], v[118:119] op_sel:[0,1,0] op_sel_hi:[1,1,0]
    v_pk_fma_f32 v[54:55], v[54:55], v[118:119], v[118:119] op_sel:[0,1,0] op_sel_hi:[1,1,0]
    v_pk_fma_f32 v[56:57], v[56:57], v[118:119], v[118:119] op_sel:[0,1,0] op_sel_hi:[1,1,0]
    v_pk_fma_f32 v[58:59], v[58:59], v[118:119], v[118:119] op_sel:[0,1,0] op_sel_hi:[1,1,0]
    v_pk_fma_f32 v[60:61], v[60:61], v[118:119], v[118:119] op_sel:[0,1,0] op_sel_hi:[1,1,0]
    v_pk_fma_f32 v[62:63], v[62:63], v[118:119], v[118:119] op_sel:[0,1,0] op_sel_hi:[1,1,0]
    v_lshlrev_b32 v64, 16, v160
    v_and_b32 v65, s58, v160
    v_lshlrev_b32 v66, 16, v161
    v_and_b32 v67, s58, v161
    v_lshlrev_b32 v68, 16, v162
    v_and_b32 v69, s58, v162
    v_lshlrev_b32 v70, 16, v163
    v_and_b32 v71, s58, v163
    v_lshlrev_b32 v72, 16, v164
    v_and_b32 v73, s58, v164
    v_lshlrev_b32 v74, 16, v165
    v_and_b32 v75, s58, v165
    v_lshlrev_b32 v76, 16, v166
    v_and_b32 v77, s58, v166
    v_lshlrev_b32 v78, 16, v167
    v_and_b32_e64 v79, s58, v167
    s_waitcnt lgkmcnt(2)
    v_pk_fma_f32 v[64:65], v[64:65], v[120:121], v[120:121] op_sel:[0,1,0] op_sel_hi:[1,1,0]
    v_pk_fma_f32 v[66:67], v[66:67], v[120:121], v[120:121] op_sel:[0,1,0] op_sel_hi:[1,1,0]
    v_pk_fma_f32 v[68:69], v[68:69], v[120:121], v[120:121] op_sel:[0,1,0] op_sel_hi:[1,1,0]
    v_pk_fma_f32 v[70:71], v[70:71], v[120:121], v[120:121] op_sel:[0,1,0] op_sel_hi:[1,1,0]
    v_pk_fma_f32 v[72:73], v[72:73], v[120:121], v[120:121] op_sel:[0,1,0] op_sel_hi:[1,1,0]
    v_pk_fma_f32 v[74:75], v[74:75], v[120:121], v[120:121] op_sel:[0,1,0] op_sel_hi:[1,1,0]
    v_pk_fma_f32 v[76:77], v[76:77], v[120:121], v[120:121] op_sel:[0,1,0] op_sel_hi:[1,1,0]
    v_pk_fma_f32 v[78:79], v[78:79], v[120:121], v[120:121] op_sel:[0,1,0] op_sel_hi:[1,1,0]
    v_lshlrev_b32 v80, 16, v168
    v_and_b32 v81, s58, v168
    v_lshlrev_b32 v82, 16, v169
    v_and_b32 v83, s58, v169
    v_lshlrev_b32 v84, 16, v170
    v_and_b32 v85, s58, v170
    v_lshlrev_b32 v86, 16, v171
    v_and_b32 v87, s58, v171
    v_lshlrev_b32 v88, 16, v172
    v_and_b32 v89, s58, v172
    v_lshlrev_b32 v90, 16, v173
    v_and_b32 v91, s58, v173
    v_lshlrev_b32 v92, 16, v174
    v_and_b32 v93, s58, v174
    v_lshlrev_b32 v94, 16, v175
    v_and_b32 v95, s58, v175
    v_pk_fma_f32 v[80:81], v[80:81], v[122:123], v[122:123] op_sel:[0,1,0] op_sel_hi:[1,1,0]
    v_pk_fma_f32 v[82:83], v[82:83], v[122:123], v[122:123] op_sel:[0,1,0] op_sel_hi:[1,1,0]
    v_pk_fma_f32 v[84:85], v[84:85], v[122:123], v[122:123] op_sel:[0,1,0] op_sel_hi:[1,1,0]
    v_pk_fma_f32 v[86:87], v[86:87], v[122:123], v[122:123] op_sel:[0,1,0] op_sel_hi:[1,1,0]
    v_pk_fma_f32 v[88:89], v[88:89], v[122:123], v[122:123] op_sel:[0,1,0] op_sel_hi:[1,1,0]
    v_pk_fma_f32 v[90:91], v[90:91], v[122:123], v[122:123] op_sel:[0,1,0] op_sel_hi:[1,1,0]
    v_pk_fma_f32 v[92:93], v[92:93], v[122:123], v[122:123] op_sel:[0,1,0] op_sel_hi:[1,1,0]
    v_pk_fma_f32 v[94:95], v[94:95], v[122:123], v[122:123] op_sel:[0,1,0] op_sel_hi:[1,1,0]
    v_lshlrev_b32 v96, 16, v176
    v_and_b32 v97, s58, v176
    v_lshlrev_b32 v98, 16, v177
    v_and_b32 v99, s58, v177
    v_lshlrev_b32 v100, 16, v178
    v_and_b32 v101, s58, v178
    v_lshlrev_b32 v102, 16, v179
    v_and_b32 v103, s58, v179
    v_lshlrev_b32 v104, 16, v180
    v_and_b32 v105, s58, v180
    v_lshlrev_b32 v106, 16, v181
    v_and_b32 v107, s58, v181
    v_lshlrev_b32 v108, 16, v182
    v_and_b32 v109, s58, v182
    v_lshlrev_b32 v110, 16, v183
    v_and_b32_e64 v111, s58, v183
    s_waitcnt lgkmcnt(1)
    v_pk_fma_f32 v[96:97], v[96:97], v[124:125], v[124:125] op_sel:[0,1,0] op_sel_hi:[1,1,0]
    v_pk_fma_f32 v[98:99], v[98:99], v[124:125], v[124:125] op_sel:[0,1,0] op_sel_hi:[1,1,0]
    v_pk_fma_f32 v[100:101], v[100:101], v[124:125], v[124:125] op_sel:[0,1,0] op_sel_hi:[1,1,0]
    v_pk_fma_f32 v[102:103], v[102:103], v[124:125], v[124:125] op_sel:[0,1,0] op_sel_hi:[1,1,0]
    v_pk_fma_f32 v[104:105], v[104:105], v[124:125], v[124:125] op_sel:[0,1,0] op_sel_hi:[1,1,0]
    v_pk_fma_f32 v[106:107], v[106:107], v[124:125], v[124:125] op_sel:[0,1,0] op_sel_hi:[1,1,0]
    v_pk_fma_f32 v[108:109], v[108:109], v[124:125], v[124:125] op_sel:[0,1,0] op_sel_hi:[1,1,0]
    v_pk_fma_f32 v[110:111], v[110:111], v[124:125], v[124:125] op_sel:[0,1,0] op_sel_hi:[1,1,0]
    v_lshlrev_b32 v112, 16, v184
    v_and_b32 v113, s58, v184
    v_lshlrev_b32 v114, 16, v185
    v_and_b32 v115, s58, v185
    v_lshlrev_b32 v116, 16, v186
    v_and_b32 v117, s58, v186
    v_lshlrev_b32 v118, 16, v187
    v_and_b32 v119, s58, v187
    v_lshlrev_b32 v120, 16, v188
    v_and_b32 v121, s58, v188
    v_lshlrev_b32 v122, 16, v189
    v_and_b32 v123, s58, v189
    v_lshlrev_b32 v124, 16, v190
    v_and_b32 v125, s58, v190
    v_lshlrev_b32 v126, 16, v191
    v_and_b32_e64 v127, s58, v191
    s_waitcnt lgkmcnt(0)
    v_pk_fma_f32 v[112:113], v[112:113], v[244:245], v[244:245] op_sel:[0,1,0] op_sel_hi:[1,1,0]
    v_pk_fma_f32 v[114:115], v[114:115], v[244:245], v[244:245] op_sel:[0,1,0] op_sel_hi:[1,1,0]
    v_pk_fma_f32 v[116:117], v[116:117], v[244:245], v[244:245] op_sel:[0,1,0] op_sel_hi:[1,1,0]
    v_pk_fma_f32 v[118:119], v[118:119], v[244:245], v[244:245] op_sel:[0,1,0] op_sel_hi:[1,1,0]
    v_pk_fma_f32 v[120:121], v[120:121], v[244:245], v[244:245] op_sel:[0,1,0] op_sel_hi:[1,1,0]
    v_pk_fma_f32 v[122:123], v[122:123], v[244:245], v[244:245] op_sel:[0,1,0] op_sel_hi:[1,1,0]
    v_pk_fma_f32 v[124:125], v[124:125], v[244:245], v[244:245] op_sel:[0,1,0] op_sel_hi:[1,1,0]
    v_pk_fma_f32 v[126:127], v[126:127], v[244:245], v[244:245] op_sel:[0,1,0] op_sel_hi:[1,1,0]
    s_sub_u32 s32, s7, 64
    s_cmp_ge_u32 s32, 128
    s_cselect_b32 s32, 1, s39
    s_cmp_lg_u32 s32, 0
    s_cbranch_scc1 NOGEMVB
    s_waitcnt vmcnt(3)
    v_accvgpr_read_b32 v160, a224
    v_accvgpr_read_b32 v161, a225
    v_accvgpr_read_b32 v162, a226
    v_accvgpr_read_b32 v163, a227
    s_waitcnt vmcnt(2)
    v_accvgpr_read_b32 v164, a228
    v_accvgpr_read_b32 v165, a229
    v_accvgpr_read_b32 v166, a230
    v_accvgpr_read_b32 v167, a231
    s_waitcnt vmcnt(1)
    v_accvgpr_read_b32 v168, a232
    v_accvgpr_read_b32 v169, a233
    v_accvgpr_read_b32 v170, a234
    v_accvgpr_read_b32 v171, a235
    s_waitcnt vmcnt(0)
    v_accvgpr_read_b32 v172, a236
    v_accvgpr_read_b32 v173, a237
    v_accvgpr_read_b32 v174, a238
    v_accvgpr_read_b32 v175, a239
    v_accvgpr_read_b32 v176, a240
    v_accvgpr_read_b32 v177, a241
    v_accvgpr_read_b32 v178, a242
    v_accvgpr_read_b32 v179, a243
    v_accvgpr_read_b32 v152, a244
    s_mov_b32 s33, 0xbfb8aa3b
    v_lshlrev_b32 v176, 16, v176
    v_lshlrev_b32 v177, 16, v177
    v_lshlrev_b32 v178, 16, v178
    v_lshlrev_b32 v179, 16, v179
    v_mul_f32 v180, s33, v176
    v_mul_f32 v181, s33, v177
    v_mul_f32 v182, s33, v178
    v_mul_f32 v183, s33, v179
    v_exp_f32 v180, v180
    v_exp_f32 v181, v181
    v_exp_f32 v182, v182
    v_exp_f32 v183, v183
    v_add_f32 v180, 1.0, v180
    v_add_f32 v181, 1.0, v181
    v_add_f32 v182, 1.0, v182
    v_add_f32 v183, 1.0, v183
    v_rcp_f32 v180, v180
    v_rcp_f32 v181, v181
    v_rcp_f32 v182, v182
    v_rcp_f32 v183, v183
    v_mul_f32 v176, v176, v180
    v_mul_f32 v177, v177, v181
    v_mul_f32 v178, v178, v182
    v_mul_f32 v179, v179, v183
    v_cvt_pk_bf16_f32 v144, 0, v176
    v_cvt_pk_bf16_f32 v146, 0, v177
    v_cvt_pk_bf16_f32 v148, 0, v178
    v_cvt_pk_bf16_f32 v150, 0, v179
    v_lshlrev_b32 v188, 16, v160
    v_and_b32 v189, s58, v160
    v_pk_mul_f32 v[180:181], v[188:189], v[144:145] op_sel_hi:[1,0]
    v_lshlrev_b32 v190, 16, v161
    v_and_b32 v191, s58, v161
    v_pk_mul_f32 v[182:183], v[190:191], v[144:145] op_sel_hi:[1,0]
    v_lshlrev_b32 v188, 16, v162
    v_and_b32 v189, s58, v162
    v_pk_mul_f32 v[184:185], v[188:189], v[144:145] op_sel_hi:[1,0]
    v_lshlrev_b32 v190, 16, v163
    v_and_b32 v191, s58, v163
    v_pk_mul_f32 v[186:187], v[190:191], v[144:145] op_sel_hi:[1,0]
    v_lshlrev_b32 v188, 16, v164
    v_and_b32 v189, s58, v164
    v_pk_fma_f32 v[180:181], v[188:189], v[146:147], v[180:181] op_sel_hi:[1,0,1]
    v_lshlrev_b32 v190, 16, v165
    v_and_b32 v191, s58, v165
    v_pk_fma_f32 v[182:183], v[190:191], v[146:147], v[182:183] op_sel_hi:[1,0,1]
    v_lshlrev_b32 v188, 16, v166
    v_and_b32 v189, s58, v166
    v_pk_fma_f32 v[184:185], v[188:189], v[146:147], v[184:185] op_sel_hi:[1,0,1]
    v_lshlrev_b32 v190, 16, v167
    v_and_b32 v191, s58, v167
    v_pk_fma_f32 v[186:187], v[190:191], v[146:147], v[186:187] op_sel_hi:[1,0,1]
    v_lshlrev_b32 v188, 16, v168
    v_and_b32 v189, s58, v168
    v_pk_fma_f32 v[180:181], v[188:189], v[148:149], v[180:181] op_sel_hi:[1,0,1]
    v_lshlrev_b32 v190, 16, v169
    v_and_b32 v191, s58, v169
    v_pk_fma_f32 v[182:183], v[190:191], v[148:149], v[182:183] op_sel_hi:[1,0,1]
    v_lshlrev_b32 v188, 16, v170
    v_and_b32 v189, s58, v170
    v_pk_fma_f32 v[184:185], v[188:189], v[148:149], v[184:185] op_sel_hi:[1,0,1]
    v_lshlrev_b32 v190, 16, v171
    v_and_b32 v191, s58, v171
    v_pk_fma_f32 v[186:187], v[190:191], v[148:149], v[186:187] op_sel_hi:[1,0,1]
    v_lshlrev_b32 v188, 16, v172
    v_and_b32 v189, s58, v172
    v_pk_fma_f32 v[180:181], v[188:189], v[150:151], v[180:181] op_sel_hi:[1,0,1]
    v_lshlrev_b32 v190, 16, v173
    v_and_b32 v191, s58, v173
    v_pk_fma_f32 v[182:183], v[190:191], v[150:151], v[182:183] op_sel_hi:[1,0,1]
    v_lshlrev_b32 v188, 16, v174
    v_and_b32 v189, s58, v174
    v_pk_fma_f32 v[184:185], v[188:189], v[150:151], v[184:185] op_sel_hi:[1,0,1]
    v_lshlrev_b32 v190, 16, v175
    v_and_b32 v191, s58, v175
    v_pk_fma_f32 v[186:187], v[190:191], v[150:151], v[186:187] op_sel_hi:[1,0,1]
    v_add_f32_dpp v180, v180, v180 quad_perm:[2,3,0,1] row_mask:0xf bank_mask:0xf
    v_add_f32_dpp v181, v181, v181 quad_perm:[2,3,0,1] row_mask:0xf bank_mask:0xf
    v_add_f32_dpp v182, v182, v182 quad_perm:[2,3,0,1] row_mask:0xf bank_mask:0xf
    v_add_f32_dpp v183, v183, v183 quad_perm:[2,3,0,1] row_mask:0xf bank_mask:0xf
    v_add_f32_dpp v184, v184, v184 quad_perm:[2,3,0,1] row_mask:0xf bank_mask:0xf
    v_add_f32_dpp v185, v185, v185 quad_perm:[2,3,0,1] row_mask:0xf bank_mask:0xf
    v_add_f32_dpp v186, v186, v186 quad_perm:[2,3,0,1] row_mask:0xf bank_mask:0xf
    v_add_f32_dpp v187, v187, v187 quad_perm:[2,3,0,1] row_mask:0xf bank_mask:0xf
    v_add_f32_dpp v180, v180, v180 row_ror:4 row_mask:0xf bank_mask:0xf
    v_add_f32_dpp v181, v181, v181 row_ror:4 row_mask:0xf bank_mask:0xf
    v_add_f32_dpp v182, v182, v182 row_ror:4 row_mask:0xf bank_mask:0xf
    v_add_f32_dpp v183, v183, v183 row_ror:4 row_mask:0xf bank_mask:0xf
    v_add_f32_dpp v184, v184, v184 row_ror:4 row_mask:0xf bank_mask:0xf
    v_add_f32_dpp v185, v185, v185 row_ror:4 row_mask:0xf bank_mask:0xf
    v_add_f32_dpp v186, v186, v186 row_ror:4 row_mask:0xf bank_mask:0xf
    v_add_f32_dpp v187, v187, v187 row_ror:4 row_mask:0xf bank_mask:0xf
    v_add_f32_dpp v180, v180, v180 row_ror:8 row_mask:0xf bank_mask:0xf
    v_add_f32_dpp v181, v181, v181 row_ror:8 row_mask:0xf bank_mask:0xf
    v_add_f32_dpp v182, v182, v182 row_ror:8 row_mask:0xf bank_mask:0xf
    v_add_f32_dpp v183, v183, v183 row_ror:8 row_mask:0xf bank_mask:0xf
    v_add_f32_dpp v184, v184, v184 row_ror:8 row_mask:0xf bank_mask:0xf
    v_add_f32_dpp v185, v185, v185 row_ror:8 row_mask:0xf bank_mask:0xf
    v_add_f32_dpp v186, v186, v186 row_ror:8 row_mask:0xf bank_mask:0xf
    v_add_f32_dpp v187, v187, v187 row_ror:8 row_mask:0xf bank_mask:0xf
    ds_write_b128 v152, v[180:183] offset:20480
    ds_write_b128 v152, v[184:187] offset:20496
    v_lshlrev_b32_e64 v153, 2, v220
    s_lshr_b32 s32, s7, 5
    s_cmp_eq_u32 s32, 1
    s_cselect_b32 s33, 1.0, 0
    s_cmp_eq_u32 s32, 4
    s_cselect_b32 s33, 1.0, s33
    s_cmp_lt_u32 s32, 2
    s_cselect_b32 s51, 0x3e0293ee, 1.0
    s_cmp_ge_u32 s32, 3
    s_cselect_b32 s51, 0x3eeff558, s51
    s_cmp_eq_u32 s32, 5
    s_cselect_b32 s51, 0x4091afa4, s51
    s_lshl_b32 s32, s7, 6
    s_waitcnt lgkmcnt(0)
    s_barrier
    s_cmp_lg_u32 s28, 3
    s_cbranch_scc1 NOGEMVB
    ds_read_b32 v180, v153 offset:20480
    ds_read_b32 v181, v153 offset:20736
    ds_read_b32 v182, v153 offset:20992
    ds_read_b32 v183, v153 offset:21248
    s_waitcnt lgkmcnt(2)
    v_add_f32 v180, v180, v181
    s_waitcnt lgkmcnt(0)
    v_add_f32 v182, v182, v183
    v_add_f32 v180, v180, v182
    v_mov_b32 v181, v180
    s_nop 1
    v_permlane16_swap_b32 v180, v181
    v_add_f32 v180, v180, v181
    v_mov_b32 v181, v180
    s_nop 1
    v_permlane32_swap_b32 v180, v181
    v_add_f32 v180, v180, v181
    v_cvt_pk_bf16_f32 v180, 0, v180
    v_add_f32 v180, s33, v180
    v_mul_f32 v180, s51, v180
    s_mov_b64 exec, 0xffff
    buffer_store_dword v180, v153, s[24:27], s32 offen sc1
    s_mov_b64 exec, -1
NOGEMVB:
    s_lshr_b32 s36, s50, 1
    s_lshl_b32 s36, s36, 13
    s_add_u32 s37, s36, 8192
    s_and_b32 s37, s37, 0x1ffff
    s_add_u32 s38, s37, 8192
    s_and_b32 s38, s38, 0x1ffff
    s_waitcnt lgkmcnt(0)
    s_lshl_b32 s33, s39, 2
    s_sub_u32 s33, s33, s39
    v_mov_b32_e64 v248, 0
    s_mov_b32 s51, 0
POLL:
    s_add_u32 s33, s33, 1
    s_and_b32 s32, s33, 3
    s_cbranch_scc1 POLLR
    buffer_load_dword v249, v248, s[20:23], 0 offen sc1
    s_waitcnt vmcnt(0)
    v_readfirstlane_b32 s32, v249
    s_nop 0
    s_cmp_ge_u32 s32, 0x100
    s_cselect_b32 s51, 1, 0
    s_cmp_gt_u32 s33, 0x8000
    s_cselect_b32 s51, 1, s51
POLLR:
    buffer_load_dwordx4 v[160:163], v240, s[24:27], s63 offen sc1
    s_waitcnt vmcnt(0)
    v_xor_b32_e64 v250, v160, v236
    v_bitop3_b32 v250, v161, v237, v250 bitop3:0x28
    v_bitop3_b32 v250, v162, v238, v250 bitop3:0x28
    v_bitop3_b32 v250, v163, v239, v250 bitop3:0x28
    v_and_b32 v250, 1, v250
    v_cmp_eq_u32 vcc, 0, v250
    s_nop 0
    s_cmp_lg_u64 vcc, 0
    s_cselect_b32 s51, s51, 1
    s_cmp_lg_u32 s61, 0
    s_cbranch_scc1 NOARR
    s_mov_b64 exec, 1
    v_mov_b32_e64 v251, 1
    buffer_atomic_add v251, v248, s[20:23], 0 offen
    s_mov_b64 exec, -1
    s_mov_b32 s61, 1
NOARR:
    s_cmp_lg_u32 s51, 0
    s_cbranch_scc1 POLLED
    s_sleep 2
    s_branch POLL
POLLED:
    v_and_b32 v160, -2, v160
    v_and_b32 v161, -2, v161
    v_and_b32 v162, -2, v162
    v_and_b32 v163, -2, v163
    s_lshl_b32 s32, s28, 10
    v_add_u32 v249, s32, v216
    ds_write_b128 v249, v[160:163] offset:16384
    ds_read_b128 v[128:131], v235 offset:16896
    ds_read_b128 v[132:135], v235 offset:16912
    ds_read_b128 v[136:139], v235 offset:16384
    ds_read_b128 v[140:143], v235 offset:16400
    ds_read_b128 v[144:147], v235 offset:17152
    ds_read_b128 v[148:151], v235 offset:17168
    ds_read_b128 v[152:155], v235 offset:16640
    ds_read_b128 v[156:159], v235 offset:16656
    s_mov_b32 s20, s46
    s_nop 0
    s_and_b32 s21, s47, 0xffff
    s_mov_b32 s22, 0x400000
    s_mov_b32 s23, 0x20000
    ds_read_b64_tr_b16 a[128:129], v204 offset:0
    ds_read_b64_tr_b16 a[130:131], v204 offset:1024
    ds_read_b64_tr_b16 a[132:133], v205 offset:0
    ds_read_b64_tr_b16 a[134:135], v205 offset:1024
    ds_read_b64_tr_b16 a[136:137], v206 offset:0
    ds_read_b64_tr_b16 a[138:139], v206 offset:1024
    ds_read_b64_tr_b16 a[140:141], v207 offset:0
    ds_read_b64_tr_b16 a[142:143], v207 offset:1024
    s_waitcnt lgkmcnt(13)
    v_pk_fma_f32 v[0:1], v[0:1], v[128:129], v[136:137]
    v_pk_fma_f32 v[2:3], v[2:3], v[130:131], v[138:139]
    s_waitcnt lgkmcnt(12)
    v_pk_fma_f32 v[4:5], v[4:5], v[132:133], v[140:141]
    v_pk_fma_f32 v[6:7], v[6:7], v[134:135], v[142:143]
    v_cvt_pk_bf16_f32 v0, v0, v1
    v_cvt_pk_bf16_f32 v1, v2, v3
    v_cvt_pk_bf16_f32 v2, v4, v5
    v_cvt_pk_bf16_f32 v3, v6, v7
    s_waitcnt lgkmcnt(9)
    v_pk_fma_f32 v[8:9], v[8:9], v[144:145], v[152:153]
    v_pk_fma_f32 v[10:11], v[10:11], v[146:147], v[154:155]
    s_waitcnt lgkmcnt(8)
    v_pk_fma_f32 v[12:13], v[12:13], v[148:149], v[156:157]
    v_pk_fma_f32 v[14:15], v[14:15], v[150:151], v[158:159]
    v_cvt_pk_bf16_f32 v8, v8, v9
    v_cvt_pk_bf16_f32 v9, v10, v11
    v_cvt_pk_bf16_f32 v10, v12, v13
    v_cvt_pk_bf16_f32 v11, v14, v15
    ds_write_b128 v231, v[0:3] offset:0
    ds_write_b128 v232, v[8:11] offset:0
    v_pk_fma_f32 v[16:17], v[16:17], v[128:129], v[136:137]
    v_pk_fma_f32 v[18:19], v[18:19], v[130:131], v[138:139]
    v_pk_fma_f32 v[20:21], v[20:21], v[132:133], v[140:141]
    v_pk_fma_f32 v[22:23], v[22:23], v[134:135], v[142:143]
    v_cvt_pk_bf16_f32 v16, v16, v17
    v_cvt_pk_bf16_f32 v17, v18, v19
    v_cvt_pk_bf16_f32 v18, v20, v21
    v_cvt_pk_bf16_f32 v19, v22, v23
    v_pk_fma_f32 v[24:25], v[24:25], v[144:145], v[152:153]
    v_pk_fma_f32 v[26:27], v[26:27], v[146:147], v[154:155]
    v_pk_fma_f32 v[28:29], v[28:29], v[148:149], v[156:157]
    v_pk_fma_f32 v[30:31], v[30:31], v[150:151], v[158:159]
    v_cvt_pk_bf16_f32 v24, v24, v25
    v_cvt_pk_bf16_f32 v25, v26, v27
    v_cvt_pk_bf16_f32 v26, v28, v29
    v_cvt_pk_bf16_f32 v27, v30, v31
    ds_write_b128 v231, v[16:19] offset:128
    ds_write_b128 v232, v[24:27] offset:128
    v_pk_fma_f32 v[32:33], v[32:33], v[128:129], v[136:137]
    v_pk_fma_f32 v[34:35], v[34:35], v[130:131], v[138:139]
    v_pk_fma_f32 v[36:37], v[36:37], v[132:133], v[140:141]
    v_pk_fma_f32 v[38:39], v[38:39], v[134:135], v[142:143]
    v_cvt_pk_bf16_f32 v32, v32, v33
    v_cvt_pk_bf16_f32 v33, v34, v35
    v_cvt_pk_bf16_f32 v34, v36, v37
    v_cvt_pk_bf16_f32 v35, v38, v39
    v_pk_fma_f32 v[40:41], v[40:41], v[144:145], v[152:153]
    v_pk_fma_f32 v[42:43], v[42:43], v[146:147], v[154:155]
    v_pk_fma_f32 v[44:45], v[44:45], v[148:149], v[156:157]
    v_pk_fma_f32 v[46:47], v[46:47], v[150:151], v[158:159]
    v_cvt_pk_bf16_f32 v40, v40, v41
    v_cvt_pk_bf16_f32 v41, v42, v43
    v_cvt_pk_bf16_f32 v42, v44, v45
    v_cvt_pk_bf16_f32 v43, v46, v47
    ds_write_b128 v231, v[32:35] offset:256
    ds_write_b128 v232, v[40:43] offset:256
    v_pk_fma_f32 v[48:49], v[48:49], v[128:129], v[136:137]
    v_pk_fma_f32 v[50:51], v[50:51], v[130:131], v[138:139]
    v_pk_fma_f32 v[52:53], v[52:53], v[132:133], v[140:141]
    v_pk_fma_f32 v[54:55], v[54:55], v[134:135], v[142:143]
    v_cvt_pk_bf16_f32 v48, v48, v49
    v_cvt_pk_bf16_f32 v49, v50, v51
    v_cvt_pk_bf16_f32 v50, v52, v53
    v_cvt_pk_bf16_f32 v51, v54, v55
    v_pk_fma_f32 v[56:57], v[56:57], v[144:145], v[152:153]
    v_pk_fma_f32 v[58:59], v[58:59], v[146:147], v[154:155]
    v_pk_fma_f32 v[60:61], v[60:61], v[148:149], v[156:157]
    v_pk_fma_f32 v[62:63], v[62:63], v[150:151], v[158:159]
    v_cvt_pk_bf16_f32 v56, v56, v57
    v_cvt_pk_bf16_f32 v57, v58, v59
    v_cvt_pk_bf16_f32 v58, v60, v61
    v_cvt_pk_bf16_f32 v59, v62, v63
    ds_write_b128 v231, v[48:51] offset:384
    ds_write_b128 v232, v[56:59] offset:384
    v_pk_fma_f32 v[64:65], v[64:65], v[128:129], v[136:137]
    v_pk_fma_f32 v[66:67], v[66:67], v[130:131], v[138:139]
    v_pk_fma_f32 v[68:69], v[68:69], v[132:133], v[140:141]
    v_pk_fma_f32 v[70:71], v[70:71], v[134:135], v[142:143]
    v_cvt_pk_bf16_f32 v64, v64, v65
    v_cvt_pk_bf16_f32 v65, v66, v67
    v_cvt_pk_bf16_f32 v66, v68, v69
    v_cvt_pk_bf16_f32 v67, v70, v71
    v_pk_fma_f32 v[72:73], v[72:73], v[144:145], v[152:153]
    v_pk_fma_f32 v[74:75], v[74:75], v[146:147], v[154:155]
    v_pk_fma_f32 v[76:77], v[76:77], v[148:149], v[156:157]
    v_pk_fma_f32 v[78:79], v[78:79], v[150:151], v[158:159]
    v_cvt_pk_bf16_f32 v72, v72, v73
    v_cvt_pk_bf16_f32 v73, v74, v75
    v_cvt_pk_bf16_f32 v74, v76, v77
    v_cvt_pk_bf16_f32 v75, v78, v79
    ds_write_b128 v231, v[64:67] offset:32768
    ds_write_b128 v232, v[72:75] offset:32768
    v_pk_fma_f32 v[80:81], v[80:81], v[128:129], v[136:137]
    v_pk_fma_f32 v[82:83], v[82:83], v[130:131], v[138:139]
    v_pk_fma_f32 v[84:85], v[84:85], v[132:133], v[140:141]
    v_pk_fma_f32 v[86:87], v[86:87], v[134:135], v[142:143]
    v_cvt_pk_bf16_f32 v80, v80, v81
    v_cvt_pk_bf16_f32 v81, v82, v83
    v_cvt_pk_bf16_f32 v82, v84, v85
    v_cvt_pk_bf16_f32 v83, v86, v87
    v_pk_fma_f32 v[88:89], v[88:89], v[144:145], v[152:153]
    v_pk_fma_f32 v[90:91], v[90:91], v[146:147], v[154:155]
    v_pk_fma_f32 v[92:93], v[92:93], v[148:149], v[156:157]
    v_pk_fma_f32 v[94:95], v[94:95], v[150:151], v[158:159]
    v_cvt_pk_bf16_f32 v88, v88, v89
    v_cvt_pk_bf16_f32 v89, v90, v91
    v_cvt_pk_bf16_f32 v90, v92, v93
    v_cvt_pk_bf16_f32 v91, v94, v95
    ds_write_b128 v231, v[80:83] offset:32896
    ds_write_b128 v232, v[88:91] offset:32896
    v_pk_fma_f32 v[96:97], v[96:97], v[128:129], v[136:137]
    v_pk_fma_f32 v[98:99], v[98:99], v[130:131], v[138:139]
    v_pk_fma_f32 v[100:101], v[100:101], v[132:133], v[140:141]
    v_pk_fma_f32 v[102:103], v[102:103], v[134:135], v[142:143]
    v_cvt_pk_bf16_f32 v96, v96, v97
    v_cvt_pk_bf16_f32 v97, v98, v99
    v_cvt_pk_bf16_f32 v98, v100, v101
    v_cvt_pk_bf16_f32 v99, v102, v103
    v_pk_fma_f32 v[104:105], v[104:105], v[144:145], v[152:153]
    v_pk_fma_f32 v[106:107], v[106:107], v[146:147], v[154:155]
    v_pk_fma_f32 v[108:109], v[108:109], v[148:149], v[156:157]
    v_pk_fma_f32 v[110:111], v[110:111], v[150:151], v[158:159]
    v_cvt_pk_bf16_f32 v104, v104, v105
    v_cvt_pk_bf16_f32 v105, v106, v107
    v_cvt_pk_bf16_f32 v106, v108, v109
    v_cvt_pk_bf16_f32 v107, v110, v111
    ds_write_b128 v231, v[96:99] offset:33024
    ds_write_b128 v232, v[104:107] offset:33024
    v_pk_fma_f32 v[112:113], v[112:113], v[128:129], v[136:137]
    v_pk_fma_f32 v[114:115], v[114:115], v[130:131], v[138:139]
    v_pk_fma_f32 v[116:117], v[116:117], v[132:133], v[140:141]
    v_pk_fma_f32 v[118:119], v[118:119], v[134:135], v[142:143]
    v_cvt_pk_bf16_f32 v112, v112, v113
    v_cvt_pk_bf16_f32 v113, v114, v115
    v_cvt_pk_bf16_f32 v114, v116, v117
    v_cvt_pk_bf16_f32 v115, v118, v119
    v_pk_fma_f32 v[120:121], v[120:121], v[144:145], v[152:153]
STUB1:
    s_cbranch_execz STUB5
    s_nop 0
    v_pk_fma_f32 v[122:123], v[122:123], v[146:147], v[154:155]
    v_pk_fma_f32 v[124:125], v[124:125], v[148:149], v[156:157]
    v_pk_fma_f32 v[126:127], v[126:127], v[150:151], v[158:159]
    v_cvt_pk_bf16_f32 v120, v120, v121
    v_cvt_pk_bf16_f32 v121, v122, v123
    v_cvt_pk_bf16_f32 v122, v124, v125
    v_cvt_pk_bf16_f32 v123, v126, v127
    ds_write_b128 v231, v[112:115] offset:33152
    ds_write_b128 v232, v[120:123] offset:33152
    s_add_u32 s32, s55, s74
    s_add_u32 m0, s34, 8192
    s_nop 0
    buffer_load_dwordx4 v208, s[8:11], s32 offen lds
    buffer_load_dwordx4 v209, s[8:11], s32 offen offset:1024 lds
    buffer_load_dwordx4 v210, s[8:11], s32 offen offset:2048 lds
    buffer_load_dwordx4 v211, s[8:11], s32 offen offset:3072 lds
    s_add_u32 s32, s55, s75
    s_add_u32 m0, s34, 12288
    s_nop 0
    buffer_load_dwordx4 v208, s[8:11], s32 offen lds
    buffer_load_dwordx4 v209, s[8:11], s32 offen offset:1024 lds
    buffer_load_dwordx4 v210, s[8:11], s32 offen offset:2048 lds
    buffer_load_dwordx4 v211, s[8:11], s32 offen offset:3072 lds
    s_waitcnt lgkmcnt(0)
    s_barrier
    ds_read_b128 a[160:163], v215 offset:0
    ds_read_b128 a[164:167], v215 offset:32768
    s_waitcnt lgkmcnt(1)
    v_mfma_f32_32x32x16_bf16 v[0:15], a[128:131], a[160:163], 0
    ds_read_b128 a[168:171], v219 offset:1024
    ds_read_b64_tr_b16 a[144:145], v204 offset:4096
    ds_read_b64_tr_b16 a[146:147], v204 offset:5120
    s_add_u32 s32, s55, s76
    s_add_u32 m0, s34, 0
    s_waitcnt lgkmcnt(3)
    v_mfma_f32_32x32x16_bf16 v[16:31], a[128:131], a[164:167], 0
    buffer_load_dwordx4 v208, s[8:11], s32 offen lds
    ds_read_b64_tr_b16 a[148:149], v205 offset:4096
    ds_read_b64_tr_b16 a[150:151], v205 offset:5120
    v_mfma_f32_32x32x16_bf16 v[32:47], a[132:135], a[160:163], 0
    ds_read_b128 a[172:175], v219 offset:33792
    ds_read_b64_tr_b16 a[152:153], v206 offset:4096
    ds_read_b64_tr_b16 a[154:155], v206 offset:5120
    v_mfma_f32_32x32x16_bf16 v[48:63], a[132:135], a[164:167], 0
    buffer_load_dwordx4 v209, s[8:11], s32 offen offset:1024 lds
    ds_read_b64_tr_b16 a[156:157], v207 offset:4096
    v_mfma_f32_32x32x16_bf16 v[64:79], a[136:139], a[160:163], 0
    ds_read_b64_tr_b16 a[158:159], v207 offset:5120
    v_mfma_f32_32x32x16_bf16 v[80:95], a[136:139], a[164:167], 0
    buffer_load_dwordx4 v210, s[8:11], s32 offen offset:2048 lds
    v_mfma_f32_32x32x16_bf16 v[96:111], a[140:143], a[160:163], 0
    buffer_load_dwordx4 v211, s[8:11], s32 offen offset:3072 lds
    v_mfma_f32_32x32x16_bf16 v[112:127], a[140:143], a[164:167], 0
    s_waitcnt lgkmcnt(0)
    v_mfma_f32_32x32x16_bf16 v[0:15], a[144:147], a[168:171], v[0:15]
    ds_read_b128 a[160:163], v215 offset:2048
    s_waitcnt vmcnt(8)
    ds_read_b64_tr_b16 a[128:129], v204 offset:8192
    ds_read_b64_tr_b16 a[130:131], v204 offset:9216
    v_mfma_f32_32x32x16_bf16 v[16:31], a[144:147], a[172:175], v[16:31]
    ds_read_b64_tr_b16 a[132:133], v205 offset:8192
    ds_read_b64_tr_b16 a[134:135], v205 offset:9216
    s_add_u32 s32, s55, s77
    s_nop 0
    s_add_u32 m0, s34, 4096
    v_mfma_f32_32x32x16_bf16 v[32:47], a[148:151], a[168:171], v[32:47]
    buffer_load_dwordx4 v208, s[8:11], s32 offen lds
    ds_read_b128 a[164:167], v215 offset:34816
    ds_read_b64_tr_b16 a[136:137], v206 offset:8192
    ds_read_b64_tr_b16 a[138:139], v206 offset:9216
    v_mfma_f32_32x32x16_bf16 v[48:63], a[148:151], a[172:175], v[48:63]
    ds_read_b64_tr_b16 a[140:141], v207 offset:8192
    v_mfma_f32_32x32x16_bf16 v[64:79], a[152:155], a[168:171], v[64:79]
    buffer_load_dwordx4 v209, s[8:11], s32 offen offset:1024 lds
    ds_read_b64_tr_b16 a[142:143], v207 offset:9216
    v_mfma_f32_32x32x16_bf16 v[80:95], a[152:155], a[172:175], v[80:95]
    buffer_load_dwordx4 v210, s[8:11], s32 offen offset:2048 lds
    v_mfma_f32_32x32x16_bf16 v[96:111], a[156:159], a[168:171], v[96:111]
    buffer_load_dwordx4 v211, s[8:11], s32 offen offset:3072 lds
    v_mfma_f32_32x32x16_bf16 v[112:127], a[156:159], a[172:175], v[112:127]
    s_waitcnt lgkmcnt(0)
    v_mfma_f32_32x32x16_bf16 v[0:15], a[128:131], a[160:163], v[0:15]
    ds_read_b128 a[168:171], v219 offset:3072
    s_waitcnt vmcnt(8)
    ds_read_b64_tr_b16 a[144:145], v204 offset:12288
    ds_read_b64_tr_b16 a[146:147], v204 offset:13312
    v_mfma_f32_32x32x16_bf16 v[16:31], a[128:131], a[164:167], v[16:31]
    ds_read_b64_tr_b16 a[148:149], v205 offset:12288
    ds_read_b64_tr_b16 a[150:151], v205 offset:13312
    s_add_u32 s32, s55, s78
    s_nop 0
    s_add_u32 m0, s34, 8192
    v_mfma_f32_32x32x16_bf16 v[32:47], a[132:135], a[160:163], v[32:47]
    buffer_load_dwordx4 v208, s[8:11], s32 offen lds
    ds_read_b128 a[172:175], v219 offset:35840
    ds_read_b64_tr_b16 a[152:153], v206 offset:12288
    ds_read_b64_tr_b16 a[154:155], v206 offset:13312
    v_mfma_f32_32x32x16_bf16 v[48:63], a[132:135], a[164:167], v[48:63]
    ds_read_b64_tr_b16 a[156:157], v207 offset:12288
    v_mfma_f32_32x32x16_bf16 v[64:79], a[136:139], a[160:163], v[64:79]
    buffer_load_dwordx4 v209, s[8:11], s32 offen offset:1024 lds
    ds_read_b64_tr_b16 a[158:159], v207 offset:13312
    v_mfma_f32_32x32x16_bf16 v[80:95], a[136:139], a[164:167], v[80:95]
    buffer_load_dwordx4 v210, s[8:11], s32 offen offset:2048 lds
    v_mfma_f32_32x32x16_bf16 v[96:111], a[140:143], a[160:163], v[96:111]
    buffer_load_dwordx4 v211, s[8:11], s32 offen offset:3072 lds
    v_mfma_f32_32x32x16_bf16 v[112:127], a[140:143], a[164:167], v[112:127]
    s_waitcnt lgkmcnt(0)
    v_mfma_f32_32x32x16_bf16 v[0:15], a[144:147], a[168:171], v[0:15]
    ds_read_b128 a[160:163], v215 offset:4096
    s_waitcnt vmcnt(8)
    ds_read_b64_tr_b16 a[128:129], v204 offset:0
    ds_read_b64_tr_b16 a[130:131], v204 offset:1024
    v_mfma_f32_32x32x16_bf16 v[16:31], a[144:147], a[172:175], v[16:31]
    ds_read_b64_tr_b16 a[132:133], v205 offset:0
    ds_read_b64_tr_b16 a[134:135], v205 offset:1024
    s_add_u32 s32, s55, s79
    s_nop 0
    s_add_u32 m0, s34, 12288
    v_mfma_f32_32x32x16_bf16 v[32:47], a[148:151], a[168:171], v[32:47]
    ds_read_b128 a[164:167], v215 offset:36864
    ds_read_b64_tr_b16 a[136:137], v206 offset:0
    ds_read_b64_tr_b16 a[138:139], v206 offset:1024
    s_add_u32 s55, s55, 0x100000
    s_and_b32 s55, s55, 0x3fffff
    v_mfma_f32_32x32x16_bf16 v[48:63], a[148:151], a[172:175], v[48:63]
    buffer_load_dwordx4 v208, s[8:11], s32 offen lds
    ds_read_b64_tr_b16 a[140:141], v207 offset:0
    v_mfma_f32_32x32x16_bf16 v[64:79], a[152:155], a[168:171], v[64:79]
    buffer_load_dwordx4 v209, s[8:11], s32 offen offset:1024 lds
    ds_read_b64_tr_b16 a[142:143], v207 offset:1024
    v_mfma_f32_32x32x16_bf16 v[80:95], a[152:155], a[172:175], v[80:95]
    buffer_load_dwordx4 v210, s[8:11], s32 offen offset:2048 lds
    v_mfma_f32_32x32x16_bf16 v[96:111], a[156:159], a[168:171], v[96:111]
    buffer_load_dwordx4 v211, s[8:11], s32 offen offset:3072 lds
    v_mfma_f32_32x32x16_bf16 v[112:127], a[156:159], a[172:175], v[112:127]
    s_waitcnt lgkmcnt(0)
    v_mfma_f32_32x32x16_bf16 v[0:15], a[128:131], a[160:163], v[0:15]
    ds_read_b128 a[168:171], v219 offset:5120
    s_waitcnt vmcnt(8)
    ds_read_b64_tr_b16 a[144:145], v204 offset:4096
    ds_read_b64_tr_b16 a[146:147], v204 offset:5120
    v_mfma_f32_32x32x16_bf16 v[16:31], a[128:131], a[164:167], v[16:31]
    ds_read_b64_tr_b16 a[148:149], v205 offset:4096
    ds_read_b64_tr_b16 a[150:151], v205 offset:5120
    s_add_u32 s32, s55, s72
    s_add_u32 m0, s34, 0
    v_mfma_f32_32x32x16_bf16 v[32:47], a[132:135], a[160:163], v[32:47]
    buffer_load_dwordx4 v208, s[8:11], s32 offen lds
    ds_read_b128 a[172:175], v219 offset:37888
    ds_read_b64_tr_b16 a[152:153], v206 offset:4096
    ds_read_b64_tr_b16 a[154:155], v206 offset:5120
    v_mfma_f32_32x32x16_bf16 v[48:63], a[132:135], a[164:167], v[48:63]
    ds_read_b64_tr_b16 a[156:157], v207 offset:4096
    v_mfma_f32_32x32x16_bf16 v[64:79], a[136:139], a[160:163], v[64:79]
    buffer_load_dwordx4 v209, s[8:11], s32 offen offset:1024 lds
    ds_read_b64_tr_b16 a[158:159], v207 offset:5120
    v_mfma_f32_32x32x16_bf16 v[80:95], a[136:139], a[164:167], v[80:95]
    buffer_load_dwordx4 v210, s[8:11], s32 offen offset:2048 lds
    v_mfma_f32_32x32x16_bf16 v[96:111], a[140:143], a[160:163], v[96:111]
    buffer_load_dwordx4 v211, s[8:11], s32 offen offset:3072 lds
    v_mfma_f32_32x32x16_bf16 v[112:127], a[140:143], a[164:167], v[112:127]
    s_waitcnt lgkmcnt(0)
    v_mfma_f32_32x32x16_bf16 v[0:15], a[144:147], a[168:171], v[0:15]
    ds_read_b128 a[160:163], v215 offset:6144
    s_waitcnt vmcnt(8)
    ds_read_b64_tr_b16 a[128:129], v204 offset:8192
    ds_read_b64_tr_b16 a[130:131], v204 offset:9216
    v_mfma_f32_32x32x16_bf16 v[16:31], a[144:147], a[172:175], v[16:31]
    ds_read_b64_tr_b16 a[132:133], v205 offset:8192
    ds_read_b64_tr_b16 a[134:135], v205 offset:9216
    s_add_u32 s32, s55, s73
    s_nop 0
    s_add_u32 m0, s34, 4096
    v_mfma_f32_32x32x16_bf16 v[32:47], a[148:151], a[168:171], v[32:47]
    buffer_load_dwordx4 v208, s[8:11], s32 offen lds
    ds_read_b128 a[164:167], v215 offset:38912
    ds_read_b64_tr_b16 a[136:137], v206 offset:8192
    ds_read_b64_tr_b16 a[138:139], v206 offset:9216
    v_mfma_f32_32x32x16_bf16 v[48:63], a[148:151], a[172:175], v[48:63]
    ds_read_b64_tr_b16 a[140:141], v207 offset:8192
    v_mfma_f32_32x32x16_bf16 v[64:79], a[152:155], a[168:171], v[64:79]
    buffer_load_dwordx4 v209, s[8:11], s32 offen offset:1024 lds
    ds_read_b64_tr_b16 a[142:143], v207 offset:9216
    v_mfma_f32_32x32x16_bf16 v[80:95], a[152:155], a[172:175], v[80:95]
    buffer_load_dwordx4 v210, s[8:11], s32 offen offset:2048 lds
    v_mfma_f32_32x32x16_bf16 v[96:111], a[156:159], a[168:171], v[96:111]
    buffer_load_dwordx4 v211, s[8:11], s32 offen offset:3072 lds
    v_mfma_f32_32x32x16_bf16 v[112:127], a[156:159], a[172:175], v[112:127]
    s_waitcnt lgkmcnt(0)
    v_mfma_f32_32x32x16_bf16 v[0:15], a[128:131], a[160:163], v[0:15]
    ds_read_b128 a[168:171], v219 offset:7168
    s_waitcnt vmcnt(8)
    ds_read_b64_tr_b16 a[144:145], v204 offset:12288
    ds_read_b64_tr_b16 a[146:147], v204 offset:13312
    v_mfma_f32_32x32x16_bf16 v[16:31], a[128:131], a[164:167], v[16:31]
    ds_read_b64_tr_b16 a[148:149], v205 offset:12288
    ds_read_b64_tr_b16 a[150:151], v205 offset:13312
    s_add_u32 s32, s55, s74
    s_nop 0
    s_add_u32 m0, s34, 8192
    v_mfma_f32_32x32x16_bf16 v[32:47], a[132:135], a[160:163], v[32:47]
    buffer_load_dwordx4 v208, s[8:11], s32 offen lds
    ds_read_b128 a[172:175], v219 offset:39936
    ds_read_b64_tr_b16 a[152:153], v206 offset:12288
    ds_read_b64_tr_b16 a[154:155], v206 offset:13312
    v_mfma_f32_32x32x16_bf16 v[48:63], a[132:135], a[164:167], v[48:63]
    ds_read_b64_tr_b16 a[156:157], v207 offset:12288
    v_mfma_f32_32x32x16_bf16 v[64:79], a[136:139], a[160:163], v[64:79]
    buffer_load_dwordx4 v209, s[8:11], s32 offen offset:1024 lds
    ds_read_b64_tr_b16 a[158:159], v207 offset:13312
    v_mfma_f32_32x32x16_bf16 v[80:95], a[136:139], a[164:167], v[80:95]
    buffer_load_dwordx4 v210, s[8:11], s32 offen offset:2048 lds
    v_mfma_f32_32x32x16_bf16 v[96:111], a[140:143], a[160:163], v[96:111]
    buffer_load_dwordx4 v211, s[8:11], s32 offen offset:3072 lds
    v_mfma_f32_32x32x16_bf16 v[112:127], a[140:143], a[164:167], v[112:127]
    s_waitcnt lgkmcnt(0)
    v_mfma_f32_32x32x16_bf16 v[0:15], a[144:147], a[168:171], v[0:15]
    s_waitcnt vmcnt(8)
    ds_read_b64_tr_b16 a[128:129], v204 offset:0
    ds_read_b64_tr_b16 a[130:131], v204 offset:1024
    v_mfma_f32_32x32x16_bf16 v[16:31], a[144:147], a[172:175], v[16:31]
    ds_read_b128 a[160:163], v215 offset:8192
    ds_read_b64_tr_b16 a[132:133], v205 offset:0
    ds_read_b64_tr_b16 a[134:135], v205 offset:1024
    s_add_u32 s32, s55, s75
    s_nop 0
    s_add_u32 m0, s34, 12288
    v_mfma_f32_32x32x16_bf16 v[32:47], a[148:151], a[168:171], v[32:47]
    buffer_load_dwordx4 v208, s[8:11], s32 offen lds
    ds_read_b128 a[164:167], v215 offset:40960
    ds_read_b64_tr_b16 a[136:137], v206 offset:0
    ds_read_b64_tr_b16 a[138:139], v206 offset:1024
    v_mfma_f32_32x32x16_bf16 v[48:63], a[148:151], a[172:175], v[48:63]
    ds_read_b64_tr_b16 a[140:141], v207 offset:0
    v_mfma_f32_32x32x16_bf16 v[64:79], a[152:155], a[168:171], v[64:79]
    buffer_load_dwordx4 v209, s[8:11], s32 offen offset:1024 lds
    ds_read_b64_tr_b16 a[142:143], v207 offset:1024
    v_mfma_f32_32x32x16_bf16 v[80:95], a[152:155], a[172:175], v[80:95]
    buffer_load_dwordx4 v210, s[8:11], s32 offen offset:2048 lds
    v_mfma_f32_32x32x16_bf16 v[96:111], a[156:159], a[168:171], v[96:111]
    buffer_load_dwordx4 v211, s[8:11], s32 offen offset:3072 lds
    v_mfma_f32_32x32x16_bf16 v[112:127], a[156:159], a[172:175], v[112:127]
    s_waitcnt lgkmcnt(0)
    v_mfma_f32_32x32x16_bf16 v[0:15], a[128:131], a[160:163], v[0:15]
    ds_read_b128 a[168:171], v219 offset:9216
    s_waitcnt vmcnt(8)
    ds_read_b64_tr_b16 a[144:145], v204 offset:4096
    ds_read_b64_tr_b16 a[146:147], v204 offset:5120
    v_mfma_f32_32x32x16_bf16 v[16:31], a[128:131], a[164:167], v[16:31]
    ds_read_b64_tr_b16 a[148:149], v205 offset:4096
    ds_read_b64_tr_b16 a[150:151], v205 offset:5120
    s_add_u32 s32, s55, s76
    s_add_u32 m0, s34, 0
    v_mfma_f32_32x32x16_bf16 v[32:47], a[132:135], a[160:163], v[32:47]
    buffer_load_dwordx4 v208, s[8:11], s32 offen lds
    ds_read_b128 a[172:175], v219 offset:41984
    ds_read_b64_tr_b16 a[152:153], v206 offset:4096
    ds_read_b64_tr_b16 a[154:155], v206 offset:5120
    v_mfma_f32_32x32x16_bf16 v[48:63], a[132:135], a[164:167], v[48:63]
    ds_read_b64_tr_b16 a[156:157], v207 offset:4096
    v_mfma_f32_32x32x16_bf16 v[64:79], a[136:139], a[160:163], v[64:79]
    buffer_load_dwordx4 v209, s[8:11], s32 offen offset:1024 lds
    ds_read_b64_tr_b16 a[158:159], v207 offset:5120
    v_mfma_f32_32x32x16_bf16 v[80:95], a[136:139], a[164:167], v[80:95]
    buffer_load_dwordx4 v210, s[8:11], s32 offen offset:2048 lds
    v_mfma_f32_32x32x16_bf16 v[96:111], a[140:143], a[160:163], v[96:111]
    buffer_load_dwordx4 v211, s[8:11], s32 offen offset:3072 lds
    v_mfma_f32_32x32x16_bf16 v[112:127], a[140:143], a[164:167], v[112:127]
    s_waitcnt lgkmcnt(0)
    v_mfma_f32_32x32x16_bf16 v[0:15], a[144:147], a[168:171], v[0:15]
    ds_read_b128 a[160:163], v215 offset:10240
    s_waitcnt vmcnt(8)
    ds_read_b64_tr_b16 a[128:129], v204 offset:8192
    ds_read_b64_tr_b16 a[130:131], v204 offset:9216
    v_mfma_f32_32x32x16_bf16 v[16:31], a[144:147], a[172:175], v[16:31]
    ds_read_b64_tr_b16 a[132:133], v205 offset:8192
    ds_read_b64_tr_b16 a[134:135], v205 offset:9216
    s_add_u32 s32, s55, s77
    s_nop 0
    s_add_u32 m0, s34, 4096
    v_mfma_f32_32x32x16_bf16 v[32:47], a[148:151], a[168:171], v[32:47]
    buffer_load_dwordx4 v208, s[8:11], s32 offen lds
    ds_read_b128 a[164:167], v215 offset:43008
    ds_read_b64_tr_b16 a[136:137], v206 offset:8192
    ds_read_b64_tr_b16 a[138:139], v206 offset:9216
    v_mfma_f32_32x32x16_bf16 v[48:63], a[148:151], a[172:175], v[48:63]
    ds_read_b64_tr_b16 a[140:141], v207 offset:8192
    v_mfma_f32_32x32x16_bf16 v[64:79], a[152:155], a[168:171], v[64:79]
    buffer_load_dwordx4 v209, s[8:11], s32 offen offset:1024 lds
    ds_read_b64_tr_b16 a[142:143], v207 offset:9216
    v_mfma_f32_32x32x16_bf16 v[80:95], a[152:155], a[172:175], v[80:95]
    buffer_load_dwordx4 v210, s[8:11], s32 offen offset:2048 lds
    v_mfma_f32_32x32x16_bf16 v[96:111], a[156:159], a[168:171], v[96:111]
    buffer_load_dwordx4 v211, s[8:11], s32 offen offset:3072 lds
    v_mfma_f32_32x32x16_bf16 v[112:127], a[156:159], a[172:175], v[112:127]
    s_waitcnt lgkmcnt(0)
    v_mfma_f32_32x32x16_bf16 v[0:15], a[128:131], a[160:163], v[0:15]
    ds_read_b128 a[168:171], v219 offset:11264
    s_waitcnt vmcnt(8)
    ds_read_b64_tr_b16 a[144:145], v204 offset:12288
    ds_read_b64_tr_b16 a[146:147], v204 offset:13312
    v_mfma_f32_32x32x16_bf16 v[16:31], a[128:131], a[164:167], v[16:31]
    ds_read_b64_tr_b16 a[148:149], v205 offset:12288
    ds_read_b64_tr_b16 a[150:151], v205 offset:13312
    s_add_u32 s32, s55, s78
    s_nop 0
    s_add_u32 m0, s34, 8192
    v_mfma_f32_32x32x16_bf16 v[32:47], a[132:135], a[160:163], v[32:47]
    buffer_load_dwordx4 v208, s[8:11], s32 offen lds
    ds_read_b128 a[172:175], v219 offset:44032
    ds_read_b64_tr_b16 a[152:153], v206 offset:12288
    ds_read_b64_tr_b16 a[154:155], v206 offset:13312
    v_mfma_f32_32x32x16_bf16 v[48:63], a[132:135], a[164:167], v[48:63]
    ds_read_b64_tr_b16 a[156:157], v207 offset:12288
    v_mfma_f32_32x32x16_bf16 v[64:79], a[136:139], a[160:163], v[64:79]
    buffer_load_dwordx4 v209, s[8:11], s32 offen offset:1024 lds
    ds_read_b64_tr_b16 a[158:159], v207 offset:13312
    v_mfma_f32_32x32x16_bf16 v[80:95], a[136:139], a[164:167], v[80:95]
    buffer_load_dwordx4 v210, s[8:11], s32 offen offset:2048 lds
    v_mfma_f32_32x32x16_bf16 v[96:111], a[140:143], a[160:163], v[96:111]
    buffer_load_dwordx4 v211, s[8:11], s32 offen offset:3072 lds
    v_mfma_f32_32x32x16_bf16 v[112:127], a[140:143], a[164:167], v[112:127]
    s_waitcnt lgkmcnt(0)
    v_mfma_f32_32x32x16_bf16 v[0:15], a[144:147], a[168:171], v[0:15]
    ds_read_b128 a[160:163], v215 offset:12288
    s_waitcnt vmcnt(8)
    ds_read_b64_tr_b16 a[128:129], v204 offset:0
    ds_read_b64_tr_b16 a[130:131], v204 offset:1024
    v_mfma_f32_32x32x16_bf16 v[16:31], a[144:147], a[172:175], v[16:31]
    ds_read_b64_tr_b16 a[132:133], v205 offset:0
    ds_read_b64_tr_b16 a[134:135], v205 offset:1024
    s_add_u32 s32, s55, s79
    s_nop 0
    s_add_u32 m0, s34, 12288
    v_mfma_f32_32x32x16_bf16 v[32:47], a[148:151], a[168:171], v[32:47]
    ds_read_b128 a[164:167], v215 offset:45056
    ds_read_b64_tr_b16 a[136:137], v206 offset:0
    ds_read_b64_tr_b16 a[138:139], v206 offset:1024
    s_add_u32 s55, s55, 0x100000
    s_and_b32 s55, s55, 0x3fffff
    v_mfma_f32_32x32x16_bf16 v[48:63], a[148:151], a[172:175], v[48:63]
    buffer_load_dwordx4 v208, s[8:11], s32 offen lds
    ds_read_b64_tr_b16 a[140:141], v207 offset:0
    v_mfma_f32_32x32x16_bf16 v[64:79], a[152:155], a[168:171], v[64:79]
    buffer_load_dwordx4 v209, s[8:11], s32 offen offset:1024 lds
    ds_read_b64_tr_b16 a[142:143], v207 offset:1024
    v_mfma_f32_32x32x16_bf16 v[80:95], a[152:155], a[172:175], v[80:95]
    buffer_load_dwordx4 v210, s[8:11], s32 offen offset:2048 lds
    v_mfma_f32_32x32x16_bf16 v[96:111], a[156:159], a[168:171], v[96:111]
    buffer_load_dwordx4 v211, s[8:11], s32 offen offset:3072 lds
    v_mfma_f32_32x32x16_bf16 v[112:127], a[156:159], a[172:175], v[112:127]
    s_waitcnt lgkmcnt(0)
    v_mfma_f32_32x32x16_bf16 v[0:15], a[128:131], a[160:163], v[0:15]
    ds_read_b128 a[168:171], v219 offset:13312
    s_waitcnt vmcnt(8)
    ds_read_b64_tr_b16 a[144:145], v204 offset:4096
    ds_read_b64_tr_b16 a[146:147], v204 offset:5120
    v_mfma_f32_32x32x16_bf16 v[16:31], a[128:131], a[164:167], v[16:31]
    ds_read_b64_tr_b16 a[148:149], v205 offset:4096
    ds_read_b64_tr_b16 a[150:151], v205 offset:5120
    s_add_u32 s32, s55, s72
    s_add_u32 m0, s34, 0
    v_mfma_f32_32x32x16_bf16 v[32:47], a[132:135], a[160:163], v[32:47]
    buffer_load_dwordx4 v208, s[8:11], s32 offen lds
    ds_read_b128 a[172:175], v219 offset:46080
    ds_read_b64_tr_b16 a[152:153], v206 offset:4096
    ds_read_b64_tr_b16 a[154:155], v206 offset:5120
    v_mfma_f32_32x32x16_bf16 v[48:63], a[132:135], a[164:167], v[48:63]
    ds_read_b64_tr_b16 a[156:157], v207 offset:4096
    v_mfma_f32_32x32x16_bf16 v[64:79], a[136:139], a[160:163], v[64:79]
    buffer_load_dwordx4 v209, s[8:11], s32 offen offset:1024 lds
    ds_read_b64_tr_b16 a[158:159], v207 offset:5120
    v_mfma_f32_32x32x16_bf16 v[80:95], a[136:139], a[164:167], v[80:95]
    buffer_load_dwordx4 v210, s[8:11], s32 offen offset:2048 lds
    v_mfma_f32_32x32x16_bf16 v[96:111], a[140:143], a[160:163], v[96:111]
    buffer_load_dwordx4 v211, s[8:11], s32 offen offset:3072 lds
    v_mfma_f32_32x32x16_bf16 v[112:127], a[140:143], a[164:167], v[112:127]
    s_waitcnt lgkmcnt(0)
    v_mfma_f32_32x32x16_bf16 v[0:15], a[144:147], a[168:171], v[0:15]
    ds_read_b128 a[160:163], v215 offset:14336
    s_waitcnt vmcnt(8)
    ds_read_b64_tr_b16 a[128:129], v204 offset:8192
    ds_read_b64_tr_b16 a[130:131], v204 offset:9216
    v_mfma_f32_32x32x16_bf16 v[16:31], a[144:147], a[172:175], v[16:31]
    ds_read_b64_tr_b16 a[132:133], v205 offset:8192
    ds_read_b64_tr_b16 a[134:135], v205 offset:9216
    s_add_u32 s32, s55, s73
    s_nop 0
    s_add_u32 m0, s34, 4096
    v_mfma_f32_32x32x16_bf16 v[32:47], a[148:151], a[168:171], v[32:47]
    buffer_load_dwordx4 v208, s[8:11], s32 offen lds
    ds_read_b128 a[164:167], v215 offset:47104
    ds_read_b64_tr_b16 a[136:137], v206 offset:8192
    ds_read_b64_tr_b16 a[138:139], v206 offset:9216
    v_mfma_f32_32x32x16_bf16 v[48:63], a[148:151], a[172:175], v[48:63]
    ds_read_b64_tr_b16 a[140:141], v207 offset:8192
    v_mfma_f32_32x32x16_bf16 v[64:79], a[152:155], a[168:171], v[64:79]
    buffer_load_dwordx4 v209, s[8:11], s32 offen offset:1024 lds
    ds_read_b64_tr_b16 a[142:143], v207 offset:9216
    v_mfma_f32_32x32x16_bf16 v[80:95], a[152:155], a[172:175], v[80:95]
    buffer_load_dwordx4 v210, s[8:11], s32 offen offset:2048 lds
    v_mfma_f32_32x32x16_bf16 v[96:111], a[156:159], a[168:171], v[96:111]
    buffer_load_dwordx4 v211, s[8:11], s32 offen offset:3072 lds
    v_mfma_f32_32x32x16_bf16 v[112:127], a[156:159], a[172:175], v[112:127]
    s_waitcnt lgkmcnt(0)
    v_mfma_f32_32x32x16_bf16 v[0:15], a[128:131], a[160:163], v[0:15]
    ds_read_b128 a[168:171], v219 offset:15360
    s_waitcnt vmcnt(8)
    ds_read_b64_tr_b16 a[144:145], v204 offset:12288
    ds_read_b64_tr_b16 a[146:147], v204 offset:13312
    v_mfma_f32_32x32x16_bf16 v[16:31], a[128:131], a[164:167], v[16:31]
    ds_read_b64_tr_b16 a[148:149], v205 offset:12288
    ds_read_b64_tr_b16 a[150:151], v205 offset:13312
    s_add_u32 s32, s55, s74
    s_nop 0
    s_add_u32 m0, s34, 8192
    v_mfma_f32_32x32x16_bf16 v[32:47], a[132:135], a[160:163], v[32:47]
    buffer_load_dwordx4 v208, s[8:11], s32 offen lds
    ds_read_b128 a[172:175], v219 offset:48128
    ds_read_b64_tr_b16 a[152:153], v206 offset:12288
    ds_read_b64_tr_b16 a[154:155], v206 offset:13312
    v_mfma_f32_32x32x16_bf16 v[48:63], a[132:135], a[164:167], v[48:63]
    ds_read_b64_tr_b16 a[156:157], v207 offset:12288
    v_mfma_f32_32x32x16_bf16 v[64:79], a[136:139], a[160:163], v[64:79]
    buffer_load_dwordx4 v209, s[8:11], s32 offen offset:1024 lds
    ds_read_b64_tr_b16 a[158:159], v207 offset:13312
    v_mfma_f32_32x32x16_bf16 v[80:95], a[136:139], a[164:167], v[80:95]
    buffer_load_dwordx4 v210, s[8:11], s32 offen offset:2048 lds
    v_mfma_f32_32x32x16_bf16 v[96:111], a[140:143], a[160:163], v[96:111]
    buffer_load_dwordx4 v211, s[8:11], s32 offen offset:3072 lds
    v_mfma_f32_32x32x16_bf16 v[112:127], a[140:143], a[164:167], v[112:127]
    s_waitcnt lgkmcnt(0)
    v_mfma_f32_32x32x16_bf16 v[0:15], a[144:147], a[168:171], v[0:15]
    s_waitcnt vmcnt(8)
    ds_read_b64_tr_b16 a[128:129], v204 offset:0
    ds_read_b64_tr_b16 a[130:131], v204 offset:1024
    v_mfma_f32_32x32x16_bf16 v[16:31], a[144:147], a[172:175], v[16:31]
    ds_read_b128 a[160:163], v215 offset:16384
    ds_read_b64_tr_b16 a[132:133], v205 offset:0
    ds_read_b64_tr_b16 a[134:135], v205 offset:1024
    s_add_u32 s32, s55, s75
    s_nop 0
    s_add_u32 m0, s34, 12288
    v_mfma_f32_32x32x16_bf16 v[32:47], a[148:151], a[168:171], v[32:47]
    buffer_load_dwordx4 v208, s[8:11], s32 offen lds
    ds_read_b128 a[164:167], v215 offset:49152
    ds_read_b64_tr_b16 a[136:137], v206 offset:0
    ds_read_b64_tr_b16 a[138:139], v206 offset:1024
    v_mfma_f32_32x32x16_bf16 v[48:63], a[148:151], a[172:175], v[48:63]
    ds_read_b64_tr_b16 a[140:141], v207 offset:0
    v_mfma_f32_32x32x16_bf16 v[64:79], a[152:155], a[168:171], v[64:79]
    buffer_load_dwordx4 v209, s[8:11], s32 offen offset:1024 lds
    ds_read_b64_tr_b16 a[142:143], v207 offset:1024
    v_mfma_f32_32x32x16_bf16 v[80:95], a[152:155], a[172:175], v[80:95]
    buffer_load_dwordx4 v210, s[8:11], s32 offen offset:2048 lds
    v_mfma_f32_32x32x16_bf16 v[96:111], a[156:159], a[168:171], v[96:111]
    buffer_load_dwordx4 v211, s[8:11], s32 offen offset:3072 lds
    v_mfma_f32_32x32x16_bf16 v[112:127], a[156:159], a[172:175], v[112:127]
    s_waitcnt lgkmcnt(0)
    v_mfma_f32_32x32x16_bf16 v[0:15], a[128:131], a[160:163], v[0:15]
    ds_read_b128 a[168:171], v219 offset:17408
    s_waitcnt vmcnt(8)
    ds_read_b64_tr_b16 a[144:145], v204 offset:4096
    ds_read_b64_tr_b16 a[146:147], v204 offset:5120
    v_mfma_f32_32x32x16_bf16 v[16:31], a[128:131], a[164:167], v[16:31]
    ds_read_b64_tr_b16 a[148:149], v205 offset:4096
    ds_read_b64_tr_b16 a[150:151], v205 offset:5120
    s_add_u32 s32, s55, s76
    s_add_u32 m0, s34, 0
    v_mfma_f32_32x32x16_bf16 v[32:47], a[132:135], a[160:163], v[32:47]
    buffer_load_dwordx4 v208, s[8:11], s32 offen lds
    ds_read_b128 a[172:175], v219 offset:50176
    ds_read_b64_tr_b16 a[152:153], v206 offset:4096
    ds_read_b64_tr_b16 a[154:155], v206 offset:5120
    v_mfma_f32_32x32x16_bf16 v[48:63], a[132:135], a[164:167], v[48:63]
    ds_read_b64_tr_b16 a[156:157], v207 offset:4096
    v_mfma_f32_32x32x16_bf16 v[64:79], a[136:139], a[160:163], v[64:79]
    buffer_load_dwordx4 v209, s[8:11], s32 offen offset:1024 lds
    ds_read_b64_tr_b16 a[158:159], v207 offset:5120
    v_mfma_f32_32x32x16_bf16 v[80:95], a[136:139], a[164:167], v[80:95]
    buffer_load_dwordx4 v210, s[8:11], s32 offen offset:2048 lds
    v_mfma_f32_32x32x16_bf16 v[96:111], a[140:143], a[160:163], v[96:111]
    buffer_load_dwordx4 v211, s[8:11], s32 offen offset:3072 lds
    v_mfma_f32_32x32x16_bf16 v[112:127], a[140:143], a[164:167], v[112:127]
    s_waitcnt lgkmcnt(0)
    v_mfma_f32_32x32x16_bf16 v[0:15], a[144:147], a[168:171], v[0:15]
    ds_read_b128 a[160:163], v215 offset:18432
    s_waitcnt vmcnt(8)
    ds_read_b64_tr_b16 a[128:129], v204 offset:8192
    ds_read_b64_tr_b16 a[130:131], v204 offset:9216
    v_mfma_f32_32x32x16_bf16 v[16:31], a[144:147], a[172:175], v[16:31]
    ds_read_b64_tr_b16 a[132:133], v205 offset:8192
    ds_read_b64_tr_b16 a[134:135], v205 offset:9216
    s_add_u32 s32, s55, s77
    s_nop 0
    s_add_u32 m0, s34, 4096
    v_mfma_f32_32x32x16_bf16 v[32:47], a[148:151], a[168:171], v[32:47]
    buffer_load_dwordx4 v208, s[8:11], s32 offen lds
    ds_read_b128 a[164:167], v215 offset:51200
    ds_read_b64_tr_b16 a[136:137], v206 offset:8192
    ds_read_b64_tr_b16 a[138:139], v206 offset:9216
    v_mfma_f32_32x32x16_bf16 v[48:63], a[148:151], a[172:175], v[48:63]
    ds_read_b64_tr_b16 a[140:141], v207 offset:8192
    v_mfma_f32_32x32x16_bf16 v[64:79], a[152:155], a[168:171], v[64:79]
    buffer_load_dwordx4 v209, s[8:11], s32 offen offset:1024 lds
    ds_read_b64_tr_b16 a[142:143], v207 offset:9216
    v_mfma_f32_32x32x16_bf16 v[80:95], a[152:155], a[172:175], v[80:95]
    buffer_load_dwordx4 v210, s[8:11], s32 offen offset:2048 lds
    v_mfma_f32_32x32x16_bf16 v[96:111], a[156:159], a[168:171], v[96:111]
    buffer_load_dwordx4 v211, s[8:11], s32 offen offset:3072 lds
    v_mfma_f32_32x32x16_bf16 v[112:127], a[156:159], a[172:175], v[112:127]
    s_waitcnt lgkmcnt(0)
    v_mfma_f32_32x32x16_bf16 v[0:15], a[128:131], a[160:163], v[0:15]
    ds_read_b128 a[168:171], v219 offset:19456
    s_waitcnt vmcnt(8)
    ds_read_b64_tr_b16 a[144:145], v204 offset:12288
    ds_read_b64_tr_b16 a[146:147], v204 offset:13312
    v_mfma_f32_32x32x16_bf16 v[16:31], a[128:131], a[164:167], v[16:31]
    ds_read_b64_tr_b16 a[148:149], v205 offset:12288
    ds_read_b64_tr_b16 a[150:151], v205 offset:13312
    s_add_u32 s32, s55, s78
    s_nop 0
    s_add_u32 m0, s34, 8192
    v_mfma_f32_32x32x16_bf16 v[32:47], a[132:135], a[160:163], v[32:47]
    buffer_load_dwordx4 v208, s[8:11], s32 offen lds
    ds_read_b128 a[172:175], v219 offset:52224
    ds_read_b64_tr_b16 a[152:153], v206 offset:12288
    ds_read_b64_tr_b16 a[154:155], v206 offset:13312
    v_mfma_f32_32x32x16_bf16 v[48:63], a[132:135], a[164:167], v[48:63]
    ds_read_b64_tr_b16 a[156:157], v207 offset:12288
    v_mfma_f32_32x32x16_bf16 v[64:79], a[136:139], a[160:163], v[64:79]
    buffer_load_dwordx4 v209, s[8:11], s32 offen offset:1024 lds
    ds_read_b64_tr_b16 a[158:159], v207 offset:13312
    v_mfma_f32_32x32x16_bf16 v[80:95], a[136:139], a[164:167], v[80:95]
    buffer_load_dwordx4 v210, s[8:11], s32 offen offset:2048 lds
    v_mfma_f32_32x32x16_bf16 v[96:111], a[140:143], a[160:163], v[96:111]
    buffer_load_dwordx4 v211, s[8:11], s32 offen offset:3072 lds
    v_mfma_f32_32x32x16_bf16 v[112:127], a[140:143], a[164:167], v[112:127]
    s_waitcnt lgkmcnt(0)
    v_mfma_f32_32x32x16_bf16 v[0:15], a[144:147], a[168:171], v[0:15]
    ds_read_b128 a[160:163], v215 offset:20480
    s_waitcnt vmcnt(8)
    ds_read_b64_tr_b16 a[128:129], v204 offset:0
    ds_read_b64_tr_b16 a[130:131], v204 offset:1024
    v_mfma_f32_32x32x16_bf16 v[16:31], a[144:147], a[172:175], v[16:31]
    ds_read_b64_tr_b16 a[132:133], v205 offset:0
    ds_read_b64_tr_b16 a[134:135], v205 offset:1024
    s_add_u32 s32, s55, s79
    s_nop 0
    s_add_u32 m0, s34, 12288
    v_mfma_f32_32x32x16_bf16 v[32:47], a[148:151], a[168:171], v[32:47]
    ds_read_b128 a[164:167], v215 offset:53248
    ds_read_b64_tr_b16 a[136:137], v206 offset:0
STUB2:
    s_cbranch_execz STUB6
    s_nop 0
    ds_read_b64_tr_b16 a[138:139], v206 offset:1024
    s_add_u32 s55, s55, 0x100000
    s_and_b32 s55, s55, 0x3fffff
    v_mfma_f32_32x32x16_bf16 v[48:63], a[148:151], a[172:175], v[48:63]
    buffer_load_dwordx4 v208, s[8:11], s32 offen lds
    ds_read_b64_tr_b16 a[140:141], v207 offset:0
    v_mfma_f32_32x32x16_bf16 v[64:79], a[152:155], a[168:171], v[64:79]
    buffer_load_dwordx4 v209, s[8:11], s32 offen offset:1024 lds
    ds_read_b64_tr_b16 a[142:143], v207 offset:1024
    v_mfma_f32_32x32x16_bf16 v[80:95], a[152:155], a[172:175], v[80:95]
    buffer_load_dwordx4 v210, s[8:11], s32 offen offset:2048 lds
    v_mfma_f32_32x32x16_bf16 v[96:111], a[156:159], a[168:171], v[96:111]
    buffer_load_dwordx4 v211, s[8:11], s32 offen offset:3072 lds
    v_mfma_f32_32x32x16_bf16 v[112:127], a[156:159], a[172:175], v[112:127]
    s_waitcnt lgkmcnt(0)
    v_mfma_f32_32x32x16_bf16 v[0:15], a[128:131], a[160:163], v[0:15]
    ds_read_b128 a[168:171], v219 offset:21504
    s_waitcnt vmcnt(8)
    ds_read_b64_tr_b16 a[144:145], v204 offset:4096
    ds_read_b64_tr_b16 a[146:147], v204 offset:5120
    v_mfma_f32_32x32x16_bf16 v[16:31], a[128:131], a[164:167], v[16:31]
    ds_read_b64_tr_b16 a[148:149], v205 offset:4096
    ds_read_b64_tr_b16 a[150:151], v205 offset:5120
    s_add_u32 s32, s55, s72
    s_add_u32 m0, s34, 0
    v_mfma_f32_32x32x16_bf16 v[32:47], a[132:135], a[160:163], v[32:47]
    buffer_load_dwordx4 v208, s[8:11], s32 offen lds
    ds_read_b128 a[172:175], v219 offset:54272
    ds_read_b64_tr_b16 a[152:153], v206 offset:4096
    ds_read_b64_tr_b16 a[154:155], v206 offset:5120
    v_mfma_f32_32x32x16_bf16 v[48:63], a[132:135], a[164:167], v[48:63]
    ds_read_b64_tr_b16 a[156:157], v207 offset:4096
    v_mfma_f32_32x32x16_bf16 v[64:79], a[136:139], a[160:163], v[64:79]
    buffer_load_dwordx4 v209, s[8:11], s32 offen offset:1024 lds
    ds_read_b64_tr_b16 a[158:159], v207 offset:5120
    v_mfma_f32_32x32x16_bf16 v[80:95], a[136:139], a[164:167], v[80:95]
    buffer_load_dwordx4 v210, s[8:11], s32 offen offset:2048 lds
    v_mfma_f32_32x32x16_bf16 v[96:111], a[140:143], a[160:163], v[96:111]
    buffer_load_dwordx4 v211, s[8:11], s32 offen offset:3072 lds
    v_mfma_f32_32x32x16_bf16 v[112:127], a[140:143], a[164:167], v[112:127]
    s_waitcnt lgkmcnt(0)
    v_mfma_f32_32x32x16_bf16 v[0:15], a[144:147], a[168:171], v[0:15]
    ds_read_b128 a[160:163], v215 offset:22528
    s_waitcnt vmcnt(8)
    ds_read_b64_tr_b16 a[128:129], v204 offset:8192
    ds_read_b64_tr_b16 a[130:131], v204 offset:9216
    v_mfma_f32_32x32x16_bf16 v[16:31], a[144:147], a[172:175], v[16:31]
    ds_read_b64_tr_b16 a[132:133], v205 offset:8192
    ds_read_b64_tr_b16 a[134:135], v205 offset:9216
    s_add_u32 s32, s55, s73
    s_nop 0
    s_add_u32 m0, s34, 4096
    v_mfma_f32_32x32x16_bf16 v[32:47], a[148:151], a[168:171], v[32:47]
    buffer_load_dwordx4 v208, s[8:11], s32 offen lds
    ds_read_b128 a[164:167], v215 offset:55296
    ds_read_b64_tr_b16 a[136:137], v206 offset:8192
    ds_read_b64_tr_b16 a[138:139], v206 offset:9216
    v_mfma_f32_32x32x16_bf16 v[48:63], a[148:151], a[172:175], v[48:63]
    ds_read_b64_tr_b16 a[140:141], v207 offset:8192
    v_mfma_f32_32x32x16_bf16 v[64:79], a[152:155], a[168:171], v[64:79]
    buffer_load_dwordx4 v209, s[8:11], s32 offen offset:1024 lds
    ds_read_b64_tr_b16 a[142:143], v207 offset:9216
    v_mfma_f32_32x32x16_bf16 v[80:95], a[152:155], a[172:175], v[80:95]
    buffer_load_dwordx4 v210, s[8:11], s32 offen offset:2048 lds
    v_mfma_f32_32x32x16_bf16 v[96:111], a[156:159], a[168:171], v[96:111]
    buffer_load_dwordx4 v211, s[8:11], s32 offen offset:3072 lds
    v_mfma_f32_32x32x16_bf16 v[112:127], a[156:159], a[172:175], v[112:127]
    s_waitcnt lgkmcnt(0)
    v_mfma_f32_32x32x16_bf16 v[0:15], a[128:131], a[160:163], v[0:15]
    ds_read_b128 a[168:171], v219 offset:23552
    s_waitcnt vmcnt(8)
    ds_read_b64_tr_b16 a[144:145], v204 offset:12288
    ds_read_b64_tr_b16 a[146:147], v204 offset:13312
    v_mfma_f32_32x32x16_bf16 v[16:31], a[128:131], a[164:167], v[16:31]
    ds_read_b64_tr_b16 a[148:149], v205 offset:12288
    ds_read_b64_tr_b16 a[150:151], v205 offset:13312
    s_add_u32 s32, s55, s74
    s_nop 0
    s_add_u32 m0, s34, 8192
    v_mfma_f32_32x32x16_bf16 v[32:47], a[132:135], a[160:163], v[32:47]
    buffer_load_dwordx4 v208, s[8:11], s32 offen lds
    ds_read_b128 a[172:175], v219 offset:56320
    ds_read_b64_tr_b16 a[152:153], v206 offset:12288
    ds_read_b64_tr_b16 a[154:155], v206 offset:13312
    v_mfma_f32_32x32x16_bf16 v[48:63], a[132:135], a[164:167], v[48:63]
    ds_read_b64_tr_b16 a[156:157], v207 offset:12288
    v_mfma_f32_32x32x16_bf16 v[64:79], a[136:139], a[160:163], v[64:79]
    buffer_load_dwordx4 v209, s[8:11], s32 offen offset:1024 lds
    ds_read_b64_tr_b16 a[158:159], v207 offset:13312
    v_mfma_f32_32x32x16_bf16 v[80:95], a[136:139], a[164:167], v[80:95]
    buffer_load_dwordx4 v210, s[8:11], s32 offen offset:2048 lds
    v_mfma_f32_32x32x16_bf16 v[96:111], a[140:143], a[160:163], v[96:111]
    buffer_load_dwordx4 v211, s[8:11], s32 offen offset:3072 lds
    v_mfma_f32_32x32x16_bf16 v[112:127], a[140:143], a[164:167], v[112:127]
    s_waitcnt lgkmcnt(0)
    v_mfma_f32_32x32x16_bf16 v[0:15], a[144:147], a[168:171], v[0:15]
    s_waitcnt vmcnt(8)
    ds_read_b64_tr_b16 a[128:129], v204 offset:0
    ds_read_b64_tr_b16 a[130:131], v204 offset:1024
    v_mfma_f32_32x32x16_bf16 v[16:31], a[144:147], a[172:175], v[16:31]
    ds_read_b128 a[160:163], v215 offset:24576
    ds_read_b64_tr_b16 a[132:133], v205 offset:0
    ds_read_b64_tr_b16 a[134:135], v205 offset:1024
    s_add_u32 s32, s55, s75
    s_nop 0
    s_add_u32 m0, s34, 12288
    v_mfma_f32_32x32x16_bf16 v[32:47], a[148:151], a[168:171], v[32:47]
    buffer_load_dwordx4 v208, s[8:11], s32 offen lds
    ds_read_b128 a[164:167], v215 offset:57344
    ds_read_b64_tr_b16 a[136:137], v206 offset:0
    ds_read_b64_tr_b16 a[138:139], v206 offset:1024
    v_mfma_f32_32x32x16_bf16 v[48:63], a[148:151], a[172:175], v[48:63]
    ds_read_b64_tr_b16 a[140:141], v207 offset:0
    v_mfma_f32_32x32x16_bf16 v[64:79], a[152:155], a[168:171], v[64:79]
    buffer_load_dwordx4 v209, s[8:11], s32 offen offset:1024 lds
    ds_read_b64_tr_b16 a[142:143], v207 offset:1024
    v_mfma_f32_32x32x16_bf16 v[80:95], a[152:155], a[172:175], v[80:95]
    buffer_load_dwordx4 v210, s[8:11], s32 offen offset:2048 lds
    v_mfma_f32_32x32x16_bf16 v[96:111], a[156:159], a[168:171], v[96:111]
    buffer_load_dwordx4 v211, s[8:11], s32 offen offset:3072 lds
    v_mfma_f32_32x32x16_bf16 v[112:127], a[156:159], a[172:175], v[112:127]
    s_waitcnt lgkmcnt(0)
    v_mfma_f32_32x32x16_bf16 v[0:15], a[128:131], a[160:163], v[0:15]
    s_mov_b32 s16, s42
    s_and_b32 s17, s43, 0xffff
    s_mov_b32 s18, 0x400000
    s_mov_b32 s19, 0x20000
    s_waitcnt vmcnt(8)
    s_nop 0
    ds_read_b64_tr_b16 a[144:145], v204 offset:4096
    v_mfma_f32_32x32x16_bf16 v[16:31], a[128:131], a[164:167], v[16:31]
    ds_read_b128 a[168:171], v219 offset:25600
    ds_read_b64_tr_b16 a[146:147], v204 offset:5120
    ds_read_b64_tr_b16 a[148:149], v205 offset:4096
    ds_read_b64_tr_b16 a[150:151], v205 offset:5120
    v_mfma_f32_32x32x16_bf16 v[32:47], a[132:135], a[160:163], v[32:47]
    ds_read_b128 a[172:175], v219 offset:58368
    ds_read_b64_tr_b16 a[152:153], v206 offset:4096
    ds_read_b64_tr_b16 a[154:155], v206 offset:5120
    s_add_u32 s32, s55, s76
    s_add_u32 m0, s34, 0
    v_mfma_f32_32x32x16_bf16 v[48:63], a[132:135], a[164:167], v[48:63]
    ds_read_b64_tr_b16 a[156:157], v207 offset:4096
    s_mov_b32 s40, s64
    s_nop 0
    s_and_b32 s41, s65, 0xffff
    s_mov_b32 s42, 0x1c0000
    s_mov_b32 s43, 0x20000
    v_mfma_f32_32x32x16_bf16 v[64:79], a[136:139], a[160:163], v[64:79]
    buffer_load_dwordx4 v208, s[8:11], s32 offen lds
    buffer_load_dwordx4 v209, s[8:11], s32 offen offset:1024 lds
    ds_read_b64_tr_b16 a[158:159], v207 offset:5120
    v_mfma_f32_32x32x16_bf16 v[80:95], a[136:139], a[164:167], v[80:95]
    s_mov_b32 s44, s66
    s_and_b32 s45, s67, 0xffff
    s_mov_b32 s46, 0x1c0000
    s_mov_b32 s47, 0x20000
    v_mfma_f32_32x32x16_bf16 v[96:111], a[140:143], a[160:163], v[96:111]
    buffer_load_dwordx4 v210, s[8:11], s32 offen offset:2048 lds
    s_lshr_b32 s66, s2, 3
    s_lshl_b32 s66, s66, 2
    s_add_u32 s66, s66, s28
    v_mfma_f32_32x32x16_bf16 v[112:127], a[140:143], a[164:167], v[112:127]
    buffer_load_dwordx4 v211, s[8:11], s32 offen offset:3072 lds
    s_waitcnt lgkmcnt(0)
    v_mfma_f32_32x32x16_bf16 v[0:15], a[144:147], a[168:171], v[0:15]
    ds_read_b128 a[160:163], v215 offset:26624
    s_waitcnt vmcnt(8)
    ds_read_b64_tr_b16 a[128:129], v204 offset:8192
    ds_read_b64_tr_b16 a[130:131], v204 offset:9216
    v_mfma_f32_32x32x16_bf16 v[16:31], a[144:147], a[172:175], v[16:31]
    ds_read_b64_tr_b16 a[132:133], v205 offset:8192
    ds_read_b64_tr_b16 a[134:135], v205 offset:9216
    s_mul_i32 s64, s66, 14336
    s_and_b32 s3, s2, 3
    s_lshl_b32 s67, s3, 9
    v_mfma_f32_32x32x16_bf16 v[32:47], a[148:151], a[168:171], v[32:47]
    ds_read_b128 a[164:167], v215 offset:59392
    ds_read_b64_tr_b16 a[136:137], v206 offset:8192
    ds_read_b64_tr_b16 a[138:139], v206 offset:9216
    s_add_u32 s32, s55, s77
    s_add_u32 m0, s34, 4096
    v_mfma_f32_32x32x16_bf16 v[48:63], a[148:151], a[172:175], v[48:63]
    buffer_load_dwordx4 v208, s[8:11], s32 offen lds
    ds_read_b64_tr_b16 a[140:141], v207 offset:8192
    s_add_u32 s64, s64, s67
    s_mul_i32 s65, s66, 14336
    v_mfma_f32_32x32x16_bf16 v[64:79], a[152:155], a[168:171], v[64:79]
    buffer_load_dwordx4 v209, s[8:11], s32 offen offset:1024 lds
    ds_read_b64_tr_b16 a[142:143], v207 offset:9216
    s_lshl_b32 s3, s3, 7
    s_sub_u32 s3, 1536, s3
    v_mfma_f32_32x32x16_bf16 v[80:95], a[152:155], a[172:175], v[80:95]
    buffer_load_dwordx4 v210, s[8:11], s32 offen offset:2048 lds
    s_and_b32 s67, s2, 1
    s_mul_i32 s67, s67, 512
    s_add_u32 s65, s65, s67
    v_mfma_f32_32x32x16_bf16 v[96:111], a[156:159], a[168:171], v[96:111]
    buffer_load_dwordx4 v211, s[8:11], s32 offen offset:3072 lds
    v_mfma_f32_32x32x16_bf16 v[112:127], a[156:159], a[172:175], v[112:127]
    s_lshl_b32 s66, s50, 14
    s_lshl_b32 s67, s29, 19
    s_add_u32 s66, s66, s67
    s_waitcnt lgkmcnt(0)
    v_mfma_f32_32x32x16_bf16 v[0:15], a[128:131], a[160:163], v[0:15]
    ds_read_b128 a[168:171], v219 offset:27648
    s_waitcnt vmcnt(8)
    ds_read_b64_tr_b16 a[144:145], v204 offset:12288
    ds_read_b64_tr_b16 a[146:147], v204 offset:13312
    v_mfma_f32_32x32x16_bf16 v[16:31], a[128:131], a[164:167], v[16:31]
    ds_read_b64_tr_b16 a[148:149], v205 offset:12288
    ds_read_b64_tr_b16 a[150:151], v205 offset:13312
    s_add_u32 s32, s55, s78
    s_add_u32 m0, s34, 8192
    s_lshl_b32 s67, s28, 13
    s_add_u32 s66, s66, s67
    s_nop 0
    v_mfma_f32_32x32x16_bf16 v[32:47], a[132:135], a[160:163], v[32:47]
    buffer_load_dwordx4 v208, s[8:11], s32 offen lds
    ds_read_b128 a[172:175], v219 offset:60416
    ds_read_b64_tr_b16 a[152:153], v206 offset:12288
    ds_read_b64_tr_b16 a[154:155], v206 offset:13312
    v_mfma_f32_32x32x16_bf16 v[48:63], a[132:135], a[164:167], v[48:63]
    ds_read_b64_tr_b16 a[156:157], v207 offset:12288
    v_min_u32_e64 v233, 55, v220
    v_mfma_f32_32x32x16_bf16 v[64:79], a[136:139], a[160:163], v[64:79]
    buffer_load_dwordx4 v209, s[8:11], s32 offen offset:1024 lds
    ds_read_b64_tr_b16 a[158:159], v207 offset:13312
    v_mfma_f32_32x32x16_bf16 v[80:95], a[136:139], a[164:167], v[80:95]
    buffer_load_dwordx4 v210, s[8:11], s32 offen offset:2048 lds
    v_lshlrev_b32_e64 v233, 4, v233
    v_mfma_f32_32x32x16_bf16 v[96:111], a[140:143], a[160:163], v[96:111]
    buffer_load_dwordx4 v211, s[8:11], s32 offen offset:3072 lds
    v_mfma_f32_32x32x16_bf16 v[112:127], a[140:143], a[164:167], v[112:127]
    v_mad_u32_u24 v233, v226, s3, v233
    s_waitcnt lgkmcnt(0)
    v_mfma_f32_32x32x16_bf16 v[0:15], a[144:147], a[168:171], v[0:15]
    ds_read_b128 a[160:163], v215 offset:28672
    s_waitcnt vmcnt(8)
    ds_read_b64_tr_b16 a[128:129], v204 offset:0
    ds_read_b64_tr_b16 a[130:131], v204 offset:1024
    v_lshrrev_b32_e64 v234, 5, v220
    v_mfma_f32_32x32x16_bf16 v[16:31], a[144:147], a[172:175], v[16:31]
    ds_read_b64_tr_b16 a[132:133], v205 offset:0
    ds_read_b64_tr_b16 a[134:135], v205 offset:1024
    s_add_u32 s32, s55, s79
    s_nop 0
    s_add_u32 m0, s34, 12288
    v_mfma_f32_32x32x16_bf16 v[32:47], a[148:151], a[168:171], v[32:47]
    ds_read_b128 a[164:167], v215 offset:61440
    ds_read_b64_tr_b16 a[136:137], v206 offset:0
    ds_read_b64_tr_b16 a[138:139], v206 offset:1024
    s_add_u32 s55, s55, 0x100000
    s_and_b32 s55, s55, 0x3fffff
    v_lshlrev_b32_e64 v234, 10, v234
    v_mfma_f32_32x32x16_bf16 v[48:63], a[148:151], a[172:175], v[48:63]
    buffer_load_dwordx4 v208, s[8:11], s32 offen lds
    ds_read_b64_tr_b16 a[140:141], v207 offset:0
    v_mfma_f32_32x32x16_bf16 v[64:79], a[152:155], a[168:171], v[64:79]
    buffer_load_dwordx4 v209, s[8:11], s32 offen offset:1024 lds
    ds_read_b64_tr_b16 a[142:143], v207 offset:1024
    v_and_b32_e64 v227, 31, v220
    v_mfma_f32_32x32x16_bf16 v[80:95], a[152:155], a[172:175], v[80:95]
    buffer_load_dwordx4 v210, s[8:11], s32 offen offset:2048 lds
    v_mfma_f32_32x32x16_bf16 v[96:111], a[156:159], a[168:171], v[96:111]
    buffer_load_dwordx4 v211, s[8:11], s32 offen offset:3072 lds
    v_lshl_add_u32 v234, v227, 4, v234
    v_mfma_f32_32x32x16_bf16 v[112:127], a[156:159], a[172:175], v[112:127]
    s_waitcnt lgkmcnt(0)
    v_mfma_f32_32x32x16_bf16 v[0:15], a[128:131], a[160:163], v[0:15]
    ds_read_b128 a[168:171], v219 offset:29696
    s_waitcnt vmcnt(8)
    ds_read_b64_tr_b16 a[144:145], v204 offset:4096
    ds_read_b64_tr_b16 a[146:147], v204 offset:5120
    s_add_u32 m0, s52, 24576
    v_mfma_f32_32x32x16_bf16 v[16:31], a[128:131], a[164:167], v[16:31]
    s_mov_b32 s8, s4
    s_nop 0
    s_and_b32 s9, s5, 0xffff
    s_mov_b32 s10, 0x1c0000
    s_mov_b32 s11, 0x20000
    ds_read_b64_tr_b16 a[148:149], v205 offset:4096
    ds_read_b64_tr_b16 a[150:151], v205 offset:5120
    v_mfma_f32_32x32x16_bf16 v[32:47], a[132:135], a[160:163], v[32:47]
    ds_read_b128 a[172:175], v219 offset:62464
    ds_read_b64_tr_b16 a[152:153], v206 offset:4096
    ds_read_b64_tr_b16 a[154:155], v206 offset:5120
    s_lshl_b32 s32, s29, 19
    s_add_u32 s32, s32, s54
    v_mfma_f32_32x32x16_bf16 v[48:63], a[132:135], a[164:167], v[48:63]
    buffer_load_dwordx4 v212, s[12:15], s36 offen lds
    buffer_load_dwordx4 v213, s[12:15], s36 offen offset:1024 lds
    ds_read_b64_tr_b16 a[156:157], v207 offset:4096
    v_mfma_f32_32x32x16_bf16 v[64:79], a[136:139], a[160:163], v[64:79]
    ds_read_b64_tr_b16 a[158:159], v207 offset:5120
    s_add_u32 m0, s52, 0
    v_and_b32 v209, 15, v220
    v_mfma_f32_32x32x16_bf16 v[80:95], a[136:139], a[164:167], v[80:95]
    buffer_load_dwordx4 v212, s[12:15], s37 offen lds
    v_lshlrev_b32_e64 v210, 1, v221
    v_mfma_f32_32x32x16_bf16 v[96:111], a[140:143], a[160:163], v[96:111]
    buffer_load_dwordx4 v213, s[12:15], s37 offen offset:1024 lds
    v_mfma_f32_32x32x16_bf16 v[112:127], a[140:143], a[164:167], v[112:127]
    v_xor_b32 v209, v209, v210
    s_waitcnt lgkmcnt(0)
    v_mfma_f32_32x32x16_bf16 v[0:15], a[144:147], a[168:171], v[0:15]
    ds_read_b128 a[160:163], v215 offset:30720
    s_waitcnt vmcnt(8)
    s_nop 0
    ds_read_b64_tr_b16 a[128:129], v204 offset:8192
    ds_read_b64_tr_b16 a[130:131], v204 offset:9216
    s_add_u32 m0, s52, 8192
    v_mfma_f32_32x32x16_bf16 v[16:31], a[144:147], a[172:175], v[16:31]
    buffer_load_dwordx4 v212, s[12:15], s38 offen lds
    ds_read_b64_tr_b16 a[132:133], v205 offset:8192
    ds_read_b64_tr_b16 a[134:135], v205 offset:9216
    v_lshlrev_b32_e64 v208, 10, v221
    v_mfma_f32_32x32x16_bf16 v[32:47], a[148:151], a[168:171], v[32:47]
    buffer_load_dwordx4 v213, s[12:15], s38 offen offset:1024 lds
    ds_read_b128 a[164:167], v215 offset:63488
    ds_read_b64_tr_b16 a[136:137], v206 offset:8192
    ds_read_b64_tr_b16 a[138:139], v206 offset:9216
    v_mfma_f32_32x32x16_bf16 v[48:63], a[148:151], a[172:175], v[48:63]
    ds_read_b64_tr_b16 a[140:141], v207 offset:8192
    v_lshl_add_u32 v208, v209, 4, v208
    v_mfma_f32_32x32x16_bf16 v[64:79], a[152:155], a[168:171], v[64:79]
    ds_read_b64_tr_b16 a[142:143], v207 offset:9216
    v_xor_b32 v210, 128, v208
    v_mfma_f32_32x32x16_bf16 v[80:95], a[152:155], a[172:175], v[80:95]
    v_mfma_f32_32x32x16_bf16 v[96:111], a[156:159], a[168:171], v[96:111]
    v_add_u32_e64 v208, s32, v208
    v_mfma_f32_32x32x16_bf16 v[112:127], a[156:159], a[172:175], v[112:127]
    s_waitcnt lgkmcnt(0)
    v_mfma_f32_32x32x16_bf16 v[0:15], a[128:131], a[160:163], v[0:15]
    ds_read_b128 a[168:171], v219 offset:31744
    s_waitcnt vmcnt(6)
    ds_read_b64_tr_b16 a[144:145], v204 offset:12288
    ds_read_b64_tr_b16 a[146:147], v204 offset:13312
    v_add_u32_e64 v210, s32, v210
    v_mfma_f32_32x32x16_bf16 v[16:31], a[128:131], a[164:167], v[16:31]
    ds_read_b64_tr_b16 a[148:149], v205 offset:12288
    ds_read_b64_tr_b16 a[150:151], v205 offset:13312
    v_mfma_f32_32x32x16_bf16 v[32:47], a[132:135], a[160:163], v[32:47]
    ds_read_b128 a[172:175], v219 offset:64512
    ds_read_b64_tr_b16 a[152:153], v206 offset:12288
    ds_read_b64_tr_b16 a[154:155], v206 offset:13312
    v_add_u32 v209, 3072, v208
    v_mfma_f32_32x32x16_bf16 v[48:63], a[132:135], a[164:167], v[48:63]
    ds_read_b64_tr_b16 a[156:157], v207 offset:12288
    v_mfma_f32_32x32x16_bf16 v[64:79], a[136:139], a[160:163], v[64:79]
    ds_read_b64_tr_b16 a[158:159], v207 offset:13312
    v_add_u32 v211, 9216, v210
    v_mfma_f32_32x32x16_bf16 v[80:95], a[136:139], a[164:167], v[80:95]
    v_mfma_f32_32x32x16_bf16 v[96:111], a[140:143], a[160:163], v[96:111]
    v_add_u32 v210, 6144, v210
    v_mfma_f32_32x32x16_bf16 v[112:127], a[140:143], a[164:167], v[112:127]
    s_waitcnt lgkmcnt(0)
    v_mfma_f32_32x32x16_bf16 v[0:15], a[144:147], a[168:171], v[0:15]
    s_waitcnt vmcnt(0)
    s_waitcnt lgkmcnt(0)
    s_barrier
    ds_read_b128 a[128:131], v192 offset:24576
    ds_read_b128 a[132:135], v193 offset:24576
    s_and_b32 s6, s50, 30
    s_lshl_b32 s55, s6, 14
    v_mfma_f32_32x32x16_bf16 v[16:31], a[144:147], a[172:175], v[16:31]
    s_add_u32 m0, s52, 32768
    s_nop 0
    s_nop 0
    buffer_load_dwordx4 v214, s[16:19], s36 offen lds
    ds_read_b128 a[136:139], v194 offset:24576
    v_mfma_f32_32x32x16_bf16 v[32:47], a[148:151], a[168:171], v[32:47]
    buffer_load_dwordx4 v214, s[16:19], s36 offen offset:1024 lds
    ds_read_b128 a[140:143], v195 offset:24576
    v_add_u32 v215, 32768, v216
    v_add_u32 v219, 32768, v216
    v_mfma_f32_32x32x16_bf16 v[48:63], a[148:151], a[172:175], v[48:63]
    s_add_u32 m0, s52, 40960
    v_mfma_f32_32x32x16_bf16 v[64:79], a[152:155], a[168:171], v[64:79]
    buffer_load_dwordx4 v214, s[16:19], s37 offen lds
    v_mfma_f32_32x32x16_bf16 v[80:95], a[152:155], a[172:175], v[80:95]
    buffer_load_dwordx4 v214, s[16:19], s37 offen offset:1024 lds
    v_cvt_pk_bf16_f32 v128, v0, v1
    v_cvt_pk_bf16_f32 v129, v2, v3
    v_cvt_pk_bf16_f32 v130, v4, v5
    v_mfma_f32_32x32x16_bf16 v[96:111], a[156:159], a[168:171], v[96:111]
    v_cvt_pk_bf16_f32 v131, v6, v7
    v_cvt_pk_bf16_f32 v136, v8, v9
    v_cvt_pk_bf16_f32 v137, v10, v11
    v_cvt_pk_bf16_f32 v138, v12, v13
    v_cvt_pk_bf16_f32 v139, v14, v15
    v_cvt_pk_bf16_f32 v132, v16, v17
    v_mfma_f32_32x32x16_bf16 v[112:127], a[156:159], a[172:175], v[112:127]
    v_cvt_pk_bf16_f32 v133, v18, v19
    v_cvt_pk_bf16_f32 v134, v20, v21
    v_cvt_pk_bf16_f32 v135, v22, v23
    v_cvt_pk_bf16_f32 v140, v24, v25
    v_cvt_pk_bf16_f32 v141, v26, v27
    v_cvt_pk_bf16_f32 v142, v28, v29
    v_cvt_pk_bf16_f32 v143, v30, v31
    s_waitcnt lgkmcnt(0)
    s_nop 0
    v_mfma_f32_32x32x16_bf16 v[0:15], a[128:131], v[128:131], 0
    ds_read_b128 a[144:147], v196 offset:24576
    v_cvt_pk_bf16_f32 v144, v32, v33
    v_cvt_pk_bf16_f32 v145, v34, v35
    v_cvt_pk_bf16_f32 v146, v36, v37
    v_cvt_pk_bf16_f32 v147, v38, v39
    v_mfma_f32_32x32x16_bf16 v[16:31], a[128:131], v[132:135], 0
    ds_read_b128 a[148:151], v197 offset:24576
    v_cvt_pk_bf16_f32 v152, v40, v41
    v_cvt_pk_bf16_f32 v153, v42, v43
    v_cvt_pk_bf16_f32 v154, v44, v45
    v_cvt_pk_bf16_f32 v155, v46, v47
    v_mfma_f32_32x32x16_bf16 v[0:15], a[132:135], v[136:139], v[0:15]
    ds_read_b128 a[152:155], v198 offset:24576
    v_cvt_pk_bf16_f32 v148, v48, v49
    v_cvt_pk_bf16_f32 v149, v50, v51
    v_cvt_pk_bf16_f32 v150, v52, v53
    v_cvt_pk_bf16_f32 v151, v54, v55
    v_mfma_f32_32x32x16_bf16 v[16:31], a[132:135], v[140:143], v[16:31]
    ds_read_b128 a[156:159], v199 offset:24576
    v_cvt_pk_bf16_f32 v156, v56, v57
    v_cvt_pk_bf16_f32 v157, v58, v59
    v_cvt_pk_bf16_f32 v158, v60, v61
    v_cvt_pk_bf16_f32 v159, v62, v63
    v_mfma_f32_32x32x16_bf16 v[0:15], a[136:139], v[144:147], v[0:15]
    v_cvt_pk_bf16_f32 v160, v64, v65
    v_cvt_pk_bf16_f32 v161, v66, v67
    v_cvt_pk_bf16_f32 v162, v68, v69
    v_cvt_pk_bf16_f32 v163, v70, v71
    v_mfma_f32_32x32x16_bf16 v[16:31], a[136:139], v[148:151], v[16:31]
    v_cvt_pk_bf16_f32 v168, v72, v73
    v_cvt_pk_bf16_f32 v169, v74, v75
    v_cvt_pk_bf16_f32 v170, v76, v77
    v_cvt_pk_bf16_f32 v171, v78, v79
    v_mfma_f32_32x32x16_bf16 v[0:15], a[140:143], v[152:155], v[0:15]
    v_cvt_pk_bf16_f32 v164, v80, v81
    v_cvt_pk_bf16_f32 v165, v82, v83
    v_cvt_pk_bf16_f32 v166, v84, v85
    v_cvt_pk_bf16_f32 v167, v86, v87
    v_mfma_f32_32x32x16_bf16 v[16:31], a[140:143], v[156:159], v[16:31]
    v_cvt_pk_bf16_f32 v172, v88, v89
    v_cvt_pk_bf16_f32 v173, v90, v91
    v_cvt_pk_bf16_f32 v174, v92, v93
    v_cvt_pk_bf16_f32 v175, v94, v95
    s_waitcnt lgkmcnt(0)
    s_nop 0
    v_mfma_f32_32x32x16_bf16 v[0:15], a[144:147], v[160:163], v[0:15]
    ds_read_b128 a[128:131], v192 offset:0
    v_cvt_pk_bf16_f32 v176, v96, v97
    v_cvt_pk_bf16_f32 v177, v98, v99
    v_cvt_pk_bf16_f32 v178, v100, v101
    v_cvt_pk_bf16_f32 v179, v102, v103
    v_mfma_f32_32x32x16_bf16 v[16:31], a[144:147], v[164:167], v[16:31]
    ds_read_b128 a[132:135], v193 offset:0
    v_cvt_pk_bf16_f32 v184, v104, v105
    v_cvt_pk_bf16_f32 v185, v106, v107
    v_cvt_pk_bf16_f32 v186, v108, v109
    v_cvt_pk_bf16_f32 v187, v110, v111
    v_mfma_f32_32x32x16_bf16 v[0:15], a[148:151], v[168:171], v[0:15]
    ds_read_b128 a[136:139], v194 offset:0
    v_cvt_pk_bf16_f32 v180, v112, v113
    v_cvt_pk_bf16_f32 v181, v114, v115
    v_cvt_pk_bf16_f32 v182, v116, v117
    v_cvt_pk_bf16_f32 v183, v118, v119
    v_mfma_f32_32x32x16_bf16 v[16:31], a[148:151], v[172:175], v[16:31]
    ds_read_b128 a[140:143], v195 offset:0
    v_cvt_pk_bf16_f32 v188, v120, v121
    v_cvt_pk_bf16_f32 v189, v122, v123
    v_cvt_pk_bf16_f32 v190, v124, v125
    v_cvt_pk_bf16_f32 v191, v126, v127
    v_mfma_f32_32x32x16_bf16 v[0:15], a[152:155], v[176:179], v[0:15]
    v_mfma_f32_32x32x16_bf16 v[16:31], a[152:155], v[180:183], v[16:31]
    v_mfma_f32_32x32x16_bf16 v[0:15], a[156:159], v[184:187], v[0:15]
    v_mfma_f32_32x32x16_bf16 v[16:31], a[156:159], v[188:191], v[16:31]
    s_waitcnt lgkmcnt(0)
    s_cmp_lg_u32 s39, 0
    s_cbranch_scc1 FB_MAX
IT0:
    v_mfma_f32_32x32x16_bf16 v[32:47], a[128:131], v[128:131], 0
    ds_read_b128 a[144:147], v196 offset:0
    v_mfma_f32_32x32x16_bf16 v[48:63], a[128:131], v[132:135], 0
    ds_read_b128 a[148:151], v197 offset:0
    s_nop 3
    v_max3_f32 v236, v0, v1, v2
    v_max3_f32 v237, v16, v17, v18
    v_max3_f32 v236, v236, v3, v4
    v_max3_f32 v237, v237, v19, v20
    v_max3_f32 v236, v236, v5, v6
    v_mfma_f32_32x32x16_bf16 v[32:47], a[132:135], v[136:139], v[32:47]
    v_max3_f32 v237, v237, v21, v22
    v_max3_f32 v236, v236, v7, v8
    v_max3_f32 v237, v237, v23, v24
    v_max3_f32 v236, v236, v9, v10
    v_max3_f32 v237, v237, v25, v26
    v_max3_f32 v236, v236, v11, v12
    v_mfma_f32_32x32x16_bf16 v[48:63], a[132:135], v[140:143], v[48:63]
    ds_read_b128 a[152:155], v198 offset:0
    v_max3_f32 v237, v237, v27, v28
    v_max3_f32 v236, v236, v13, v14
    v_max3_f32 v237, v237, v29, v30
    v_max_f32 v236, v236, v15
    v_max_f32 v237, v237, v31
    v_mfma_f32_32x32x16_bf16 v[32:47], a[136:139], v[144:147], v[32:47]
    ds_read_b128 a[156:159], v199 offset:0
    v_mov_b32 v238, v236
    v_mov_b32 v239, v237
    s_nop 0
    v_permlane32_swap_b32 v236, v238
    v_mfma_f32_32x32x16_bf16 v[48:63], a[136:139], v[148:151], v[48:63]
    v_permlane32_swap_b32 v237, v239
    v_max_f32 v236, v236, v238
    v_max_f32_e64 v237, v237, v239
    s_cmp_lg_u32 s39, 0
    s_cselect_b64 vcc, -1, 0
    v_mfma_f32_32x32x16_bf16 v[32:47], a[140:143], v[152:155], v[32:47]
    v_sub_f32 v64, 0xc2c00000, v236
    v_sub_f32 v80, 0xc2c00000, v237
    v_cndmask_b32 v64, v64, v240, vcc
    v_cndmask_b32 v80, v80, v241, vcc
    v_add_f32_e64 v0, v0, v64
    v_mfma_f32_32x32x16_bf16 v[48:63], a[140:143], v[156:159], v[48:63]
    v_exp_f32 v0, v0
    v_add_f32 v1, v1, v64
    v_exp_f32 v1, v1
    s_waitcnt lgkmcnt(0)
    v_mfma_f32_32x32x16_bf16 v[32:47], a[144:147], v[160:163], v[32:47]
    v_add_f32 v217, v217, v0
    v_add_f32 v2, v2, v64
    v_exp_f32 v2, v2
    v_add_f32 v217, v217, v1
    v_cvt_pk_bf16_f32 v0, v0, v1
    v_mfma_f32_32x32x16_bf16 v[48:63], a[144:147], v[164:167], v[48:63]
    s_waitcnt vmcnt(0)
    s_barrier
    v_add_f32 v3, v3, v64
    v_exp_f32 v3, v3
    v_add_f32_e64 v217, v217, v2
    v_mfma_f32_32x32x16_bf16 v[32:47], a[148:151], v[168:171], v[32:47]
    ds_read_b64_tr_b16 a[128:129], v200 offset:0
    v_add_f32 v4, v4, v64
    v_exp_f32 v4, v4
    v_add_f32_e64 v217, v217, v3
    v_cvt_pk_bf16_f32 v1, v2, v3
    v_mfma_f32_32x32x16_bf16 v[48:63], a[148:151], v[172:175], v[48:63]
    ds_read_b64_tr_b16 a[130:131], v200 offset:2048
    v_add_f32 v5, v5, v64
    v_exp_f32 v5, v5
    v_add_f32 v217, v217, v4
    v_add_f32 v6, v6, v64
    v_mfma_f32_32x32x16_bf16 v[32:47], a[152:155], v[176:179], v[32:47]
    ds_read_b64_tr_b16 a[132:133], v201 offset:0
    v_exp_f32 v6, v6
    v_add_f32 v217, v217, v5
    v_cvt_pk_bf16_f32 v2, v4, v5
    v_add_f32_e64 v7, v7, v64
    v_mfma_f32_32x32x16_bf16 v[48:63], a[152:155], v[180:183], v[48:63]
    ds_read_b64_tr_b16 a[134:135], v201 offset:2048
    ds_read_b64_tr_b16 a[136:137], v202 offset:0
    ds_read_b64_tr_b16 a[138:139], v202 offset:2048
    ds_read_b64_tr_b16 a[140:141], v203 offset:0
    ds_read_b64_tr_b16 a[142:143], v203 offset:2048
    v_mfma_f32_32x32x16_bf16 v[32:47], a[156:159], v[184:187], v[32:47]
    v_exp_f32 v7, v7
    v_add_f32 v217, v217, v6
    v_add_f32 v16, v16, v80
    v_exp_f32 v16, v16
    v_mfma_f32_32x32x16_bf16 v[48:63], a[156:159], v[188:191], v[48:63]
    v_add_f32_e64 v217, v217, v7
STUB3:
    s_cbranch_execz STUB7
    s_nop 0
    v_cvt_pk_bf16_f32 v3, v6, v7
    v_add_f32 v17, v17, v80
    v_exp_f32 v17, v17
    v_add_f32 v218, v218, v16
    v_add_f32 v18, v18, v80
    v_exp_f32 v18, v18
    v_add_f32 v218, v218, v17
    v_cvt_pk_bf16_f32 v16, v16, v17
    v_add_f32 v19, v19, v80
    v_exp_f32 v19, v19
    v_add_f32 v218, v218, v18
    v_add_f32 v20, v20, v80
    v_exp_f32 v20, v20
    v_add_f32 v218, v218, v19
    v_cvt_pk_bf16_f32 v17, v18, v19
    v_add_f32 v21, v21, v80
    v_exp_f32 v21, v21
    v_add_f32 v218, v218, v20
    v_add_f32 v22, v22, v80
    v_exp_f32 v22, v22
    v_add_f32 v218, v218, v21
    v_cvt_pk_bf16_f32 v18, v20, v21
    v_add_f32 v23, v23, v80
    v_exp_f32 v23, v23
    v_add_f32 v218, v218, v22
    v_add_f32 v8, v8, v64
    v_exp_f32 v8, v8
    v_add_f32 v218, v218, v23
    v_cvt_pk_bf16_f32 v19, v22, v23
    s_waitcnt lgkmcnt(0)
    v_mfma_f32_32x32x16_bf16 a[0:15], a[128:131], v[0:3], 0
    ds_read_b64_tr_b16 a[144:145], v200 offset:4096
    ds_read_b64_tr_b16 a[146:147], v200 offset:6144
    v_add_f32 v9, v9, v64
    v_exp_f32 v9, v9
    v_add_f32 v217, v217, v8
    v_mfma_f32_32x32x16_bf16 a[16:31], a[128:131], v[16:19], 0
    ds_read_b64_tr_b16 a[148:149], v201 offset:4096
    v_add_f32 v10, v10, v64
    v_exp_f32 v10, v10
    v_add_f32_e64 v217, v217, v9
    v_cvt_pk_bf16_f32 v8, v8, v9
    v_mfma_f32_32x32x16_bf16 a[32:47], a[132:135], v[0:3], 0
    ds_read_b64_tr_b16 a[150:151], v201 offset:6144
    v_add_f32 v11, v11, v64
    v_exp_f32 v11, v11
    v_add_f32 v217, v217, v10
    v_add_f32 v12, v12, v64
    v_mfma_f32_32x32x16_bf16 a[48:63], a[132:135], v[16:19], 0
    ds_read_b64_tr_b16 a[152:153], v202 offset:4096
    v_exp_f32 v12, v12
    v_add_f32 v217, v217, v11
    v_cvt_pk_bf16_f32 v9, v10, v11
    v_add_f32_e64 v13, v13, v64
    v_mfma_f32_32x32x16_bf16 a[64:79], a[136:139], v[0:3], 0
    v_exp_f32 v13, v13
    v_add_f32 v217, v217, v12
    v_add_f32 v14, v14, v64
    v_exp_f32 v14, v14
    v_mfma_f32_32x32x16_bf16 a[80:95], a[136:139], v[16:19], 0
    ds_read_b64_tr_b16 a[154:155], v202 offset:6144
    ds_read_b64_tr_b16 a[156:157], v203 offset:4096
    ds_read_b64_tr_b16 a[158:159], v203 offset:6144
    v_add_f32_e64 v217, v217, v13
    v_cvt_pk_bf16_f32 v10, v12, v13
    v_add_f32_e64 v15, v15, v64
    v_mfma_f32_32x32x16_bf16 a[96:111], a[140:143], v[0:3], 0
    v_exp_f32 v15, v15
    v_add_f32 v217, v217, v14
    v_add_f32 v24, v24, v80
    v_exp_f32 v24, v24
    v_add_f32_e64 v217, v217, v15
    v_cvt_pk_bf16_f32 v11, v14, v15
    v_add_f32 v25, v25, v80
    v_exp_f32 v25, v25
    v_add_f32 v218, v218, v24
    v_add_f32 v26, v26, v80
    v_exp_f32 v26, v26
    v_add_f32 v218, v218, v25
    v_cvt_pk_bf16_f32 v24, v24, v25
    v_add_f32 v27, v27, v80
    v_exp_f32 v27, v27
    v_add_f32 v218, v218, v26
    v_add_f32 v28, v28, v80
    v_exp_f32 v28, v28
    v_add_f32 v218, v218, v27
    v_cvt_pk_bf16_f32 v25, v26, v27
    v_add_f32 v29, v29, v80
    v_exp_f32 v29, v29
    v_add_f32 v218, v218, v28
    v_add_f32 v30, v30, v80
    v_exp_f32 v30, v30
    v_add_f32 v218, v218, v29
    v_cvt_pk_bf16_f32 v26, v28, v29
    v_add_f32 v31, v31, v80
    v_exp_f32 v31, v31
    v_add_f32 v218, v218, v30
    v_add_f32 v218, v218, v31
    v_cvt_pk_bf16_f32 v27, v30, v31
    v_mfma_f32_32x32x16_bf16 a[112:127], a[140:143], v[16:19], 0
    v_mov_b32 v65, v64
    v_mov_b32 v66, v64
    v_add_f32 v32, v32, v64
    v_exp_f32_e64 v32, v32
    s_waitcnt lgkmcnt(0)
    v_mfma_f32_32x32x16_bf16 a[0:15], a[144:147], v[8:11], a[0:15]
    ds_read_b128 a[128:131], v192 offset:8192
    v_mov_b32 v67, v64
    v_mov_b32 v68, v64
    v_add_f32 v33, v33, v64
    v_exp_f32 v33, v33
    v_mfma_f32_32x32x16_bf16 a[16:31], a[144:147], v[24:27], a[16:31]
    s_add_u32 s37, s38, 8192
    s_and_b32 s37, s37, 0x1ffff
    v_mov_b32 v69, v64
    v_mov_b32 v70, v64
    v_add_f32 v217, v217, v32
    v_add_f32 v34, v34, v64
    v_mfma_f32_32x32x16_bf16 a[32:47], a[148:151], v[8:11], a[32:47]
    ds_read_b128 a[132:135], v193 offset:8192
    v_mov_b32 v71, v64
    v_mov_b32 v72, v64
    v_exp_f32 v34, v34
    v_add_f32 v217, v217, v33
    v_mfma_f32_32x32x16_bf16 a[48:63], a[148:151], v[24:27], a[48:63]
    v_mov_b32 v73, v64
    v_mov_b32 v74, v64
    v_mov_b32 v75, v64
    v_mov_b32 v76, v64
    v_cvt_pk_bf16_f32 v32, v32, v33
    v_add_f32_e64 v35, v35, v64
    v_mfma_f32_32x32x16_bf16 a[64:79], a[152:155], v[8:11], a[64:79]
    s_add_u32 m0, s52, 49152
    v_mov_b32 v77, v64
    v_exp_f32 v35, v35
    v_add_f32 v217, v217, v34
    v_add_f32 v36, v36, v64
    v_mfma_f32_32x32x16_bf16 a[80:95], a[152:155], v[24:27], a[80:95]
    ds_read_b128 a[136:139], v194 offset:8192
    ds_read_b128 a[140:143], v195 offset:8192
    v_mov_b32 v78, v64
    v_mov_b32 v79, v64
    v_exp_f32_e64 v36, v36
    v_mfma_f32_32x32x16_bf16 a[96:111], a[156:159], v[8:11], a[96:111]
    v_mov_b32 v81, v80
    v_mov_b32 v82, v80
    v_mov_b32 v83, v80
    v_mov_b32 v84, v80
    v_mov_b32 v85, v80
    v_mov_b32 v86, v80
    v_mov_b32 v87, v80
    v_mov_b32 v88, v80
    v_mov_b32 v89, v80
    v_mov_b32 v90, v80
    v_mov_b32 v91, v80
    v_mov_b32 v92, v80
    v_mov_b32 v93, v80
    v_mov_b32 v94, v80
    v_mov_b32_e64 v95, v80
    v_mfma_f32_32x32x16_bf16 a[112:127], a[156:159], v[24:27], a[112:127]
    v_add_f32_e64 v217, v217, v35
    v_cvt_pk_bf16_f32 v33, v34, v35
    v_add_f32 v37, v37, v64
    v_exp_f32_e64 v37, v37
    s_waitcnt lgkmcnt(0)
    v_mfma_f32_32x32x16_bf16 v[0:15], a[128:131], v[128:131], v[64:79]
    buffer_load_dwordx4 v214, s[16:19], s38 offen lds
    ds_read_b128 a[144:147], v196 offset:8192
    v_add_f32 v217, v217, v36
    v_add_f32 v38, v38, v64
    v_mfma_f32_32x32x16_bf16 v[16:31], a[128:131], v[132:135], v[80:95]
    buffer_load_dwordx4 v214, s[16:19], s38 offen offset:1024 lds
    v_exp_f32 v38, v38
    v_add_f32 v217, v217, v37
    v_mfma_f32_32x32x16_bf16 v[0:15], a[132:135], v[136:139], v[0:15]
    v_cvt_pk_bf16_f32 v34, v36, v37
    v_add_f32 v39, v39, v64
    v_exp_f32 v39, v39
    v_add_f32 v217, v217, v38
    v_add_f32 v48, v48, v80
    v_mfma_f32_32x32x16_bf16 v[16:31], a[132:135], v[140:143], v[16:31]
    s_add_u32 m0, s52, 16384
    v_exp_f32 v48, v48
    v_add_f32 v217, v217, v39
    v_cvt_pk_bf16_f32 v35, v38, v39
    v_add_f32_e64 v49, v49, v80
    v_mfma_f32_32x32x16_bf16 v[0:15], a[136:139], v[144:147], v[0:15]
    buffer_load_dwordx4 v212, s[12:15], s37 offen lds
    v_exp_f32 v49, v49
    v_add_f32 v218, v218, v48
    v_mfma_f32_32x32x16_bf16 v[16:31], a[136:139], v[148:151], v[16:31]
    ds_read_b128 a[148:151], v197 offset:8192
    ds_read_b128 a[152:155], v198 offset:8192
    ds_read_b128 a[156:159], v199 offset:8192
    v_add_f32 v50, v50, v80
    v_exp_f32 v50, v50
    v_add_f32_e64 v218, v218, v49
    v_mfma_f32_32x32x16_bf16 v[0:15], a[140:143], v[152:155], v[0:15]
    buffer_load_dwordx4 v213, s[12:15], s37 offen offset:1024 lds
    v_cvt_pk_bf16_f32 v48, v48, v49
    v_add_f32 v51, v51, v80
    v_exp_f32 v51, v51
    v_add_f32_e64 v218, v218, v50
    v_mfma_f32_32x32x16_bf16 v[16:31], a[140:143], v[156:159], v[16:31]
    s_add_u32 m0, s52, 57344
    v_add_f32 v52, v52, v80
    v_exp_f32 v52, v52
    v_add_f32 v218, v218, v51
    s_waitcnt lgkmcnt(0)
    v_mfma_f32_32x32x16_bf16 v[0:15], a[144:147], v[160:163], v[0:15]
    v_cvt_pk_bf16_f32 v49, v50, v51
    v_add_f32 v53, v53, v80
    v_exp_f32 v53, v53
    v_add_f32 v218, v218, v52
    v_add_f32 v54, v54, v80
    v_mfma_f32_32x32x16_bf16 v[16:31], a[144:147], v[164:167], v[16:31]
    buffer_load_dwordx4 v214, s[16:19], s37 offen lds
    v_exp_f32 v54, v54
    v_add_f32 v218, v218, v53
    v_cvt_pk_bf16_f32 v50, v52, v53
    v_mfma_f32_32x32x16_bf16 v[0:15], a[148:151], v[168:171], v[0:15]
    buffer_load_dwordx4 v214, s[16:19], s37 offen offset:1024 lds
    v_add_f32 v55, v55, v80
    v_exp_f32 v55, v55
    v_add_f32_e64 v218, v218, v54
    v_mfma_f32_32x32x16_bf16 v[16:31], a[148:151], v[172:175], v[16:31]
    s_add_u32 s38, s37, 8192
    s_and_b32 s38, s38, 0x1ffff
    s_add_u32 m0, s52, 24576
    s_nop 0
    buffer_load_dwordx4 v212, s[12:15], s38 offen lds
    buffer_load_dwordx4 v213, s[12:15], s38 offen offset:1024 lds
    v_add_f32 v40, v40, v64
    v_exp_f32 v40, v40
    v_add_f32 v218, v218, v55
    v_cvt_pk_bf16_f32 v51, v54, v55
    v_mfma_f32_32x32x16_bf16 v[0:15], a[152:155], v[176:179], v[0:15]
    ds_read_b64_tr_b16 a[128:129], v200 offset:8192
    v_add_f32 v41, v41, v64
    v_exp_f32 v41, v41
    v_add_f32 v217, v217, v40
    v_add_f32 v42, v42, v64
    v_mfma_f32_32x32x16_bf16 v[16:31], a[152:155], v[180:183], v[16:31]
    ds_read_b64_tr_b16 a[130:131], v200 offset:10240
    ds_read_b64_tr_b16 a[132:133], v201 offset:8192
    ds_read_b64_tr_b16 a[134:135], v201 offset:10240
    ds_read_b64_tr_b16 a[136:137], v202 offset:8192
    ds_read_b64_tr_b16 a[138:139], v202 offset:10240
    ds_read_b64_tr_b16 a[140:141], v203 offset:8192
    ds_read_b64_tr_b16 a[142:143], v203 offset:10240
    v_exp_f32 v42, v42
    v_add_f32 v217, v217, v41
    v_cvt_pk_bf16_f32 v40, v40, v41
    v_mfma_f32_32x32x16_bf16 v[0:15], a[156:159], v[184:187], v[0:15]
    v_add_f32 v43, v43, v64
    v_exp_f32 v43, v43
    v_add_f32 v217, v217, v42
    v_add_f32 v44, v44, v64
    v_mfma_f32_32x32x16_bf16 v[16:31], a[156:159], v[188:191], v[16:31]
    v_exp_f32 v44, v44
    v_add_f32 v217, v217, v43
    v_cvt_pk_bf16_f32 v41, v42, v43
    v_add_f32 v45, v45, v64
    s_waitcnt lgkmcnt(0)
    v_mfma_f32_32x32x16_bf16 a[0:15], a[128:131], v[32:35], a[0:15]
    v_exp_f32 v45, v45
    v_add_f32 v217, v217, v44
    v_add_f32 v46, v46, v64
    v_exp_f32 v46, v46
    v_mfma_f32_32x32x16_bf16 a[16:31], a[128:131], v[48:51], a[16:31]
    v_add_f32_e64 v217, v217, v45
    v_cvt_pk_bf16_f32 v42, v44, v45
    v_add_f32 v47, v47, v64
    v_exp_f32 v47, v47
    v_add_f32_e64 v217, v217, v46
    v_mfma_f32_32x32x16_bf16 a[32:47], a[132:135], v[32:35], a[32:47]
    v_add_f32 v56, v56, v80
    v_exp_f32 v56, v56
    v_add_f32_e64 v217, v217, v47
    v_cvt_pk_bf16_f32 v43, v46, v47
    v_add_f32_e64 v57, v57, v80
    v_mfma_f32_32x32x16_bf16 a[48:63], a[132:135], v[48:51], a[48:63]
    ds_read_b64_tr_b16 a[144:145], v200 offset:12288
    ds_read_b64_tr_b16 a[146:147], v200 offset:14336
    v_exp_f32 v57, v57
    v_add_f32 v218, v218, v56
    v_add_f32_e64 v58, v58, v80
    v_mfma_f32_32x32x16_bf16 a[64:79], a[136:139], v[32:35], a[64:79]
    ds_read_b64_tr_b16 a[148:149], v201 offset:12288
    v_exp_f32 v58, v58
    v_add_f32 v218, v218, v57
    v_cvt_pk_bf16_f32 v56, v56, v57
    v_add_f32_e64 v59, v59, v80
    v_mfma_f32_32x32x16_bf16 a[80:95], a[136:139], v[48:51], a[80:95]
    ds_read_b64_tr_b16 a[150:151], v201 offset:14336
    ds_read_b64_tr_b16 a[152:153], v202 offset:12288
    ds_read_b64_tr_b16 a[154:155], v202 offset:14336
    ds_read_b64_tr_b16 a[156:157], v203 offset:12288
    ds_read_b64_tr_b16 a[158:159], v203 offset:14336
    v_exp_f32 v59, v59
    v_add_f32 v218, v218, v58
    v_add_f32 v60, v60, v80
    v_exp_f32 v60, v60
    v_add_f32_e64 v218, v218, v59
    v_cvt_pk_bf16_f32 v57, v58, v59
    v_add_f32 v61, v61, v80
    v_exp_f32 v61, v61
    v_add_f32 v218, v218, v60
    v_add_f32 v62, v62, v80
    v_exp_f32 v62, v62
    v_add_f32 v218, v218, v61
    v_cvt_pk_bf16_f32 v58, v60, v61
    v_add_f32 v63, v63, v80
    v_exp_f32 v63, v63
    v_add_f32 v218, v218, v62
    v_add_f32 v218, v218, v63
    v_cvt_pk_bf16_f32 v59, v62, v63
    v_mfma_f32_32x32x16_bf16 a[96:111], a[140:143], v[32:35], a[96:111]
    v_exp_f32 v0, v0
    v_exp_f32 v1, v1
    v_add_f32_e64 v217, v217, v0
    v_mfma_f32_32x32x16_bf16 a[112:127], a[140:143], v[48:51], a[112:127]
    v_exp_f32 v2, v2
    v_add_f32 v217, v217, v1
    v_cvt_pk_bf16_f32 v0, v0, v1
    s_waitcnt lgkmcnt(0)
    v_mfma_f32_32x32x16_bf16 a[0:15], a[144:147], v[40:43], a[0:15]
    s_waitcnt vmcnt(0)
    s_barrier
    ds_read_b128 a[128:131], v192 offset:16384
    v_exp_f32 v3, v3
    v_add_f32_e64 v217, v217, v2
    v_mfma_f32_32x32x16_bf16 a[16:31], a[144:147], v[56:59], a[16:31]
    ds_read_b128 a[132:135], v193 offset:16384
    v_exp_f32 v4, v4
    v_add_f32 v217, v217, v3
    v_cvt_pk_bf16_f32 v1, v2, v3
    v_mfma_f32_32x32x16_bf16 a[32:47], a[148:151], v[40:43], a[32:47]
    ds_read_b128 a[136:139], v194 offset:16384
    v_exp_f32 v5, v5
    v_add_f32 v217, v217, v4
    v_exp_f32_e64 v6, v6
    v_mfma_f32_32x32x16_bf16 a[48:63], a[148:151], v[56:59], a[48:63]
    ds_read_b128 a[140:143], v195 offset:16384
    v_add_f32_e64 v217, v217, v5
    v_cvt_pk_bf16_f32 v2, v4, v5
    v_exp_f32 v7, v7
    v_add_f32 v217, v217, v6
    v_mfma_f32_32x32x16_bf16 a[64:79], a[152:155], v[40:43], a[64:79]
    v_exp_f32 v16, v16
    v_add_f32 v217, v217, v7
    v_cvt_pk_bf16_f32 v3, v6, v7
    v_mfma_f32_32x32x16_bf16 a[80:95], a[152:155], v[56:59], a[80:95]
    v_exp_f32 v17, v17
    v_add_f32 v218, v218, v16
    v_exp_f32_e64 v18, v18
    v_mfma_f32_32x32x16_bf16 a[96:111], a[156:159], v[40:43], a[96:111]
    v_add_f32_e64 v218, v218, v17
    v_cvt_pk_bf16_f32 v16, v16, v17
    v_exp_f32_e64 v19, v19
    v_mfma_f32_32x32x16_bf16 a[112:127], a[156:159], v[56:59], a[112:127]
    v_add_f32 v218, v218, v18
    s_waitcnt lgkmcnt(0)
    s_mov_b32 s35, 0
.p2align 3
LOOP_adaLN_cond___1:
    v_mfma_f32_32x32x16_bf16 v[32:47], a[128:131], v[128:131], v[64:79]
    ds_read_b128 a[144:147], v196 offset:16384
    v_exp_f32 v20, v20
    v_add_f32 v218, v218, v19
    v_cvt_pk_bf16_f32 v17, v18, v19
    v_mfma_f32_32x32x16_bf16 v[48:63], a[128:131], v[132:135], v[80:95]
    ds_read_b128 a[148:151], v197 offset:16384
    v_exp_f32 v21, v21
    v_add_f32 v218, v218, v20
    s_add_u32 s37, s38, 8192
    s_and_b32 s37, s37, 0x1ffff
    v_mfma_f32_32x32x16_bf16 v[32:47], a[132:135], v[136:139], v[32:47]
    v_exp_f32 v22, v22
    v_add_f32 v218, v218, v21
    v_cvt_pk_bf16_f32 v18, v20, v21
    v_mfma_f32_32x32x16_bf16 v[48:63], a[132:135], v[140:143], v[48:63]
    ds_read_b128 a[152:155], v198 offset:16384
    v_exp_f32 v23, v23
    v_add_f32 v218, v218, v22
    v_mfma_f32_32x32x16_bf16 v[32:47], a[136:139], v[144:147], v[32:47]
    ds_read_b128 a[156:159], v199 offset:16384
    v_exp_f32 v8, v8
    v_add_f32 v218, v218, v23
    v_cvt_pk_bf16_f32 v19, v22, v23
    s_add_u32 m0, s52, 32768
    v_mfma_f32_32x32x16_bf16 v[48:63], a[136:139], v[148:151], v[48:63]
    v_exp_f32 v9, v9
    v_add_f32 v217, v217, v8
    v_mfma_f32_32x32x16_bf16 v[32:47], a[140:143], v[152:155], v[32:47]
    v_exp_f32 v10, v10
    v_add_f32 v217, v217, v9
    v_cvt_pk_bf16_f32 v8, v8, v9
    v_mfma_f32_32x32x16_bf16 v[48:63], a[140:143], v[156:159], v[48:63]
    v_exp_f32 v11, v11
    v_add_f32_e64 v217, v217, v10
    s_waitcnt lgkmcnt(0)
    v_mfma_f32_32x32x16_bf16 v[32:47], a[144:147], v[160:163], v[32:47]
    ds_read_b64_tr_b16 a[128:129], v200 offset:16384
    ds_read_b64_tr_b16 a[130:131], v200 offset:18432
    v_exp_f32 v12, v12
    v_add_f32 v217, v217, v11
    v_cvt_pk_bf16_f32 v9, v10, v11
    v_mfma_f32_32x32x16_bf16 v[48:63], a[144:147], v[164:167], v[48:63]
    buffer_load_dwordx4 v214, s[16:19], s38 offen lds
    v_exp_f32 v13, v13
    v_add_f32 v217, v217, v12
    v_mfma_f32_32x32x16_bf16 v[32:47], a[148:151], v[168:171], v[32:47]
    ds_read_b64_tr_b16 a[132:133], v201 offset:16384
    ds_read_b64_tr_b16 a[134:135], v201 offset:18432
    v_exp_f32 v14, v14
    v_add_f32 v217, v217, v13
    v_cvt_pk_bf16_f32 v10, v12, v13
    v_mfma_f32_32x32x16_bf16 v[48:63], a[148:151], v[172:175], v[48:63]
    ds_read_b64_tr_b16 a[136:137], v202 offset:16384
    ds_read_b64_tr_b16 a[138:139], v202 offset:18432
    v_exp_f32 v15, v15
    v_add_f32 v217, v217, v14
    v_mfma_f32_32x32x16_bf16 v[32:47], a[152:155], v[176:179], v[32:47]
    ds_read_b64_tr_b16 a[140:141], v203 offset:16384
    v_exp_f32 v24, v24
    v_add_f32 v217, v217, v15
    v_cvt_pk_bf16_f32 v11, v14, v15
    v_mfma_f32_32x32x16_bf16 v[48:63], a[152:155], v[180:183], v[48:63]
    ds_read_b64_tr_b16 a[142:143], v203 offset:18432
    v_exp_f32 v25, v25
    v_add_f32 v218, v218, v24
    v_mfma_f32_32x32x16_bf16 v[32:47], a[156:159], v[184:187], v[32:47]
    v_exp_f32 v26, v26
    v_add_f32 v218, v218, v25
    v_cvt_pk_bf16_f32 v24, v24, v25
    v_mfma_f32_32x32x16_bf16 v[48:63], a[156:159], v[188:191], v[48:63]
    buffer_load_dwordx4 v214, s[16:19], s38 offen offset:1024 lds
    v_exp_f32 v27, v27
    v_add_f32_e64 v218, v218, v26
    s_waitcnt lgkmcnt(0)
    v_mfma_f32_32x32x16_bf16 a[0:15], a[128:131], v[0:3], a[0:15]
    ds_read_b64_tr_b16 a[144:145], v200 offset:20480
    v_exp_f32 v28, v28
    v_add_f32 v218, v218, v27
    v_cvt_pk_bf16_f32 v25, v26, v27
    s_add_u32 m0, s52, 0
    v_mfma_f32_32x32x16_bf16 a[16:31], a[128:131], v[16:19], a[16:31]
    ds_read_b64_tr_b16 a[146:147], v200 offset:22528
    ds_read_b64_tr_b16 a[148:149], v201 offset:20480
    v_exp_f32 v29, v29
    v_add_f32_e64 v218, v218, v28
    v_mfma_f32_32x32x16_bf16 a[32:47], a[132:135], v[0:3], a[32:47]
    ds_read_b64_tr_b16 a[150:151], v201 offset:22528
    ds_read_b64_tr_b16 a[152:153], v202 offset:20480
    v_exp_f32 v30, v30
    v_add_f32 v218, v218, v29
    v_cvt_pk_bf16_f32 v26, v28, v29
    v_mfma_f32_32x32x16_bf16 a[48:63], a[132:135], v[16:19], a[48:63]
    buffer_load_dwordx4 v212, s[12:15], s37 offen lds
    v_exp_f32 v31, v31
    v_add_f32 v218, v218, v30
    v_mfma_f32_32x32x16_bf16 a[64:79], a[136:139], v[0:3], a[64:79]
    ds_read_b64_tr_b16 a[154:155], v202 offset:22528
    ds_read_b64_tr_b16 a[156:157], v203 offset:20480
    v_add_f32_e64 v218, v218, v31
    v_cvt_pk_bf16_f32 v27, v30, v31
    v_exp_f32_e64 v32, v32
    v_mfma_f32_32x32x16_bf16 a[80:95], a[136:139], v[16:19], a[80:95]
    ds_read_b64_tr_b16 a[158:159], v203 offset:22528
    v_exp_f32 v33, v33
    v_add_f32 v217, v217, v32
    v_mfma_f32_32x32x16_bf16 a[96:111], a[140:143], v[0:3], a[96:111]
    v_exp_f32 v34, v34
    v_add_f32 v217, v217, v33
    v_cvt_pk_bf16_f32 v32, v32, v33
    v_mfma_f32_32x32x16_bf16 a[112:127], a[140:143], v[16:19], a[112:127]
    v_exp_f32 v35, v35
    v_add_f32_e64 v217, v217, v34
    s_waitcnt lgkmcnt(0)
    v_mfma_f32_32x32x16_bf16 a[0:15], a[144:147], v[8:11], a[0:15]
    buffer_load_dwordx4 v213, s[12:15], s37 offen offset:1024 lds
    v_exp_f32 v36, v36
    v_add_f32 v217, v217, v35
    v_cvt_pk_bf16_f32 v33, v34, v35
    v_mfma_f32_32x32x16_bf16 a[16:31], a[144:147], v[24:27], a[16:31]
    ds_read_b128 a[128:131], v192 offset:24576
    ds_read_b128 a[132:135], v193 offset:24576
    v_exp_f32 v37, v37
    v_add_f32 v217, v217, v36
    s_add_u32 m0, s52, 40960
    v_mfma_f32_32x32x16_bf16 a[32:47], a[148:151], v[8:11], a[32:47]
    v_exp_f32 v38, v38
    v_add_f32 v217, v217, v37
    v_cvt_pk_bf16_f32 v34, v36, v37
    v_mfma_f32_32x32x16_bf16 a[48:63], a[148:151], v[24:27], a[48:63]
    buffer_load_dwordx4 v214, s[16:19], s37 offen lds
    v_exp_f32 v39, v39
    v_add_f32 v217, v217, v38
    v_mfma_f32_32x32x16_bf16 a[64:79], a[152:155], v[8:11], a[64:79]
    ds_read_b128 a[136:139], v194 offset:24576
    ds_read_b128 a[140:143], v195 offset:24576
    v_exp_f32 v48, v48
    v_add_f32 v217, v217, v39
    v_cvt_pk_bf16_f32 v35, v38, v39
    v_mfma_f32_32x32x16_bf16 a[80:95], a[152:155], v[24:27], a[80:95]
    buffer_load_dwordx4 v214, s[16:19], s37 offen offset:1024 lds
    v_exp_f32 v49, v49
    v_add_f32 v218, v218, v48
    v_mfma_f32_32x32x16_bf16 a[96:111], a[156:159], v[8:11], a[96:111]
    v_exp_f32 v50, v50
    v_add_f32 v218, v218, v49
    v_cvt_pk_bf16_f32 v48, v48, v49
    s_add_u32 s38, s37, 8192
    s_and_b32 s38, s38, 0x1ffff
    v_mfma_f32_32x32x16_bf16 a[112:127], a[156:159], v[24:27], a[112:127]
    v_exp_f32 v51, v51
    v_add_f32_e64 v218, v218, v50
    s_waitcnt lgkmcnt(0)
    v_mfma_f32_32x32x16_bf16 v[0:15], a[128:131], v[128:131], v[64:79]
    ds_read_b128 a[144:147], v196 offset:24576
    v_exp_f32 v52, v52
    v_add_f32 v218, v218, v51
    v_cvt_pk_bf16_f32 v49, v50, v51
    s_add_u32 m0, s52, 8192
    v_mfma_f32_32x32x16_bf16 v[16:31], a[128:131], v[132:135], v[80:95]
    ds_read_b128 a[148:151], v197 offset:24576
    v_exp_f32 v53, v53
    v_add_f32 v218, v218, v52
    v_mfma_f32_32x32x16_bf16 v[0:15], a[132:135], v[136:139], v[0:15]
    v_exp_f32 v54, v54
    v_add_f32 v218, v218, v53
    v_cvt_pk_bf16_f32 v50, v52, v53
    v_mfma_f32_32x32x16_bf16 v[16:31], a[132:135], v[140:143], v[16:31]
    ds_read_b128 a[152:155], v198 offset:24576
    v_exp_f32 v55, v55
    v_add_f32 v218, v218, v54
    v_mfma_f32_32x32x16_bf16 v[0:15], a[136:139], v[144:147], v[0:15]
    ds_read_b128 a[156:159], v199 offset:24576
    v_exp_f32 v40, v40
    v_add_f32 v218, v218, v55
    v_cvt_pk_bf16_f32 v51, v54, v55
    v_mfma_f32_32x32x16_bf16 v[16:31], a[136:139], v[148:151], v[16:31]
    buffer_load_dwordx4 v212, s[12:15], s38 offen lds
    v_exp_f32 v41, v41
    v_add_f32 v217, v217, v40
    v_mfma_f32_32x32x16_bf16 v[0:15], a[140:143], v[152:155], v[0:15]
    v_exp_f32 v42, v42
    v_add_f32 v217, v217, v41
    v_cvt_pk_bf16_f32 v40, v40, v41
    v_mfma_f32_32x32x16_bf16 v[16:31], a[140:143], v[156:159], v[16:31]
    buffer_load_dwordx4 v213, s[12:15], s38 offen offset:1024 lds
    v_exp_f32 v43, v43
    v_add_f32_e64 v217, v217, v42
    s_waitcnt lgkmcnt(0)
    v_mfma_f32_32x32x16_bf16 v[0:15], a[144:147], v[160:163], v[0:15]
    ds_read_b64_tr_b16 a[128:129], v200 offset:24576
    ds_read_b64_tr_b16 a[130:131], v200 offset:26624
    v_exp_f32 v44, v44
    v_add_f32 v217, v217, v43
    v_cvt_pk_bf16_f32 v41, v42, v43
    v_mfma_f32_32x32x16_bf16 v[16:31], a[144:147], v[164:167], v[16:31]
    ds_read_b64_tr_b16 a[132:133], v201 offset:24576
    v_exp_f32 v45, v45
    v_add_f32 v217, v217, v44
    v_mfma_f32_32x32x16_bf16 v[0:15], a[148:151], v[168:171], v[0:15]
    ds_read_b64_tr_b16 a[134:135], v201 offset:26624
    ds_read_b64_tr_b16 a[136:137], v202 offset:24576
    v_exp_f32 v46, v46
    v_add_f32 v217, v217, v45
    v_cvt_pk_bf16_f32 v42, v44, v45
    v_mfma_f32_32x32x16_bf16 v[16:31], a[148:151], v[172:175], v[16:31]
    buffer_load_dwordx4 a[192:195], v216, s[20:23], s66 offen offset:0
    v_exp_f32 v47, v47
    v_add_f32 v217, v217, v46
    v_mfma_f32_32x32x16_bf16 v[0:15], a[152:155], v[176:179], v[0:15]
    ds_read_b64_tr_b16 a[138:139], v202 offset:26624
    ds_read_b64_tr_b16 a[140:141], v203 offset:24576
    v_exp_f32 v56, v56
    v_add_f32 v217, v217, v47
    v_cvt_pk_bf16_f32 v43, v46, v47
    v_mfma_f32_32x32x16_bf16 v[16:31], a[152:155], v[180:183], v[16:31]
    ds_read_b64_tr_b16 a[142:143], v203 offset:26624
    v_exp_f32 v57, v57
    v_add_f32 v218, v218, v56
    v_mfma_f32_32x32x16_bf16 v[0:15], a[156:159], v[184:187], v[0:15]
    v_exp_f32 v58, v58
    v_add_f32 v218, v218, v57
    v_cvt_pk_bf16_f32 v56, v56, v57
    v_mfma_f32_32x32x16_bf16 v[16:31], a[156:159], v[188:191], v[16:31]
    v_exp_f32 v59, v59
    v_add_f32_e64 v218, v218, v58
    s_waitcnt lgkmcnt(0)
    v_mfma_f32_32x32x16_bf16 a[0:15], a[128:131], v[32:35], a[0:15]
    buffer_load_dwordx4 a[196:199], v216, s[20:23], s66 offen offset:1024
    v_exp_f32 v60, v60
    v_add_f32 v218, v218, v59
    v_cvt_pk_bf16_f32 v57, v58, v59
    v_mfma_f32_32x32x16_bf16 a[16:31], a[128:131], v[48:51], a[16:31]
    buffer_load_dwordx4 a[200:203], v216, s[20:23], s66 offen offset:2048
    v_exp_f32 v61, v61
    v_add_f32 v218, v218, v60
    v_mfma_f32_32x32x16_bf16 a[32:47], a[132:135], v[32:35], a[32:47]
    ds_read_b64_tr_b16 a[144:145], v200 offset:28672
    v_exp_f32 v62, v62
    v_add_f32 v218, v218, v61
    v_cvt_pk_bf16_f32 v58, v60, v61
    s_add_u32 s66, s66, 3072
    v_mfma_f32_32x32x16_bf16 a[48:63], a[132:135], v[48:51], a[48:63]
    ds_read_b64_tr_b16 a[146:147], v200 offset:30720
    ds_read_b64_tr_b16 a[148:149], v201 offset:28672
    ds_read_b64_tr_b16 a[150:151], v201 offset:30720
    v_exp_f32 v63, v63
    v_add_f32 v218, v218, v62
    v_mfma_f32_32x32x16_bf16 a[64:79], a[136:139], v[32:35], a[64:79]
    ds_read_b64_tr_b16 a[152:153], v202 offset:28672
    ds_read_b64_tr_b16 a[154:155], v202 offset:30720
    v_add_f32_e64 v218, v218, v63
    v_cvt_pk_bf16_f32 v59, v62, v63
    v_exp_f32_e64 v0, v0
    v_mfma_f32_32x32x16_bf16 a[80:95], a[136:139], v[48:51], a[80:95]
    ds_read_b64_tr_b16 a[156:157], v203 offset:28672
    ds_read_b64_tr_b16 a[158:159], v203 offset:30720
    v_exp_f32 v1, v1
    v_add_f32 v217, v217, v0
    v_mfma_f32_32x32x16_bf16 a[96:111], a[140:143], v[32:35], a[96:111]
    v_exp_f32 v2, v2
    v_add_f32 v217, v217, v1
    v_cvt_pk_bf16_f32 v0, v0, v1
    v_mfma_f32_32x32x16_bf16 a[112:127], a[140:143], v[48:51], a[112:127]
    buffer_load_dwordx4 a[204:207], v234, s[8:11], s65 offen
    s_add_u32 s65, s65, 2048
    buffer_load_dwordx4 a[208:211], v234, s[8:11], s65 offen
    s_add_u32 s65, s65, 2048
    buffer_load_dwordx4 a[212:215], v234, s[8:11], s65 offen
    s_add_u32 s65, s65, 2048
    v_exp_f32 v3, v3
    v_add_f32_e64 v217, v217, v2
    s_waitcnt lgkmcnt(0)
    v_mfma_f32_32x32x16_bf16 a[0:15], a[144:147], v[40:43], a[0:15]
    s_waitcnt vmcnt(6)
    s_barrier
    v_exp_f32 v4, v4
    v_add_f32 v217, v217, v3
    v_cvt_pk_bf16_f32 v1, v2, v3
    v_mfma_f32_32x32x16_bf16 a[16:31], a[144:147], v[56:59], a[16:31]
    ds_read_b128 a[128:131], v192 offset:0
    ds_read_b128 a[132:135], v193 offset:0
    v_exp_f32 v5, v5
    v_add_f32 v217, v217, v4
    v_mfma_f32_32x32x16_bf16 a[32:47], a[148:151], v[40:43], a[32:47]
    ds_read_b128 a[136:139], v194 offset:0
    v_exp_f32 v6, v6
    v_add_f32 v217, v217, v5
    v_cvt_pk_bf16_f32 v2, v4, v5
    v_mfma_f32_32x32x16_bf16 a[48:63], a[148:151], v[56:59], a[48:63]
    ds_read_b128 a[140:143], v195 offset:0
    v_exp_f32 v7, v7
    v_add_f32 v217, v217, v6
    v_mfma_f32_32x32x16_bf16 a[64:79], a[152:155], v[40:43], a[64:79]
    v_exp_f32 v16, v16
    v_add_f32 v217, v217, v7
    v_cvt_pk_bf16_f32 v3, v6, v7
    v_mfma_f32_32x32x16_bf16 a[80:95], a[152:155], v[56:59], a[80:95]
    v_exp_f32 v17, v17
    v_add_f32 v218, v218, v16
    v_mfma_f32_32x32x16_bf16 a[96:111], a[156:159], v[40:43], a[96:111]
    v_exp_f32 v18, v18
    v_add_f32 v218, v218, v17
    v_cvt_pk_bf16_f32 v16, v16, v17
    v_mfma_f32_32x32x16_bf16 a[112:127], a[156:159], v[56:59], a[112:127]
    v_exp_f32 v19, v19
    v_add_f32_e64 v218, v218, v18
    s_waitcnt lgkmcnt(0)
    v_mfma_f32_32x32x16_bf16 v[32:47], a[128:131], v[128:131], v[64:79]
    ds_read_b128 a[144:147], v196 offset:0
STUB4:
    s_cbranch_execz STUB8
    s_nop 0
    v_exp_f32 v20, v20
    v_add_f32 v218, v218, v19
    v_cvt_pk_bf16_f32 v17, v18, v19
    v_mfma_f32_32x32x16_bf16 v[48:63], a[128:131], v[132:135], v[80:95]
    ds_read_b128 a[148:151], v197 offset:0
    v_exp_f32 v21, v21
    v_add_f32 v218, v218, v20
    s_add_u32 s37, s38, 8192
    s_and_b32 s37, s37, 0x1ffff
    v_mfma_f32_32x32x16_bf16 v[32:47], a[132:135], v[136:139], v[32:47]
    v_exp_f32 v22, v22
    v_add_f32 v218, v218, v21
    v_cvt_pk_bf16_f32 v18, v20, v21
    v_mfma_f32_32x32x16_bf16 v[48:63], a[132:135], v[140:143], v[48:63]
    ds_read_b128 a[152:155], v198 offset:0
    v_exp_f32 v23, v23
    v_add_f32 v218, v218, v22
    v_mfma_f32_32x32x16_bf16 v[32:47], a[136:139], v[144:147], v[32:47]
    ds_read_b128 a[156:159], v199 offset:0
    v_exp_f32 v8, v8
    v_add_f32 v218, v218, v23
    v_cvt_pk_bf16_f32 v19, v22, v23
    s_add_u32 m0, s52, 49152
    v_mfma_f32_32x32x16_bf16 v[48:63], a[136:139], v[148:151], v[48:63]
    v_exp_f32 v9, v9
    v_add_f32 v217, v217, v8
    v_mfma_f32_32x32x16_bf16 v[32:47], a[140:143], v[152:155], v[32:47]
    v_exp_f32 v10, v10
    v_add_f32 v217, v217, v9
    v_cvt_pk_bf16_f32 v8, v8, v9
    v_mfma_f32_32x32x16_bf16 v[48:63], a[140:143], v[156:159], v[48:63]
    v_exp_f32 v11, v11
    v_add_f32_e64 v217, v217, v10
    s_waitcnt lgkmcnt(0)
    v_mfma_f32_32x32x16_bf16 v[32:47], a[144:147], v[160:163], v[32:47]
    ds_read_b64_tr_b16 a[128:129], v200 offset:0
    ds_read_b64_tr_b16 a[130:131], v200 offset:2048
    v_exp_f32 v12, v12
    v_add_f32 v217, v217, v11
    v_cvt_pk_bf16_f32 v9, v10, v11
    v_mfma_f32_32x32x16_bf16 v[48:63], a[144:147], v[164:167], v[48:63]
    buffer_load_dwordx4 v214, s[16:19], s38 offen lds
    v_exp_f32 v13, v13
    v_add_f32 v217, v217, v12
    v_mfma_f32_32x32x16_bf16 v[32:47], a[148:151], v[168:171], v[32:47]
    ds_read_b64_tr_b16 a[132:133], v201 offset:0
    ds_read_b64_tr_b16 a[134:135], v201 offset:2048
    v_exp_f32 v14, v14
    v_add_f32 v217, v217, v13
    v_cvt_pk_bf16_f32 v10, v12, v13
    v_mfma_f32_32x32x16_bf16 v[48:63], a[148:151], v[172:175], v[48:63]
    ds_read_b64_tr_b16 a[136:137], v202 offset:0
    ds_read_b64_tr_b16 a[138:139], v202 offset:2048
    v_exp_f32 v15, v15
    v_add_f32 v217, v217, v14
    v_mfma_f32_32x32x16_bf16 v[32:47], a[152:155], v[176:179], v[32:47]
    ds_read_b64_tr_b16 a[140:141], v203 offset:0
    v_exp_f32 v24, v24
    v_add_f32 v217, v217, v15
    v_cvt_pk_bf16_f32 v11, v14, v15
    v_mfma_f32_32x32x16_bf16 v[48:63], a[152:155], v[180:183], v[48:63]
    ds_read_b64_tr_b16 a[142:143], v203 offset:2048
    v_exp_f32 v25, v25
    v_add_f32 v218, v218, v24
    v_mfma_f32_32x32x16_bf16 v[32:47], a[156:159], v[184:187], v[32:47]
    v_exp_f32 v26, v26
    v_add_f32 v218, v218, v25
    v_cvt_pk_bf16_f32 v24, v24, v25
    v_mfma_f32_32x32x16_bf16 v[48:63], a[156:159], v[188:191], v[48:63]
    buffer_load_dwordx4 v214, s[16:19], s38 offen offset:1024 lds
    v_exp_f32 v27, v27
    v_add_f32_e64 v218, v218, v26
    s_waitcnt lgkmcnt(0)
    v_mfma_f32_32x32x16_bf16 a[0:15], a[128:131], v[0:3], a[0:15]
    ds_read_b64_tr_b16 a[144:145], v200 offset:4096
    v_exp_f32 v28, v28
    v_add_f32 v218, v218, v27
    v_cvt_pk_bf16_f32 v25, v26, v27
    s_add_u32 m0, s52, 16384
    v_mfma_f32_32x32x16_bf16 a[16:31], a[128:131], v[16:19], a[16:31]
    ds_read_b64_tr_b16 a[146:147], v200 offset:6144
    ds_read_b64_tr_b16 a[148:149], v201 offset:4096
    v_exp_f32 v29, v29
    v_add_f32 v218, v218, v28
    v_mfma_f32_32x32x16_bf16 a[32:47], a[132:135], v[0:3], a[32:47]
    ds_read_b64_tr_b16 a[150:151], v201 offset:6144
    ds_read_b64_tr_b16 a[152:153], v202 offset:4096
    v_exp_f32 v30, v30
    v_add_f32 v218, v218, v29
    v_cvt_pk_bf16_f32 v26, v28, v29
    v_mfma_f32_32x32x16_bf16 a[48:63], a[132:135], v[16:19], a[48:63]
    buffer_load_dwordx4 v212, s[12:15], s37 offen lds
    v_exp_f32 v31, v31
    v_add_f32 v218, v218, v30
    v_mfma_f32_32x32x16_bf16 a[64:79], a[136:139], v[0:3], a[64:79]
    ds_read_b64_tr_b16 a[154:155], v202 offset:6144
    ds_read_b64_tr_b16 a[156:157], v203 offset:4096
    v_add_f32_e64 v218, v218, v31
    v_cvt_pk_bf16_f32 v27, v30, v31
    v_exp_f32_e64 v32, v32
    v_mfma_f32_32x32x16_bf16 a[80:95], a[136:139], v[16:19], a[80:95]
    ds_read_b64_tr_b16 a[158:159], v203 offset:6144
    v_exp_f32 v33, v33
    v_add_f32 v217, v217, v32
    v_mfma_f32_32x32x16_bf16 a[96:111], a[140:143], v[0:3], a[96:111]
    v_exp_f32 v34, v34
    v_add_f32 v217, v217, v33
    v_cvt_pk_bf16_f32 v32, v32, v33
    v_mfma_f32_32x32x16_bf16 a[112:127], a[140:143], v[16:19], a[112:127]
    v_exp_f32 v35, v35
    v_add_f32_e64 v217, v217, v34
    s_waitcnt lgkmcnt(0)
    v_mfma_f32_32x32x16_bf16 a[0:15], a[144:147], v[8:11], a[0:15]
    buffer_load_dwordx4 v213, s[12:15], s37 offen offset:1024 lds
    v_exp_f32 v36, v36
    v_add_f32 v217, v217, v35
    v_cvt_pk_bf16_f32 v33, v34, v35
    v_mfma_f32_32x32x16_bf16 a[16:31], a[144:147], v[24:27], a[16:31]
    ds_read_b128 a[128:131], v192 offset:8192
    ds_read_b128 a[132:135], v193 offset:8192
    v_exp_f32 v37, v37
    v_add_f32 v217, v217, v36
    s_add_u32 m0, s52, 57344
    v_mfma_f32_32x32x16_bf16 a[32:47], a[148:151], v[8:11], a[32:47]
    v_exp_f32 v38, v38
    v_add_f32 v217, v217, v37
    v_cvt_pk_bf16_f32 v34, v36, v37
    v_mfma_f32_32x32x16_bf16 a[48:63], a[148:151], v[24:27], a[48:63]
    buffer_load_dwordx4 v214, s[16:19], s37 offen lds
    v_exp_f32 v39, v39
    v_add_f32 v217, v217, v38
    v_mfma_f32_32x32x16_bf16 a[64:79], a[152:155], v[8:11], a[64:79]
    ds_read_b128 a[136:139], v194 offset:8192
    ds_read_b128 a[140:143], v195 offset:8192
    v_exp_f32 v48, v48
    v_add_f32 v217, v217, v39
    v_cvt_pk_bf16_f32 v35, v38, v39
    v_mfma_f32_32x32x16_bf16 a[80:95], a[152:155], v[24:27], a[80:95]
    buffer_load_dwordx4 v214, s[16:19], s37 offen offset:1024 lds
    v_exp_f32 v49, v49
    v_add_f32 v218, v218, v48
    v_mfma_f32_32x32x16_bf16 a[96:111], a[156:159], v[8:11], a[96:111]
    v_exp_f32 v50, v50
    v_add_f32 v218, v218, v49
    v_cvt_pk_bf16_f32 v48, v48, v49
    s_add_u32 s38, s37, 8192
    s_and_b32 s38, s38, 0x1ffff
    v_mfma_f32_32x32x16_bf16 a[112:127], a[156:159], v[24:27], a[112:127]
    v_exp_f32 v51, v51
    v_add_f32_e64 v218, v218, v50
    s_waitcnt lgkmcnt(0)
    v_mfma_f32_32x32x16_bf16 v[0:15], a[128:131], v[128:131], v[64:79]
    ds_read_b128 a[144:147], v196 offset:8192
    v_exp_f32 v52, v52
    v_add_f32 v218, v218, v51
    v_cvt_pk_bf16_f32 v49, v50, v51
    s_add_u32 m0, s52, 24576
    v_mfma_f32_32x32x16_bf16 v[16:31], a[128:131], v[132:135], v[80:95]
    ds_read_b128 a[148:151], v197 offset:8192
    v_exp_f32 v53, v53
    v_add_f32 v218, v218, v52
    v_mfma_f32_32x32x16_bf16 v[0:15], a[132:135], v[136:139], v[0:15]
    v_exp_f32 v54, v54
    v_add_f32 v218, v218, v53
    v_cvt_pk_bf16_f32 v50, v52, v53
    v_mfma_f32_32x32x16_bf16 v[16:31], a[132:135], v[140:143], v[16:31]
    ds_read_b128 a[152:155], v198 offset:8192
    v_exp_f32 v55, v55
    v_add_f32 v218, v218, v54
    v_mfma_f32_32x32x16_bf16 v[0:15], a[136:139], v[144:147], v[0:15]
    ds_read_b128 a[156:159], v199 offset:8192
    v_exp_f32 v40, v40
    v_add_f32 v218, v218, v55
    v_cvt_pk_bf16_f32 v51, v54, v55
    v_mfma_f32_32x32x16_bf16 v[16:31], a[136:139], v[148:151], v[16:31]
    buffer_load_dwordx4 v212, s[12:15], s38 offen lds
    v_exp_f32 v41, v41
    v_add_f32 v217, v217, v40
    v_mfma_f32_32x32x16_bf16 v[0:15], a[140:143], v[152:155], v[0:15]
    v_exp_f32 v42, v42
    v_add_f32 v217, v217, v41
    v_cvt_pk_bf16_f32 v40, v40, v41
    v_mfma_f32_32x32x16_bf16 v[16:31], a[140:143], v[156:159], v[16:31]
    buffer_load_dwordx4 v213, s[12:15], s38 offen offset:1024 lds
    v_exp_f32 v43, v43
    v_add_f32_e64 v217, v217, v42
    s_waitcnt lgkmcnt(0)
    v_mfma_f32_32x32x16_bf16 v[0:15], a[144:147], v[160:163], v[0:15]
    ds_read_b64_tr_b16 a[128:129], v200 offset:8192
    ds_read_b64_tr_b16 a[130:131], v200 offset:10240
    v_exp_f32 v44, v44
    v_add_f32 v217, v217, v43
    v_cvt_pk_bf16_f32 v41, v42, v43
    v_mfma_f32_32x32x16_bf16 v[16:31], a[144:147], v[164:167], v[16:31]
    ds_read_b64_tr_b16 a[132:133], v201 offset:8192
    v_exp_f32 v45, v45
    v_add_f32 v217, v217, v44
    v_mfma_f32_32x32x16_bf16 v[0:15], a[148:151], v[168:171], v[0:15]
    ds_read_b64_tr_b16 a[134:135], v201 offset:10240
    ds_read_b64_tr_b16 a[136:137], v202 offset:8192
    v_exp_f32 v46, v46
    v_add_f32 v217, v217, v45
    v_cvt_pk_bf16_f32 v42, v44, v45
    v_mfma_f32_32x32x16_bf16 v[16:31], a[148:151], v[172:175], v[16:31]
    buffer_load_dwordx4 a[224:227], v233, s[40:43], s64 offen
    v_exp_f32 v47, v47
    v_add_f32 v217, v217, v46
    v_mfma_f32_32x32x16_bf16 v[0:15], a[152:155], v[176:179], v[0:15]
    ds_read_b64_tr_b16 a[138:139], v202 offset:10240
    ds_read_b64_tr_b16 a[140:141], v203 offset:8192
    v_exp_f32 v56, v56
    v_add_f32 v217, v217, v47
    v_cvt_pk_bf16_f32 v43, v46, v47
    v_mfma_f32_32x32x16_bf16 v[16:31], a[152:155], v[180:183], v[16:31]
    ds_read_b64_tr_b16 a[142:143], v203 offset:10240
    v_exp_f32 v57, v57
    v_add_f32 v218, v218, v56
    v_mfma_f32_32x32x16_bf16 v[0:15], a[156:159], v[184:187], v[0:15]
    v_exp_f32 v58, v58
    v_add_f32 v218, v218, v57
    v_cvt_pk_bf16_f32 v56, v56, v57
    v_mfma_f32_32x32x16_bf16 v[16:31], a[156:159], v[188:191], v[16:31]
    v_exp_f32 v59, v59
    v_add_f32_e64 v218, v218, v58
    s_waitcnt lgkmcnt(0)
    v_mfma_f32_32x32x16_bf16 a[0:15], a[128:131], v[32:35], a[0:15]
    ds_read_b64_tr_b16 a[144:145], v200 offset:12288
    ds_read_b64_tr_b16 a[146:147], v200 offset:14336
    v_exp_f32 v60, v60
    v_add_f32 v218, v218, v59
    v_cvt_pk_bf16_f32 v57, v58, v59
    v_mfma_f32_32x32x16_bf16 a[16:31], a[128:131], v[48:51], a[16:31]
    ds_read_b64_tr_b16 a[148:149], v201 offset:12288
    v_exp_f32 v61, v61
    v_add_f32 v218, v218, v60
    v_mfma_f32_32x32x16_bf16 a[32:47], a[132:135], v[32:35], a[32:47]
    buffer_load_dwordx4 a[228:231], v233, s[44:47], s64 offen
    s_add_u32 s64, s64, 3584
    v_exp_f32 v62, v62
    v_add_f32 v218, v218, v61
    v_cvt_pk_bf16_f32 v58, v60, v61
    v_mfma_f32_32x32x16_bf16 a[48:63], a[132:135], v[48:51], a[48:63]
    ds_read_b64_tr_b16 a[150:151], v201 offset:14336
    ds_read_b64_tr_b16 a[152:153], v202 offset:12288
    ds_read_b64_tr_b16 a[154:155], v202 offset:14336
    v_exp_f32 v63, v63
    v_add_f32 v218, v218, v62
    v_mfma_f32_32x32x16_bf16 a[64:79], a[136:139], v[32:35], a[64:79]
    ds_read_b64_tr_b16 a[156:157], v203 offset:12288
    v_add_f32_e64 v218, v218, v63
    v_cvt_pk_bf16_f32 v59, v62, v63
    v_exp_f32_e64 v0, v0
    v_mfma_f32_32x32x16_bf16 a[80:95], a[136:139], v[48:51], a[80:95]
    ds_read_b64_tr_b16 a[158:159], v203 offset:14336
    v_exp_f32 v1, v1
    v_add_f32 v217, v217, v0
    v_mfma_f32_32x32x16_bf16 a[96:111], a[140:143], v[32:35], a[96:111]
    buffer_load_dwordx4 a[232:235], v233, s[40:43], s64 offen
    v_exp_f32 v2, v2
    v_add_f32 v217, v217, v1
    v_cvt_pk_bf16_f32 v0, v0, v1
    v_mfma_f32_32x32x16_bf16 a[112:127], a[140:143], v[48:51], a[112:127]
    buffer_load_dwordx4 a[236:239], v233, s[44:47], s64 offen
    s_add_u32 s64, s64, 3584
    v_exp_f32 v3, v3
    v_add_f32_e64 v217, v217, v2
    s_waitcnt lgkmcnt(0)
    v_mfma_f32_32x32x16_bf16 a[0:15], a[144:147], v[40:43], a[0:15]
    s_waitcnt vmcnt(4)
    s_barrier
    v_exp_f32 v4, v4
    v_add_f32 v217, v217, v3
    v_cvt_pk_bf16_f32 v1, v2, v3
    v_mfma_f32_32x32x16_bf16 a[16:31], a[144:147], v[56:59], a[16:31]
    ds_read_b128 a[128:131], v192 offset:16384
    ds_read_b128 a[132:135], v193 offset:16384
    v_exp_f32 v5, v5
    v_add_f32 v217, v217, v4
    v_mfma_f32_32x32x16_bf16 a[32:47], a[148:151], v[40:43], a[32:47]
    ds_read_b128 a[136:139], v194 offset:16384
    v_exp_f32 v6, v6
    v_add_f32 v217, v217, v5
    v_cvt_pk_bf16_f32 v2, v4, v5
    v_mfma_f32_32x32x16_bf16 a[48:63], a[148:151], v[56:59], a[48:63]
    ds_read_b128 a[140:143], v195 offset:16384
    v_exp_f32 v7, v7
    v_add_f32 v217, v217, v6
    v_mfma_f32_32x32x16_bf16 a[64:79], a[152:155], v[40:43], a[64:79]
    v_exp_f32 v16, v16
    v_add_f32 v217, v217, v7
    v_cvt_pk_bf16_f32 v3, v6, v7
    v_mfma_f32_32x32x16_bf16 a[80:95], a[152:155], v[56:59], a[80:95]
    v_exp_f32 v17, v17
    v_add_f32 v218, v218, v16
    v_mfma_f32_32x32x16_bf16 a[96:111], a[156:159], v[40:43], a[96:111]
    v_exp_f32 v18, v18
    v_add_f32 v218, v218, v17
    v_cvt_pk_bf16_f32 v16, v16, v17
    v_mfma_f32_32x32x16_bf16 a[112:127], a[156:159], v[56:59], a[112:127]
    v_exp_f32 v19, v19
    v_add_f32 v218, v218, v18
    s_waitcnt lgkmcnt(0)
    s_add_u32 s35, s35, 1
    s_cmp_lt_u32 s35, 3
    s_cbranch_scc1 LOOP_adaLN_cond___1
    v_mfma_f32_32x32x16_bf16 v[32:47], a[128:131], v[128:131], v[64:79]
    ds_read_b128 a[144:147], v196 offset:16384
    v_exp_f32 v20, v20
    v_add_f32 v218, v218, v19
    v_cvt_pk_bf16_f32 v17, v18, v19
    s_lshl_b32 s31, s28, 12
    v_mfma_f32_32x32x16_bf16 v[48:63], a[128:131], v[132:135], v[80:95]
    ds_read_b128 a[148:151], v197 offset:16384
    v_exp_f32 v21, v21
    v_add_f32_e64 v218, v218, v20
    s_lshl_b32 s57, s28, 3
    s_sub_u32 s57, s57, s6
    v_mfma_f32_32x32x16_bf16 v[32:47], a[132:135], v[136:139], v[32:47]
    v_exp_f32 v22, v22
    v_add_f32 v218, v218, v21
    v_cvt_pk_bf16_f32 v18, v20, v21
    s_add_u32 m0, s34, 0
    v_mfma_f32_32x32x16_bf16 v[48:63], a[132:135], v[140:143], v[48:63]
    v_exp_f32 v23, v23
    v_add_f32 v218, v218, v22
    s_add_u32 s56, s57, 0
    s_and_b32 s56, s56, 31
    s_lshl_b32 s56, s56, 10
    v_mfma_f32_32x32x16_bf16 v[32:47], a[136:139], v[144:147], v[32:47]
    ds_read_b128 a[152:155], v198 offset:16384
    v_exp_f32 v8, v8
    v_add_f32 v218, v218, v23
    v_cvt_pk_bf16_f32 v19, v22, v23
    v_add_u32_e64 v244, s56, v215
    v_mfma_f32_32x32x16_bf16 v[48:63], a[136:139], v[148:151], v[48:63]
    ds_read_b128 a[156:159], v199 offset:16384
    v_exp_f32 v9, v9
    v_add_f32 v217, v217, v8
    v_mfma_f32_32x32x16_bf16 v[32:47], a[140:143], v[152:155], v[32:47]
    v_exp_f32 v10, v10
    v_add_f32 v217, v217, v9
    v_cvt_pk_bf16_f32 v8, v8, v9
    v_mfma_f32_32x32x16_bf16 v[48:63], a[140:143], v[156:159], v[48:63]
    buffer_load_dwordx4 v208, s[20:23], s55 offen lds
    v_exp_f32 v11, v11
    v_add_f32 v217, v217, v10
    s_add_u32 s56, s57, 2
    s_and_b32 s56, s56, 31
    s_lshl_b32 s56, s56, 10
    s_waitcnt lgkmcnt(0)
    v_mfma_f32_32x32x16_bf16 v[32:47], a[144:147], v[160:163], v[32:47]
    ds_read_b64_tr_b16 a[128:129], v200 offset:16384
    v_exp_f32 v12, v12
    v_add_f32 v217, v217, v11
    v_cvt_pk_bf16_f32 v9, v10, v11
    v_add_u32_e64 v245, s56, v215
    v_mfma_f32_32x32x16_bf16 v[48:63], a[144:147], v[164:167], v[48:63]
    buffer_load_dwordx4 v209, s[20:23], s55 offen offset:1024 lds
    v_exp_f32 v13, v13
    v_add_f32 v217, v217, v12
    s_add_u32 s56, s57, 4
    s_and_b32 s56, s56, 31
    s_lshl_b32 s56, s56, 10
    v_add_u32 v246, s56, v215
    v_mfma_f32_32x32x16_bf16 v[32:47], a[148:151], v[168:171], v[32:47]
    buffer_load_dwordx4 v210, s[20:23], s55 offen offset:2048 lds
    v_exp_f32 v14, v14
    v_add_f32 v217, v217, v13
    v_cvt_pk_bf16_f32 v10, v12, v13
    s_add_u32 s56, s57, 6
    s_and_b32 s56, s56, 31
    s_lshl_b32 s56, s56, 10
    v_mfma_f32_32x32x16_bf16 v[48:63], a[148:151], v[172:175], v[48:63]
    buffer_load_dwordx4 v211, s[20:23], s55 offen offset:3072 lds
    v_exp_f32 v15, v15
    v_add_f32 v217, v217, v14
    v_add_u32 v247, s56, v215
    v_mfma_f32_32x32x16_bf16 v[32:47], a[152:155], v[176:179], v[32:47]
    v_exp_f32 v24, v24
    v_add_f32 v217, v217, v15
    v_cvt_pk_bf16_f32 v11, v14, v15
    s_add_u32 s55, s55, 16384
    v_lshl_add_u32 v227, v221, 3, v223
    v_lshlrev_b32_e64 v227, 8, v227
    v_mfma_f32_32x32x16_bf16 v[48:63], a[152:155], v[180:183], v[48:63]
    ds_read_b64_tr_b16 a[130:131], v200 offset:18432
    ds_read_b64_tr_b16 a[132:133], v201 offset:16384
    ds_read_b64_tr_b16 a[134:135], v201 offset:18432
    ds_read_b64_tr_b16 a[136:137], v202 offset:16384
    ds_read_b64_tr_b16 a[138:139], v202 offset:18432
    ds_read_b64_tr_b16 a[140:141], v203 offset:16384
    ds_read_b64_tr_b16 a[142:143], v203 offset:18432
    v_exp_f32 v25, v25
    v_add_f32 v218, v218, v24
    s_add_u32 m0, s34, 4096
    v_and_b32_e64 v228, 1, v220
    v_mfma_f32_32x32x16_bf16 v[32:47], a[156:159], v[184:187], v[32:47]
    buffer_load_dwordx4 v208, s[20:23], s55 offen lds
    v_exp_f32 v26, v26
    v_add_f32 v218, v218, v25
    v_cvt_pk_bf16_f32 v24, v24, v25
    v_lshl_add_u32 v227, v228, 4, v227
    v_mfma_f32_32x32x16_bf16 v[48:63], a[156:159], v[188:191], v[48:63]
    buffer_load_dwordx4 v209, s[20:23], s55 offen offset:1024 lds
    v_exp_f32 v27, v27
    v_add_f32 v218, v218, v26
    v_add_u32 v227, s34, v227
    s_waitcnt lgkmcnt(0)
    v_mfma_f32_32x32x16_bf16 a[0:15], a[128:131], v[0:3], a[0:15]
    v_exp_f32 v28, v28
    v_add_f32 v218, v218, v27
    v_cvt_pk_bf16_f32 v25, v26, v27
    v_lshl_add_u32 v228, v225, 2, v223
    v_bfe_u32 v229, v220, 1, 1
    v_mfma_f32_32x32x16_bf16 a[16:31], a[128:131], v[16:19], a[16:31]
    buffer_load_dwordx4 v210, s[20:23], s55 offen offset:2048 lds
    v_exp_f32 v29, v29
    v_add_f32 v218, v218, v28
    v_xor_b32_e64 v228, v228, v229
    v_mfma_f32_32x32x16_bf16 a[32:47], a[132:135], v[0:3], a[32:47]
    buffer_load_dwordx4 v211, s[20:23], s55 offen offset:3072 lds
    v_exp_f32 v30, v30
    v_add_f32 v218, v218, v29
    v_cvt_pk_bf16_f32 v26, v28, v29
    v_lshl_add_u32 v204, v228, 5, v227
    v_xor_b32_e64 v205, 64, v204
    v_xor_b32 v206, 128, v204
    v_xor_b32 v207, 192, v204
    v_and_b32 v228, 15, v220
    v_lshlrev_b32 v228, 4, v228
    v_lshl_add_u32 v231, v221, 9, v228
    v_add_u32 v219, 32768, v231
    v_mfma_f32_32x32x16_bf16 a[48:63], a[132:135], v[16:19], a[48:63]
    ds_read_b64_tr_b16 a[144:145], v200 offset:20480
    v_exp_f32 v31, v31
    v_add_f32 v218, v218, v30
    s_add_u32 s55, s55, 16384
    s_and_b32 s55, s55, 0x7ffff
    v_mfma_f32_32x32x16_bf16 a[64:79], a[136:139], v[0:3], a[64:79]
    ds_read_b64_tr_b16 a[146:147], v200 offset:22528
    ds_read_b64_tr_b16 a[148:149], v201 offset:20480
    ds_read_b64_tr_b16 a[150:151], v201 offset:22528
    v_add_f32_e64 v218, v218, v31
    v_cvt_pk_bf16_f32 v27, v30, v31
    s_add_u32 m0, s34, 8192
    v_mfma_f32_32x32x16_bf16 a[80:95], a[136:139], v[16:19], a[80:95]
    ds_read_b64_tr_b16 a[152:153], v202 offset:20480
    ds_read_b64_tr_b16 a[154:155], v202 offset:22528
    ds_read_b64_tr_b16 a[156:157], v203 offset:20480
    ds_read_b64_tr_b16 a[158:159], v203 offset:22528
    v_exp_f32_e64 v32, v32
    v_mfma_f32_32x32x16_bf16 a[96:111], a[140:143], v[0:3], a[96:111]
    buffer_load_dwordx4 v208, s[20:23], s55 offen lds
    buffer_load_dwordx4 v209, s[20:23], s55 offen offset:1024 lds
    v_mfma_f32_32x32x16_bf16 a[112:127], a[140:143], v[16:19], a[112:127]
    v_exp_f32 v33, v33
    v_add_f32 v217, v217, v32
    v_exp_f32 v34, v34
    s_waitcnt lgkmcnt(0)
    v_mfma_f32_32x32x16_bf16 a[0:15], a[144:147], v[8:11], a[0:15]
    buffer_load_dwordx4 v210, s[20:23], s55 offen offset:2048 lds
    ds_read_b64_tr_b16 a[128:129], v200 offset:24576
    v_add_f32_e64 v217, v217, v33
    v_cvt_pk_bf16_f32 v32, v32, v33
    v_mfma_f32_32x32x16_bf16 a[16:31], a[144:147], v[24:27], a[16:31]
    buffer_load_dwordx4 v211, s[20:23], s55 offen offset:3072 lds
    v_exp_f32 v35, v35
    v_add_f32 v217, v217, v34
    v_mfma_f32_32x32x16_bf16 a[32:47], a[148:151], v[8:11], a[32:47]
    v_exp_f32 v36, v36
    v_add_f32 v217, v217, v35
    v_cvt_pk_bf16_f32 v33, v34, v35
    v_exp_f32_e64 v37, v37
    v_mfma_f32_32x32x16_bf16 a[48:63], a[148:151], v[24:27], a[48:63]
    v_add_f32 v217, v217, v36
    v_exp_f32 v38, v38
    v_add_f32_e64 v217, v217, v37
    v_cvt_pk_bf16_f32 v34, v36, v37
    s_add_u32 s55, s55, 16384
    v_mfma_f32_32x32x16_bf16 a[64:79], a[152:155], v[8:11], a[64:79]
    ds_read_b64_tr_b16 a[130:131], v200 offset:26624
    ds_read_b64_tr_b16 a[132:133], v201 offset:24576
    v_exp_f32 v39, v39
    v_add_f32 v217, v217, v38
    s_add_u32 m0, s34, 12288
    v_mfma_f32_32x32x16_bf16 a[80:95], a[152:155], v[24:27], a[80:95]
    buffer_load_dwordx4 v208, s[20:23], s55 offen lds
    ds_read_b64_tr_b16 a[134:135], v201 offset:26624
    ds_read_b64_tr_b16 a[136:137], v202 offset:24576
    ds_read_b64_tr_b16 a[138:139], v202 offset:26624
    ds_read_b64_tr_b16 a[140:141], v203 offset:24576
    ds_read_b64_tr_b16 a[142:143], v203 offset:26624
    v_exp_f32 v48, v48
    v_add_f32 v217, v217, v39
    v_cvt_pk_bf16_f32 v35, v38, v39
    v_mfma_f32_32x32x16_bf16 a[96:111], a[156:159], v[8:11], a[96:111]
    buffer_load_dwordx4 v209, s[20:23], s55 offen offset:1024 lds
    v_exp_f32 v49, v49
    v_add_f32 v218, v218, v48
    v_exp_f32 v50, v50
    v_add_f32 v218, v218, v49
    v_cvt_pk_bf16_f32 v48, v48, v49
    v_exp_f32 v51, v51
    v_add_f32 v218, v218, v50
    v_exp_f32 v52, v52
    v_add_f32 v218, v218, v51
    v_cvt_pk_bf16_f32 v49, v50, v51
    v_exp_f32 v53, v53
    v_add_f32 v218, v218, v52
    v_exp_f32 v54, v54
    v_add_f32 v218, v218, v53
    v_cvt_pk_bf16_f32 v50, v52, v53
    v_exp_f32 v55, v55
    v_add_f32 v218, v218, v54
    v_exp_f32 v40, v40
    v_add_f32 v218, v218, v55
    v_cvt_pk_bf16_f32 v51, v54, v55
    v_mfma_f32_32x32x16_bf16 a[112:127], a[156:159], v[24:27], a[112:127]
    buffer_load_dwordx4 v210, s[20:23], s55 offen offset:2048 lds
    buffer_load_dwordx4 v211, s[20:23], s55 offen offset:3072 lds
    s_waitcnt lgkmcnt(0)
    v_mfma_f32_32x32x16_bf16 a[0:15], a[128:131], v[32:35], a[0:15]
    ds_read_b64_tr_b16 a[144:145], v200 offset:28672
    v_exp_f32 v41, v41
    v_add_f32_e64 v217, v217, v40
    s_add_u32 s55, s55, 16384
    s_and_b32 s55, s55, 0x7ffff
    v_mfma_f32_32x32x16_bf16 a[16:31], a[128:131], v[48:51], a[16:31]
    ds_read_b64_tr_b16 a[146:147], v200 offset:30720
    v_exp_f32 v42, v42
    v_add_f32 v217, v217, v41
    v_cvt_pk_bf16_f32 v40, v40, v41
    s_add_u32 m0, s31, 0
    v_mfma_f32_32x32x16_bf16 a[32:47], a[132:135], v[32:35], a[32:47]
    v_exp_f32 v43, v43
    v_add_f32 v217, v217, v42
    v_exp_f32 v44, v44
    v_add_f32_e64 v217, v217, v43
    v_mfma_f32_32x32x16_bf16 a[48:63], a[132:135], v[48:51], a[48:63]
    buffer_load_dwordx4 v208, s[20:23], s55 offen lds
    ds_read_b64_tr_b16 a[148:149], v201 offset:28672
    ds_read_b64_tr_b16 a[150:151], v201 offset:30720
    v_cvt_pk_bf16_f32 v41, v42, v43
    v_mfma_f32_32x32x16_bf16 a[64:79], a[136:139], v[32:35], a[64:79]
    v_exp_f32 v45, v45
    v_add_f32 v217, v217, v44
    v_exp_f32 v46, v46
    v_add_f32 v217, v217, v45
    v_mfma_f32_32x32x16_bf16 a[80:95], a[136:139], v[48:51], a[80:95]
    buffer_load_dwordx4 v209, s[20:23], s55 offen offset:1024 lds
    buffer_load_dwordx4 v210, s[20:23], s55 offen offset:2048 lds
    buffer_load_dwordx4 v211, s[20:23], s55 offen offset:3072 lds
    ds_read_b64_tr_b16 a[152:153], v202 offset:28672
    ds_read_b64_tr_b16 a[154:155], v202 offset:30720
    ds_read_b64_tr_b16 a[156:157], v203 offset:28672
    ds_read_b64_tr_b16 a[158:159], v203 offset:30720
    s_add_u32 s55, s55, 16384
    v_mfma_f32_32x32x16_bf16 a[96:111], a[140:143], v[32:35], a[96:111]
    v_cvt_pk_bf16_f32 v42, v44, v45
    v_exp_f32 v47, v47
    v_add_f32 v217, v217, v46
    v_exp_f32 v56, v56
    v_add_f32 v217, v217, v47
    v_cvt_pk_bf16_f32 v43, v46, v47
    v_exp_f32 v57, v57
    v_add_f32 v218, v218, v56
    v_exp_f32 v58, v58
    v_add_f32 v218, v218, v57
    v_cvt_pk_bf16_f32 v56, v56, v57
    v_exp_f32 v59, v59
    v_add_f32 v218, v218, v58
    v_exp_f32 v60, v60
    v_add_f32 v218, v218, v59
    v_cvt_pk_bf16_f32 v57, v58, v59
    v_exp_f32 v61, v61
    v_add_f32 v218, v218, v60
    v_exp_f32 v62, v62
    v_add_f32 v218, v218, v61
    v_cvt_pk_bf16_f32 v58, v60, v61
    v_exp_f32 v63, v63
    v_add_f32 v218, v218, v62
    v_add_f32_e64 v218, v218, v63
    v_cvt_pk_bf16_f32 v59, v62, v63
    v_mfma_f32_32x32x16_bf16 a[112:127], a[140:143], v[48:51], a[112:127]
    v_mov_b32 v236, v217
    v_mov_b32 v237, v218
    v_mov_b32 v240, 0
    v_mov_b32_e64 v241, 0
    s_waitcnt lgkmcnt(0)
    v_mfma_f32_32x32x16_bf16 a[0:15], a[144:147], v[40:43], a[0:15]
    s_barrier
    s_waitcnt vmcnt(12)
    ds_read_b64_tr_b16 a[192:193], v204 offset:0
    ds_read_b64_tr_b16 a[194:195], v204 offset:1024
    v_permlane32_swap_b32 v217, v236
    v_mfma_f32_32x32x16_bf16 a[16:31], a[144:147], v[56:59], a[16:31]
    ds_read_b64_tr_b16 a[196:197], v204 offset:8
    s_add_u32 m0, s31, 16384
    v_permlane32_swap_b32 v218, v237
    v_add_f32 v217, v217, v236
    v_add_f32 v218, v218, v237
    v_mfma_f32_32x32x16_bf16 a[32:47], a[148:151], v[40:43], a[32:47]
    ds_read_b64_tr_b16 a[198:199], v204 offset:1032
    v_rcp_f32 v248, v217
    v_rcp_f32 v249, v218
    v_max_f32_e64 v242, v217, v218
    v_mfma_f32_32x32x16_bf16 a[48:63], a[148:151], v[56:59], a[48:63]
    buffer_load_dwordx4 v208, s[20:23], s55 offen lds
    ds_read_b64_tr_b16 a[200:201], v205 offset:0
    ds_read_b64_tr_b16 a[202:203], v205 offset:1024
    v_accvgpr_read_b32 v128, a0
    v_mfma_f32_32x32x16_bf16 a[64:79], a[152:155], v[40:43], a[64:79]
    buffer_load_dwordx4 v209, s[20:23], s55 offen offset:1024 lds
    v_accvgpr_read_b32 v129, a1
    v_accvgpr_read_b32 v130, a2
    v_accvgpr_read_b32 v131, a3
    v_mfma_f32_32x32x16_bf16 a[80:95], a[152:155], v[56:59], a[80:95]
    ds_read_b64_tr_b16 a[204:205], v205 offset:8
    ds_read_b64_tr_b16 a[206:207], v205 offset:1032
    v_accvgpr_read_b32 v132, a4
    v_accvgpr_read_b32 v133, a5
    v_accvgpr_read_b32 v134, a6
    v_accvgpr_read_b32 v135, a7
    v_mfma_f32_32x32x16_bf16 a[96:111], a[156:159], v[40:43], a[96:111]
    buffer_load_dwordx4 v210, s[20:23], s55 offen offset:2048 lds
    v_accvgpr_read_b32 v136, a8
    v_accvgpr_read_b32 v137, a9
    v_accvgpr_read_b32 v138, a10
    v_mfma_f32_32x32x16_bf16 a[112:127], a[156:159], v[56:59], a[112:127]
    buffer_load_dwordx4 v211, s[20:23], s55 offen offset:3072 lds
    s_add_u32 s55, s55, 16384
    s_and_b32 s55, s55, 0x7ffff
    v_accvgpr_read_b32 v139, a11
    v_accvgpr_read_b32 v140, a12
    v_accvgpr_read_b32 v141, a13
    v_accvgpr_read_b32 v142, a14
    v_accvgpr_read_b32 v143, a15
    v_accvgpr_read_b32 v144, a16
    v_accvgpr_read_b32 v145, a17
    v_accvgpr_read_b32 v146, a18
    v_accvgpr_read_b32 v147, a19
    v_accvgpr_read_b32 v148, a20
    v_accvgpr_read_b32 v149, a21
STUB5:
    s_cbranch_execz STUB9
    s_nop 0
    v_accvgpr_read_b32 v150, a22
    v_accvgpr_read_b32 v151, a23
    v_accvgpr_read_b32 v152, a24
    v_accvgpr_read_b32 v153, a25
    v_accvgpr_read_b32 v154, a26
    v_accvgpr_read_b32 v155, a27
    s_load_dwordx2 s[46:47], s[0:1], 0
    s_load_dwordx2 s[48:49], s[0:1], 88
    ds_read_b64_tr_b16 a[208:209], v206 offset:0
    ds_read_b64_tr_b16 a[210:211], v206 offset:1024
    ds_read_b64_tr_b16 a[212:213], v206 offset:8
    ds_read_b64_tr_b16 a[214:215], v206 offset:1032
    ds_read_b64_tr_b16 a[216:217], v207 offset:0
    ds_read_b64_tr_b16 a[218:219], v207 offset:1024
    ds_read_b64_tr_b16 a[220:221], v207 offset:8
    ds_read_b64_tr_b16 a[222:223], v207 offset:1032
    s_sub_u32 s3, s31, s34
    v_mul_u32_u24 v227, 12288, v226
    v_add_u32 v227, s3, v227
    v_add_u32 v200, v204, v227
    v_add_u32 v201, v205, v227
    v_add_u32 v202, v206, v227
    v_add_u32 v203, v207, v227
    v_max3_f32 v240, |v128|, |v129|, v240
    v_max3_f32 v240, |v130|, |v131|, v240
    v_max3_f32 v240, |v132|, |v133|, v240
    v_max3_f32 v240, |v134|, |v135|, v240
    v_max3_f32 v240, |v136|, |v137|, v240
    v_max3_f32 v240, |v138|, |v139|, v240
    v_max3_f32 v240, |v140|, |v141|, v240
    v_max3_f32 v240, |v142|, |v143|, v240
    v_pk_mul_f32 v[128:129], v[128:129], v[248:249] op_sel:[0,0] op_sel_hi:[1,0]
    v_pk_mul_f32 v[130:131], v[130:131], v[248:249] op_sel:[0,0] op_sel_hi:[1,0]
    v_pk_mul_f32 v[132:133], v[132:133], v[248:249] op_sel:[0,0] op_sel_hi:[1,0]
    v_pk_mul_f32 v[134:135], v[134:135], v[248:249] op_sel:[0,0] op_sel_hi:[1,0]
    v_pk_mul_f32 v[136:137], v[136:137], v[248:249] op_sel:[0,0] op_sel_hi:[1,0]
    v_pk_mul_f32 v[138:139], v[138:139], v[248:249] op_sel:[0,0] op_sel_hi:[1,0]
    v_pk_mul_f32 v[140:141], v[140:141], v[248:249] op_sel:[0,0] op_sel_hi:[1,0]
    v_pk_mul_f32 v[142:143], v[142:143], v[248:249] op_sel:[0,0] op_sel_hi:[1,0]
    v_cvt_pk_bf16_f32 v128, v128, v129
    v_cvt_pk_bf16_f32 v129, v130, v131
    v_cvt_pk_bf16_f32 v130, v132, v133
    v_cvt_pk_bf16_f32 v131, v134, v135
    ds_write_b128 v244, v[128:131] offset:0
    v_cvt_pk_bf16_f32 v136, v136, v137
    v_cvt_pk_bf16_f32 v137, v138, v139
    v_cvt_pk_bf16_f32 v138, v140, v141
    v_cvt_pk_bf16_f32 v139, v142, v143
    ds_write_b128 v244, v[136:139] offset:1024
    v_accvgpr_read_b32 v156, a28
    v_accvgpr_read_b32 v157, a29
    v_accvgpr_read_b32 v158, a30
    v_accvgpr_read_b32 v159, a31
    v_max3_f32 v241, |v144|, |v145|, v241
    v_max3_f32 v241, |v146|, |v147|, v241
    v_max3_f32 v241, |v148|, |v149|, v241
    v_max3_f32 v241, |v150|, |v151|, v241
    v_max3_f32 v241, |v152|, |v153|, v241
    v_max3_f32 v241, |v154|, |v155|, v241
    v_max3_f32 v241, |v156|, |v157|, v241
    v_max3_f32 v241, |v158|, |v159|, v241
    v_pk_mul_f32 v[144:145], v[144:145], v[248:249] op_sel:[0,1] op_sel_hi:[1,1]
    v_pk_mul_f32 v[146:147], v[146:147], v[248:249] op_sel:[0,1] op_sel_hi:[1,1]
    v_pk_mul_f32 v[148:149], v[148:149], v[248:249] op_sel:[0,1] op_sel_hi:[1,1]
    v_pk_mul_f32 v[150:151], v[150:151], v[248:249] op_sel:[0,1] op_sel_hi:[1,1]
    v_pk_mul_f32 v[152:153], v[152:153], v[248:249] op_sel:[0,1] op_sel_hi:[1,1]
    v_pk_mul_f32 v[154:155], v[154:155], v[248:249] op_sel:[0,1] op_sel_hi:[1,1]
    v_pk_mul_f32 v[156:157], v[156:157], v[248:249] op_sel:[0,1] op_sel_hi:[1,1]
    v_pk_mul_f32 v[158:159], v[158:159], v[248:249] op_sel:[0,1] op_sel_hi:[1,1]
    v_cvt_pk_bf16_f32 v144, v144, v145
    v_cvt_pk_bf16_f32 v145, v146, v147
    v_cvt_pk_bf16_f32 v146, v148, v149
    v_cvt_pk_bf16_f32 v147, v150, v151
    ds_write_b128 v244, v[144:147] offset:32768
    v_cvt_pk_bf16_f32 v152, v152, v153
    v_cvt_pk_bf16_f32 v153, v154, v155
    v_cvt_pk_bf16_f32 v154, v156, v157
    v_cvt_pk_bf16_f32 v155, v158, v159
    ds_write_b128 v244, v[152:155] offset:33792
    v_accvgpr_read_b32 v160, a32
    v_accvgpr_read_b32 v161, a33
    v_accvgpr_read_b32 v162, a34
    v_accvgpr_read_b32 v163, a35
    v_accvgpr_read_b32 v164, a36
    v_accvgpr_read_b32 v165, a37
    v_accvgpr_read_b32 v166, a38
    v_accvgpr_read_b32 v167, a39
    v_accvgpr_read_b32 v168, a40
    v_accvgpr_read_b32 v169, a41
    v_accvgpr_read_b32 v170, a42
    v_accvgpr_read_b32 v171, a43
    v_accvgpr_read_b32 v172, a44
    v_accvgpr_read_b32 v173, a45
    v_accvgpr_read_b32 v174, a46
    v_accvgpr_read_b32 v175, a47
    v_pk_mul_f32 v[160:161], v[160:161], v[248:249] op_sel:[0,0] op_sel_hi:[1,0]
    v_pk_mul_f32 v[162:163], v[162:163], v[248:249] op_sel:[0,0] op_sel_hi:[1,0]
    v_pk_mul_f32 v[164:165], v[164:165], v[248:249] op_sel:[0,0] op_sel_hi:[1,0]
    v_pk_mul_f32 v[166:167], v[166:167], v[248:249] op_sel:[0,0] op_sel_hi:[1,0]
    v_pk_mul_f32 v[168:169], v[168:169], v[248:249] op_sel:[0,0] op_sel_hi:[1,0]
    v_pk_mul_f32 v[170:171], v[170:171], v[248:249] op_sel:[0,0] op_sel_hi:[1,0]
    v_pk_mul_f32 v[172:173], v[172:173], v[248:249] op_sel:[0,0] op_sel_hi:[1,0]
    v_pk_mul_f32 v[174:175], v[174:175], v[248:249] op_sel:[0,0] op_sel_hi:[1,0]
    v_cvt_pk_bf16_f32 v160, v160, v161
    v_cvt_pk_bf16_f32 v161, v162, v163
    v_cvt_pk_bf16_f32 v162, v164, v165
    v_cvt_pk_bf16_f32 v163, v166, v167
    ds_write_b128 v245, v[160:163] offset:0
    v_cvt_pk_bf16_f32 v168, v168, v169
    v_cvt_pk_bf16_f32 v169, v170, v171
    v_cvt_pk_bf16_f32 v170, v172, v173
    v_cvt_pk_bf16_f32 v171, v174, v175
    ds_write_b128 v245, v[168:171] offset:1024
    v_accvgpr_read_b32 v176, a48
    v_accvgpr_read_b32 v177, a49
    v_accvgpr_read_b32 v178, a50
    v_accvgpr_read_b32 v179, a51
    v_accvgpr_read_b32 v180, a52
    v_accvgpr_read_b32 v181, a53
    v_accvgpr_read_b32 v182, a54
    v_accvgpr_read_b32 v183, a55
    v_accvgpr_read_b32 v184, a56
    v_accvgpr_read_b32 v185, a57
    v_accvgpr_read_b32 v186, a58
    v_accvgpr_read_b32 v187, a59
    v_accvgpr_read_b32 v188, a60
    v_accvgpr_read_b32 v189, a61
    v_accvgpr_read_b32 v190, a62
    v_accvgpr_read_b32 v191, a63
    v_pk_mul_f32 v[176:177], v[176:177], v[248:249] op_sel:[0,1] op_sel_hi:[1,1]
    v_pk_mul_f32 v[178:179], v[178:179], v[248:249] op_sel:[0,1] op_sel_hi:[1,1]
    v_pk_mul_f32 v[180:181], v[180:181], v[248:249] op_sel:[0,1] op_sel_hi:[1,1]
    v_pk_mul_f32 v[182:183], v[182:183], v[248:249] op_sel:[0,1] op_sel_hi:[1,1]
    v_pk_mul_f32 v[184:185], v[184:185], v[248:249] op_sel:[0,1] op_sel_hi:[1,1]
    v_pk_mul_f32 v[186:187], v[186:187], v[248:249] op_sel:[0,1] op_sel_hi:[1,1]
    v_pk_mul_f32 v[188:189], v[188:189], v[248:249] op_sel:[0,1] op_sel_hi:[1,1]
    v_pk_mul_f32 v[190:191], v[190:191], v[248:249] op_sel:[0,1] op_sel_hi:[1,1]
    v_cvt_pk_bf16_f32 v176, v176, v177
    v_cvt_pk_bf16_f32 v177, v178, v179
    v_cvt_pk_bf16_f32 v178, v180, v181
    v_cvt_pk_bf16_f32 v179, v182, v183
    ds_write_b128 v245, v[176:179] offset:32768
    v_cvt_pk_bf16_f32 v184, v184, v185
    v_cvt_pk_bf16_f32 v185, v186, v187
    v_cvt_pk_bf16_f32 v186, v188, v189
    v_cvt_pk_bf16_f32 v187, v190, v191
    ds_write_b128 v245, v[184:187] offset:33792
    v_accvgpr_read_b32 v128, a64
    v_accvgpr_read_b32 v129, a65
    v_accvgpr_read_b32 v130, a66
    v_accvgpr_read_b32 v131, a67
    v_accvgpr_read_b32 v132, a68
    v_accvgpr_read_b32 v133, a69
    v_accvgpr_read_b32 v134, a70
    v_accvgpr_read_b32 v135, a71
    v_accvgpr_read_b32 v136, a72
    v_accvgpr_read_b32 v137, a73
    v_accvgpr_read_b32 v138, a74
    v_accvgpr_read_b32 v139, a75
    v_accvgpr_read_b32 v140, a76
    v_accvgpr_read_b32 v141, a77
    v_accvgpr_read_b32 v142, a78
    v_accvgpr_read_b32 v143, a79
    v_pk_mul_f32 v[128:129], v[128:129], v[248:249] op_sel:[0,0] op_sel_hi:[1,0]
    v_pk_mul_f32 v[130:131], v[130:131], v[248:249] op_sel:[0,0] op_sel_hi:[1,0]
    v_pk_mul_f32 v[132:133], v[132:133], v[248:249] op_sel:[0,0] op_sel_hi:[1,0]
    v_pk_mul_f32 v[134:135], v[134:135], v[248:249] op_sel:[0,0] op_sel_hi:[1,0]
    v_pk_mul_f32 v[136:137], v[136:137], v[248:249] op_sel:[0,0] op_sel_hi:[1,0]
    v_pk_mul_f32 v[138:139], v[138:139], v[248:249] op_sel:[0,0] op_sel_hi:[1,0]
    v_pk_mul_f32 v[140:141], v[140:141], v[248:249] op_sel:[0,0] op_sel_hi:[1,0]
    v_pk_mul_f32 v[142:143], v[142:143], v[248:249] op_sel:[0,0] op_sel_hi:[1,0]
    v_cvt_pk_bf16_f32 v128, v128, v129
    v_cvt_pk_bf16_f32 v129, v130, v131
    v_cvt_pk_bf16_f32 v130, v132, v133
    v_cvt_pk_bf16_f32 v131, v134, v135
    ds_write_b128 v246, v[128:131] offset:0
    v_cvt_pk_bf16_f32 v136, v136, v137
    v_cvt_pk_bf16_f32 v137, v138, v139
    v_cvt_pk_bf16_f32 v138, v140, v141
    v_cvt_pk_bf16_f32 v139, v142, v143
    ds_write_b128 v246, v[136:139] offset:1024
    v_accvgpr_read_b32 v144, a80
    v_accvgpr_read_b32 v145, a81
    v_accvgpr_read_b32 v146, a82
    v_accvgpr_read_b32 v147, a83
    v_accvgpr_read_b32 v148, a84
    v_accvgpr_read_b32 v149, a85
    v_accvgpr_read_b32 v150, a86
    v_accvgpr_read_b32 v151, a87
    v_accvgpr_read_b32 v152, a88
    v_accvgpr_read_b32 v153, a89
    v_accvgpr_read_b32 v154, a90
    v_accvgpr_read_b32 v155, a91
    v_accvgpr_read_b32 v156, a92
    v_accvgpr_read_b32 v157, a93
    v_accvgpr_read_b32 v158, a94
    v_accvgpr_read_b32 v159, a95
    v_pk_mul_f32 v[144:145], v[144:145], v[248:249] op_sel:[0,1] op_sel_hi:[1,1]
    v_pk_mul_f32 v[146:147], v[146:147], v[248:249] op_sel:[0,1] op_sel_hi:[1,1]
    v_pk_mul_f32 v[148:149], v[148:149], v[248:249] op_sel:[0,1] op_sel_hi:[1,1]
    v_pk_mul_f32 v[150:151], v[150:151], v[248:249] op_sel:[0,1] op_sel_hi:[1,1]
    v_pk_mul_f32 v[152:153], v[152:153], v[248:249] op_sel:[0,1] op_sel_hi:[1,1]
    v_pk_mul_f32 v[154:155], v[154:155], v[248:249] op_sel:[0,1] op_sel_hi:[1,1]
    v_pk_mul_f32 v[156:157], v[156:157], v[248:249] op_sel:[0,1] op_sel_hi:[1,1]
    v_pk_mul_f32 v[158:159], v[158:159], v[248:249] op_sel:[0,1] op_sel_hi:[1,1]
    v_cvt_pk_bf16_f32 v144, v144, v145
    v_cvt_pk_bf16_f32 v145, v146, v147
    v_cvt_pk_bf16_f32 v146, v148, v149
    v_cvt_pk_bf16_f32 v147, v150, v151
    ds_write_b128 v246, v[144:147] offset:32768
    v_cvt_pk_bf16_f32 v152, v152, v153
    v_cvt_pk_bf16_f32 v153, v154, v155
    v_cvt_pk_bf16_f32 v154, v156, v157
    v_cvt_pk_bf16_f32 v155, v158, v159
    ds_write_b128 v246, v[152:155] offset:33792
    v_accvgpr_read_b32 v160, a96
    v_accvgpr_read_b32 v161, a97
    v_accvgpr_read_b32 v162, a98
    v_accvgpr_read_b32 v163, a99
    v_accvgpr_read_b32 v164, a100
    v_accvgpr_read_b32 v165, a101
    v_accvgpr_read_b32 v166, a102
    v_accvgpr_read_b32 v167, a103
    v_accvgpr_read_b32 v168, a104
    v_accvgpr_read_b32 v169, a105
    v_accvgpr_read_b32 v170, a106
    v_accvgpr_read_b32 v171, a107
    v_accvgpr_read_b32 v172, a108
    v_accvgpr_read_b32 v173, a109
    v_accvgpr_read_b32 v174, a110
    v_accvgpr_read_b32 v175, a111
    v_pk_mul_f32 v[160:161], v[160:161], v[248:249] op_sel:[0,0] op_sel_hi:[1,0]
    v_pk_mul_f32 v[162:163], v[162:163], v[248:249] op_sel:[0,0] op_sel_hi:[1,0]
    v_pk_mul_f32 v[164:165], v[164:165], v[248:249] op_sel:[0,0] op_sel_hi:[1,0]
    v_pk_mul_f32 v[166:167], v[166:167], v[248:249] op_sel:[0,0] op_sel_hi:[1,0]
    v_pk_mul_f32 v[168:169], v[168:169], v[248:249] op_sel:[0,0] op_sel_hi:[1,0]
    v_pk_mul_f32 v[170:171], v[170:171], v[248:249] op_sel:[0,0] op_sel_hi:[1,0]
    v_pk_mul_f32 v[172:173], v[172:173], v[248:249] op_sel:[0,0] op_sel_hi:[1,0]
    v_pk_mul_f32 v[174:175], v[174:175], v[248:249] op_sel:[0,0] op_sel_hi:[1,0]
    v_cvt_pk_bf16_f32 v160, v160, v161
    v_cvt_pk_bf16_f32 v161, v162, v163
    v_cvt_pk_bf16_f32 v162, v164, v165
    v_cvt_pk_bf16_f32 v163, v166, v167
    ds_write_b128 v247, v[160:163] offset:0
    v_cvt_pk_bf16_f32 v168, v168, v169
    v_cvt_pk_bf16_f32 v169, v170, v171
    v_cvt_pk_bf16_f32 v170, v172, v173
    v_cvt_pk_bf16_f32 v171, v174, v175
    ds_write_b128 v247, v[168:171] offset:1024
    v_accvgpr_read_b32 v176, a112
    v_accvgpr_read_b32 v177, a113
    v_accvgpr_read_b32 v178, a114
    v_accvgpr_read_b32 v179, a115
    v_accvgpr_read_b32 v180, a116
    v_accvgpr_read_b32 v181, a117
    v_accvgpr_read_b32 v182, a118
    v_accvgpr_read_b32 v183, a119
    v_accvgpr_read_b32 v184, a120
    v_accvgpr_read_b32 v185, a121
    v_accvgpr_read_b32 v186, a122
    v_accvgpr_read_b32 v187, a123
    v_accvgpr_read_b32 v188, a124
    v_accvgpr_read_b32 v189, a125
    v_accvgpr_read_b32 v190, a126
    v_accvgpr_read_b32 v191, a127
    v_pk_mul_f32 v[176:177], v[176:177], v[248:249] op_sel:[0,1] op_sel_hi:[1,1]
    v_pk_mul_f32 v[178:179], v[178:179], v[248:249] op_sel:[0,1] op_sel_hi:[1,1]
    v_pk_mul_f32 v[180:181], v[180:181], v[248:249] op_sel:[0,1] op_sel_hi:[1,1]
    v_pk_mul_f32 v[182:183], v[182:183], v[248:249] op_sel:[0,1] op_sel_hi:[1,1]
    v_pk_mul_f32 v[184:185], v[184:185], v[248:249] op_sel:[0,1] op_sel_hi:[1,1]
    v_pk_mul_f32 v[186:187], v[186:187], v[248:249] op_sel:[0,1] op_sel_hi:[1,1]
    v_pk_mul_f32 v[188:189], v[188:189], v[248:249] op_sel:[0,1] op_sel_hi:[1,1]
    v_pk_mul_f32 v[190:191], v[190:191], v[248:249] op_sel:[0,1] op_sel_hi:[1,1]
    v_cvt_pk_bf16_f32 v176, v176, v177
    v_cvt_pk_bf16_f32 v177, v178, v179
    v_cvt_pk_bf16_f32 v178, v180, v181
    v_cvt_pk_bf16_f32 v179, v182, v183
    ds_write_b128 v247, v[176:179] offset:32768
    v_cvt_pk_bf16_f32 v184, v184, v185
    v_cvt_pk_bf16_f32 v185, v186, v187
    v_cvt_pk_bf16_f32 v186, v188, v189
    v_cvt_pk_bf16_f32 v187, v190, v191
    ds_write_b128 v247, v[184:187] offset:33792
    s_waitcnt lgkmcnt(0)
    s_barrier
    ds_read_b128 a[160:163], v219 offset:0
    ds_read_b128 a[164:167], v219 offset:256
    ds_read_b128 a[168:171], v219 offset:32768
    ds_read_b128 a[172:175], v219 offset:33024
    s_waitcnt lgkmcnt(3)
    v_mfma_f32_16x16x32_bf16 v[0:3], a[192:195], a[160:163], 0
    ds_read_b128 a[176:179], v219 offset:2048
    s_add_u32 m0, s34, 0
    s_waitcnt lgkmcnt(3)
    v_mfma_f32_16x16x32_bf16 v[8:11], a[192:195], a[164:167], 0
    ds_read_b128 a[180:183], v219 offset:2304
    s_waitcnt lgkmcnt(3)
    v_mfma_f32_16x16x32_bf16 v[16:19], a[192:195], a[168:171], 0
    ds_read_b128 a[184:187], v219 offset:34816
    s_waitcnt lgkmcnt(3)
    v_mfma_f32_16x16x32_bf16 v[24:27], a[192:195], a[172:175], 0
    buffer_load_dwordx4 v208, s[20:23], s55 offen lds
    v_mfma_f32_16x16x32_bf16 v[4:7], a[196:199], a[160:163], 0
    ds_read_b128 a[188:191], v219 offset:35072
    v_mfma_f32_16x16x32_bf16 v[12:15], a[196:199], a[164:167], 0
    s_waitcnt vmcnt(9)
    ds_read_b64_tr_b16 a[224:225], v204 offset:8192
    v_mfma_f32_16x16x32_bf16 v[20:23], a[196:199], a[168:171], 0
    buffer_load_dwordx4 v209, s[20:23], s55 offen offset:1024 lds
    v_mfma_f32_16x16x32_bf16 v[28:31], a[196:199], a[172:175], 0
    ds_read_b64_tr_b16 a[226:227], v204 offset:9216
    v_mfma_f32_16x16x32_bf16 v[32:35], a[200:203], a[160:163], 0
    ds_read_b64_tr_b16 a[228:229], v204 offset:8200
    v_mfma_f32_16x16x32_bf16 v[40:43], a[200:203], a[164:167], 0
    buffer_load_dwordx4 v210, s[20:23], s55 offen offset:2048 lds
    v_mfma_f32_16x16x32_bf16 v[48:51], a[200:203], a[168:171], 0
    ds_read_b64_tr_b16 a[230:231], v204 offset:9224
    v_mfma_f32_16x16x32_bf16 v[56:59], a[200:203], a[172:175], 0
    ds_read_b64_tr_b16 a[232:233], v205 offset:8192
    v_min_f32_e64 v240, v240, v241
    v_mfma_f32_16x16x32_bf16 v[36:39], a[204:207], a[160:163], 0
    buffer_load_dwordx4 v211, s[20:23], s55 offen offset:3072 lds
    v_mfma_f32_16x16x32_bf16 v[44:47], a[204:207], a[164:167], 0
    ds_read_b64_tr_b16 a[234:235], v205 offset:9216
    s_add_u32 s55, s55, 16384
    v_mfma_f32_16x16x32_bf16 v[52:55], a[204:207], a[168:171], 0
    ds_read_b64_tr_b16 a[236:237], v205 offset:8200
    v_mfma_f32_16x16x32_bf16 v[60:63], a[204:207], a[172:175], 0
    ds_read_b64_tr_b16 a[238:239], v205 offset:9224
    s_add_u32 m0, s34, 4096
    v_mfma_f32_16x16x32_bf16 v[64:67], a[208:211], a[160:163], 0
    ds_read_b64_tr_b16 a[240:241], v206 offset:8192
    v_mfma_f32_16x16x32_bf16 v[72:75], a[208:211], a[164:167], 0
    buffer_load_dwordx4 v208, s[20:23], s55 offen lds
    v_mfma_f32_16x16x32_bf16 v[80:83], a[208:211], a[168:171], 0
    ds_read_b64_tr_b16 a[242:243], v206 offset:9216
    v_cmp_ngt_f32 vcc, 0x7b800000, v242
    v_mfma_f32_16x16x32_bf16 v[88:91], a[208:211], a[172:175], 0
    ds_read_b64_tr_b16 a[244:245], v206 offset:8200
    v_mfma_f32_16x16x32_bf16 v[68:71], a[212:215], a[160:163], 0
    buffer_load_dwordx4 v209, s[20:23], s55 offen offset:1024 lds
    v_mfma_f32_16x16x32_bf16 v[76:79], a[212:215], a[164:167], 0
    ds_read_b64_tr_b16 a[246:247], v206 offset:9224
    v_mfma_f32_16x16x32_bf16 v[84:87], a[212:215], a[168:171], 0
    ds_read_b64_tr_b16 a[248:249], v207 offset:8192
    v_mfma_f32_16x16x32_bf16 v[92:95], a[212:215], a[172:175], 0
    buffer_load_dwordx4 v210, s[20:23], s55 offen offset:2048 lds
    v_mfma_f32_16x16x32_bf16 v[96:99], a[216:219], a[160:163], 0
    ds_read_b64_tr_b16 a[250:251], v207 offset:9216
    v_mfma_f32_16x16x32_bf16 v[104:107], a[216:219], a[164:167], 0
    ds_read_b64_tr_b16 a[252:253], v207 offset:8200
    s_mov_b64 s[62:63], vcc
    s_nop 0
    v_mfma_f32_16x16x32_bf16 v[112:115], a[216:219], a[168:171], 0
    buffer_load_dwordx4 v211, s[20:23], s55 offen offset:3072 lds
    v_mfma_f32_16x16x32_bf16 v[120:123], a[216:219], a[172:175], 0
    ds_read_b64_tr_b16 a[254:255], v207 offset:9224
    s_add_u32 s55, s55, 16384
    v_mfma_f32_16x16x32_bf16 v[100:103], a[220:223], a[160:163], 0
    v_mfma_f32_16x16x32_bf16 v[108:111], a[220:223], a[164:167], 0
    v_mfma_f32_16x16x32_bf16 v[116:119], a[220:223], a[168:171], 0
    s_and_b32 s55, s55, 0x7ffff
    v_mfma_f32_16x16x32_bf16 v[124:127], a[220:223], a[172:175], 0
    s_waitcnt lgkmcnt(0)
    s_nop 0
    v_mfma_f32_16x16x32_bf16 v[0:3], a[224:227], a[176:179], v[0:3]
    ds_read_b128 a[160:163], v219 offset:4096
    v_cmp_gt_f32 vcc, 0x09800000, v240
    v_mfma_f32_16x16x32_bf16 v[8:11], a[224:227], a[180:183], v[8:11]
    ds_read_b128 a[164:167], v219 offset:4352
    s_add_u32 m0, s34, 8192
    v_mfma_f32_16x16x32_bf16 v[16:19], a[224:227], a[184:187], v[16:19]
    ds_read_b128 a[168:171], v219 offset:36864
    v_mfma_f32_16x16x32_bf16 v[24:27], a[224:227], a[188:191], v[24:27]
    buffer_load_dwordx4 v208, s[20:23], s55 offen lds
    v_mfma_f32_16x16x32_bf16 v[4:7], a[228:231], a[176:179], v[4:7]
    ds_read_b128 a[172:175], v219 offset:37120
    v_mfma_f32_16x16x32_bf16 v[12:15], a[228:231], a[180:183], v[12:15]
    s_waitcnt vmcnt(9)
    ds_read_b64_tr_b16 a[192:193], v200 offset:0
    v_mfma_f32_16x16x32_bf16 v[20:23], a[228:231], a[184:187], v[20:23]
    buffer_load_dwordx4 v209, s[20:23], s55 offen offset:1024 lds
    v_mfma_f32_16x16x32_bf16 v[28:31], a[228:231], a[188:191], v[28:31]
    ds_read_b64_tr_b16 a[194:195], v200 offset:1024
    s_or_b64 s[62:63], s[62:63], vcc
    v_mfma_f32_16x16x32_bf16 v[32:35], a[232:235], a[176:179], v[32:35]
    ds_read_b64_tr_b16 a[196:197], v200 offset:8
    v_mfma_f32_16x16x32_bf16 v[40:43], a[232:235], a[180:183], v[40:43]
    buffer_load_dwordx4 v210, s[20:23], s55 offen offset:2048 lds
    v_mfma_f32_16x16x32_bf16 v[48:51], a[232:235], a[184:187], v[48:51]
    ds_read_b64_tr_b16 a[198:199], v200 offset:1032
    v_mfma_f32_16x16x32_bf16 v[56:59], a[232:235], a[188:191], v[56:59]
    ds_read_b64_tr_b16 a[200:201], v201 offset:0
    v_mfma_f32_16x16x32_bf16 v[36:39], a[236:239], a[176:179], v[36:39]
    buffer_load_dwordx4 v211, s[20:23], s55 offen offset:3072 lds
    v_mfma_f32_16x16x32_bf16 v[44:47], a[236:239], a[180:183], v[44:47]
    ds_read_b64_tr_b16 a[202:203], v201 offset:1024
    s_add_u32 s55, s55, 16384
    v_mfma_f32_16x16x32_bf16 v[52:55], a[236:239], a[184:187], v[52:55]
    ds_read_b64_tr_b16 a[204:205], v201 offset:8
    v_mfma_f32_16x16x32_bf16 v[60:63], a[236:239], a[188:191], v[60:63]
    ds_read_b64_tr_b16 a[206:207], v201 offset:1032
    v_mov_b32_e64 v237, s34
    v_mfma_f32_16x16x32_bf16 v[64:67], a[240:243], a[176:179], v[64:67]
    s_add_u32 m0, s34, 12288
    v_mfma_f32_16x16x32_bf16 v[72:75], a[240:243], a[180:183], v[72:75]
    ds_read_b64_tr_b16 a[208:209], v202 offset:0
    v_mfma_f32_16x16x32_bf16 v[80:83], a[240:243], a[184:187], v[80:83]
    ds_read_b64_tr_b16 a[210:211], v202 offset:1024
    v_mfma_f32_16x16x32_bf16 v[88:91], a[240:243], a[188:191], v[88:91]
    buffer_load_dwordx4 v208, s[20:23], s55 offen lds
    v_mfma_f32_16x16x32_bf16 v[68:71], a[244:247], a[176:179], v[68:71]
    ds_read_b64_tr_b16 a[212:213], v202 offset:8
    v_mfma_f32_16x16x32_bf16 v[76:79], a[244:247], a[180:183], v[76:79]
    ds_read_b64_tr_b16 a[214:215], v202 offset:1032
    v_mfma_f32_16x16x32_bf16 v[84:87], a[244:247], a[184:187], v[84:87]
    buffer_load_dwordx4 v209, s[20:23], s55 offen offset:1024 lds
    v_mfma_f32_16x16x32_bf16 v[92:95], a[244:247], a[188:191], v[92:95]
    ds_read_b64_tr_b16 a[216:217], v203 offset:0
    v_and_b32_e64 v243, 3, v220
    v_mfma_f32_16x16x32_bf16 v[96:99], a[248:251], a[176:179], v[96:99]
    buffer_load_dwordx4 v210, s[20:23], s55 offen offset:2048 lds
    v_mfma_f32_16x16x32_bf16 v[104:107], a[248:251], a[180:183], v[104:107]
    ds_read_b64_tr_b16 a[218:219], v203 offset:1024
    ds_read_b64_tr_b16 a[220:221], v203 offset:8
    v_mfma_f32_16x16x32_bf16 v[112:115], a[248:251], a[184:187], v[112:115]
    buffer_load_dwordx4 v211, s[20:23], s55 offen offset:3072 lds
    v_mfma_f32_16x16x32_bf16 v[120:123], a[248:251], a[188:191], v[120:123]
    ds_read_b64_tr_b16 a[222:223], v203 offset:1032
    s_add_u32 s55, s55, 16384
    v_mfma_f32_16x16x32_bf16 v[100:103], a[252:255], a[176:179], v[100:103]
    v_mfma_f32_16x16x32_bf16 v[108:111], a[252:255], a[180:183], v[108:111]
    v_lshlrev_b32_e64 v243, 14, v243
    v_mfma_f32_16x16x32_bf16 v[116:119], a[252:255], a[184:187], v[116:119]
    s_and_b32 s55, s55, 0x7ffff
    v_mfma_f32_16x16x32_bf16 v[124:127], a[252:255], a[188:191], v[124:127]
    s_waitcnt lgkmcnt(0)
    v_mfma_f32_16x16x32_bf16 v[0:3], a[192:195], a[160:163], v[0:3]
    ds_read_b128 a[176:179], v219 offset:6144
    s_add_u32 m0, s31, 0
    v_mfma_f32_16x16x32_bf16 v[8:11], a[192:195], a[164:167], v[8:11]
    ds_read_b128 a[180:183], v219 offset:6400
    v_mfma_f32_16x16x32_bf16 v[16:19], a[192:195], a[168:171], v[16:19]
    ds_read_b128 a[184:187], v219 offset:38912
    v_mfma_f32_16x16x32_bf16 v[24:27], a[192:195], a[172:175], v[24:27]
    buffer_load_dwordx4 v208, s[20:23], s55 offen lds
    v_mfma_f32_16x16x32_bf16 v[4:7], a[196:199], a[160:163], v[4:7]
    ds_read_b128 a[188:191], v219 offset:39168
    v_add_u32 v243, 98304, v243
    v_mfma_f32_16x16x32_bf16 v[12:15], a[196:199], a[164:167], v[12:15]
    s_waitcnt vmcnt(9)
    s_nop 0
    ds_read_b64_tr_b16 a[224:225], v204 offset:0
    v_mfma_f32_16x16x32_bf16 v[20:23], a[196:199], a[168:171], v[20:23]
    buffer_load_dwordx4 v209, s[20:23], s55 offen offset:1024 lds
    v_mfma_f32_16x16x32_bf16 v[28:31], a[196:199], a[172:175], v[28:31]
    ds_read_b64_tr_b16 a[226:227], v204 offset:1024
    v_mfma_f32_16x16x32_bf16 v[32:35], a[200:203], a[160:163], v[32:35]
    ds_read_b64_tr_b16 a[228:229], v204 offset:8
    v_mfma_f32_16x16x32_bf16 v[40:43], a[200:203], a[164:167], v[40:43]
    buffer_load_dwordx4 v210, s[20:23], s55 offen offset:2048 lds
    v_mfma_f32_16x16x32_bf16 v[48:51], a[200:203], a[168:171], v[48:51]
    ds_read_b64_tr_b16 a[230:231], v204 offset:1032
    v_mfma_f32_16x16x32_bf16 v[56:59], a[200:203], a[172:175], v[56:59]
    ds_read_b64_tr_b16 a[232:233], v205 offset:0
    v_mov_b32_e64 v238, 0
    v_mfma_f32_16x16x32_bf16 v[36:39], a[204:207], a[160:163], v[36:39]
    buffer_load_dwordx4 v211, s[20:23], s55 offen offset:3072 lds
    v_mfma_f32_16x16x32_bf16 v[44:47], a[204:207], a[164:167], v[44:47]
    ds_read_b64_tr_b16 a[234:235], v205 offset:1024
    s_add_u32 s55, s55, 16384
    v_mfma_f32_16x16x32_bf16 v[52:55], a[204:207], a[168:171], v[52:55]
    ds_read_b64_tr_b16 a[236:237], v205 offset:8
    v_mfma_f32_16x16x32_bf16 v[60:63], a[204:207], a[172:175], v[60:63]
    ds_read_b64_tr_b16 a[238:239], v205 offset:1032
    s_add_u32 m0, s31, 16384
    v_mfma_f32_16x16x32_bf16 v[64:67], a[208:211], a[160:163], v[64:67]
    ds_read_b64_tr_b16 a[240:241], v206 offset:0
    v_mfma_f32_16x16x32_bf16 v[72:75], a[208:211], a[164:167], v[72:75]
    buffer_load_dwordx4 v208, s[20:23], s55 offen lds
    v_mfma_f32_16x16x32_bf16 v[80:83], a[208:211], a[168:171], v[80:83]
    ds_read_b64_tr_b16 a[242:243], v206 offset:1024
    v_mfma_f32_16x16x32_bf16 v[88:91], a[208:211], a[172:175], v[88:91]
    ds_read_b64_tr_b16 a[244:245], v206 offset:8
    v_mov_b32 v239, 0x7f800000
    v_mfma_f32_16x16x32_bf16 v[68:71], a[212:215], a[160:163], v[68:71]
    buffer_load_dwordx4 v209, s[20:23], s55 offen offset:1024 lds
    v_mfma_f32_16x16x32_bf16 v[76:79], a[212:215], a[164:167], v[76:79]
    ds_read_b64_tr_b16 a[246:247], v206 offset:1032
    v_mfma_f32_16x16x32_bf16 v[84:87], a[212:215], a[168:171], v[84:87]
    ds_read_b64_tr_b16 a[248:249], v207 offset:0
    v_mfma_f32_16x16x32_bf16 v[92:95], a[212:215], a[172:175], v[92:95]
    buffer_load_dwordx4 v210, s[20:23], s55 offen offset:2048 lds
    v_mfma_f32_16x16x32_bf16 v[96:99], a[216:219], a[160:163], v[96:99]
    ds_read_b64_tr_b16 a[250:251], v207 offset:1024
    v_mfma_f32_16x16x32_bf16 v[104:107], a[216:219], a[164:167], v[104:107]
    ds_read_b64_tr_b16 a[252:253], v207 offset:8
    v_mfma_f32_16x16x32_bf16 v[112:115], a[216:219], a[168:171], v[112:115]
    buffer_load_dwordx4 v211, s[20:23], s55 offen offset:3072 lds
    v_mfma_f32_16x16x32_bf16 v[120:123], a[216:219], a[172:175], v[120:123]
    ds_read_b64_tr_b16 a[254:255], v207 offset:1032
    s_lshl_b32 s51, s29, 21
    v_mfma_f32_16x16x32_bf16 v[100:103], a[220:223], a[160:163], v[100:103]
    s_add_u32 s55, s55, 16384
    v_mfma_f32_16x16x32_bf16 v[108:111], a[220:223], a[164:167], v[108:111]
    v_mfma_f32_16x16x32_bf16 v[116:119], a[220:223], a[168:171], v[116:119]
    s_and_b32 s55, s55, 0x7ffff
    v_mfma_f32_16x16x32_bf16 v[124:127], a[220:223], a[172:175], v[124:127]
    s_waitcnt lgkmcnt(0)
    v_mfma_f32_16x16x32_bf16 v[0:3], a[224:227], a[176:179], v[0:3]
    ds_read_b128 a[160:163], v219 offset:8192
    s_add_u32 m0, s34, 0
    v_mfma_f32_16x16x32_bf16 v[8:11], a[224:227], a[180:183], v[8:11]
    ds_read_b128 a[164:167], v219 offset:8448
    s_lshl_b32 s33, s30, 16
    v_mfma_f32_16x16x32_bf16 v[16:19], a[224:227], a[184:187], v[16:19]
    ds_read_b128 a[168:171], v219 offset:40960
    v_mfma_f32_16x16x32_bf16 v[24:27], a[224:227], a[188:191], v[24:27]
    buffer_load_dwordx4 v208, s[20:23], s55 offen lds
    v_mfma_f32_16x16x32_bf16 v[4:7], a[228:231], a[176:179], v[4:7]
    ds_read_b128 a[172:175], v219 offset:41216
    v_mfma_f32_16x16x32_bf16 v[12:15], a[228:231], a[180:183], v[12:15]
    s_waitcnt vmcnt(9)
    s_nop 0
    ds_read_b64_tr_b16 a[192:193], v204 offset:8192
    v_mfma_f32_16x16x32_bf16 v[20:23], a[228:231], a[184:187], v[20:23]
STUB6:
    s_cbranch_execz STUB10
    s_nop 0
    buffer_load_dwordx4 v209, s[20:23], s55 offen offset:1024 lds
    v_mfma_f32_16x16x32_bf16 v[28:31], a[228:231], a[188:191], v[28:31]
    ds_read_b64_tr_b16 a[194:195], v204 offset:9216
    v_mfma_f32_16x16x32_bf16 v[32:35], a[232:235], a[176:179], v[32:35]
    ds_read_b64_tr_b16 a[196:197], v204 offset:8200
    s_add_u32 s51, s51, s33
    s_nop 0
    v_mfma_f32_16x16x32_bf16 v[40:43], a[232:235], a[180:183], v[40:43]
    buffer_load_dwordx4 v210, s[20:23], s55 offen offset:2048 lds
    v_mfma_f32_16x16x32_bf16 v[48:51], a[232:235], a[184:187], v[48:51]
    ds_read_b64_tr_b16 a[198:199], v204 offset:9224
    v_mfma_f32_16x16x32_bf16 v[56:59], a[232:235], a[188:191], v[56:59]
    ds_read_b64_tr_b16 a[200:201], v205 offset:8192
    v_mfma_f32_16x16x32_bf16 v[36:39], a[236:239], a[176:179], v[36:39]
    buffer_load_dwordx4 v211, s[20:23], s55 offen offset:3072 lds
    v_mfma_f32_16x16x32_bf16 v[44:47], a[236:239], a[180:183], v[44:47]
    ds_read_b64_tr_b16 a[202:203], v205 offset:9216
    s_add_u32 s55, s55, 16384
    v_mfma_f32_16x16x32_bf16 v[52:55], a[236:239], a[184:187], v[52:55]
    ds_read_b64_tr_b16 a[204:205], v205 offset:8200
    v_mfma_f32_16x16x32_bf16 v[60:63], a[236:239], a[188:191], v[60:63]
    ds_read_b64_tr_b16 a[206:207], v205 offset:9224
    s_add_u32 m0, s34, 4096
    v_mfma_f32_16x16x32_bf16 v[64:67], a[240:243], a[176:179], v[64:67]
    s_lshl_b32 s33, s28, 13
    s_nop 0
    v_mfma_f32_16x16x32_bf16 v[72:75], a[240:243], a[180:183], v[72:75]
    ds_read_b64_tr_b16 a[208:209], v206 offset:8192
    v_mfma_f32_16x16x32_bf16 v[80:83], a[240:243], a[184:187], v[80:83]
    ds_read_b64_tr_b16 a[210:211], v206 offset:9216
    v_mfma_f32_16x16x32_bf16 v[88:91], a[240:243], a[188:191], v[88:91]
    buffer_load_dwordx4 v208, s[20:23], s55 offen lds
    v_mfma_f32_16x16x32_bf16 v[68:71], a[244:247], a[176:179], v[68:71]
    ds_read_b64_tr_b16 a[212:213], v206 offset:8200
    v_mfma_f32_16x16x32_bf16 v[76:79], a[244:247], a[180:183], v[76:79]
    ds_read_b64_tr_b16 a[214:215], v206 offset:9224
    v_mfma_f32_16x16x32_bf16 v[84:87], a[244:247], a[184:187], v[84:87]
    buffer_load_dwordx4 v209, s[20:23], s55 offen offset:1024 lds
    v_mfma_f32_16x16x32_bf16 v[92:95], a[244:247], a[188:191], v[92:95]
    ds_read_b64_tr_b16 a[216:217], v207 offset:8192
    ds_read_b64_tr_b16 a[218:219], v207 offset:9216
    v_mfma_f32_16x16x32_bf16 v[96:99], a[248:251], a[176:179], v[96:99]
    buffer_load_dwordx4 v210, s[20:23], s55 offen offset:2048 lds
    v_mfma_f32_16x16x32_bf16 v[104:107], a[248:251], a[180:183], v[104:107]
    ds_read_b64_tr_b16 a[220:221], v207 offset:8200
    s_add_u32 s51, s51, s33
    s_nop 0
    v_mfma_f32_16x16x32_bf16 v[112:115], a[248:251], a[184:187], v[112:115]
    buffer_load_dwordx4 v211, s[20:23], s55 offen offset:3072 lds
    v_mfma_f32_16x16x32_bf16 v[120:123], a[248:251], a[188:191], v[120:123]
    ds_read_b64_tr_b16 a[222:223], v207 offset:9224
    s_add_u32 s55, s55, 16384
    v_mfma_f32_16x16x32_bf16 v[100:103], a[252:255], a[176:179], v[100:103]
    v_mfma_f32_16x16x32_bf16 v[108:111], a[252:255], a[180:183], v[108:111]
    v_mfma_f32_16x16x32_bf16 v[116:119], a[252:255], a[184:187], v[116:119]
    s_and_b32 s55, s55, 0x7ffff
    s_add_u32 s51, s51, 0x400000
    v_mfma_f32_16x16x32_bf16 v[124:127], a[252:255], a[188:191], v[124:127]
    s_waitcnt lgkmcnt(0)
    s_nop 0
    v_mfma_f32_16x16x32_bf16 v[0:3], a[192:195], a[160:163], v[0:3]
    ds_read_b128 a[176:179], v219 offset:10240
    s_add_u32 m0, s34, 8192
    v_mfma_f32_16x16x32_bf16 v[8:11], a[192:195], a[164:167], v[8:11]
    ds_read_b128 a[180:183], v219 offset:10496
    v_mfma_f32_16x16x32_bf16 v[16:19], a[192:195], a[168:171], v[16:19]
    ds_read_b128 a[184:187], v219 offset:43008
    v_mfma_f32_16x16x32_bf16 v[24:27], a[192:195], a[172:175], v[24:27]
    buffer_load_dwordx4 v208, s[20:23], s55 offen lds
    v_mfma_f32_16x16x32_bf16 v[4:7], a[196:199], a[160:163], v[4:7]
    ds_read_b128 a[188:191], v219 offset:43264
    v_mfma_f32_16x16x32_bf16 v[12:15], a[196:199], a[164:167], v[12:15]
    s_waitcnt vmcnt(9)
    ds_read_b64_tr_b16 a[224:225], v200 offset:0
    v_mfma_f32_16x16x32_bf16 v[20:23], a[196:199], a[168:171], v[20:23]
    s_mov_b32 s12, s46
    v_mfma_f32_16x16x32_bf16 v[28:31], a[196:199], a[172:175], v[28:31]
    buffer_load_dwordx4 v209, s[20:23], s55 offen offset:1024 lds
    v_mfma_f32_16x16x32_bf16 v[32:35], a[200:203], a[160:163], v[32:35]
    ds_read_b64_tr_b16 a[226:227], v200 offset:1024
    ds_read_b64_tr_b16 a[228:229], v200 offset:8
    v_mfma_f32_16x16x32_bf16 v[40:43], a[200:203], a[164:167], v[40:43]
    buffer_load_dwordx4 v210, s[20:23], s55 offen offset:2048 lds
    v_mfma_f32_16x16x32_bf16 v[48:51], a[200:203], a[168:171], v[48:51]
    ds_read_b64_tr_b16 a[230:231], v200 offset:1032
    v_mfma_f32_16x16x32_bf16 v[56:59], a[200:203], a[172:175], v[56:59]
    ds_read_b64_tr_b16 a[232:233], v201 offset:0
    v_mfma_f32_16x16x32_bf16 v[36:39], a[204:207], a[160:163], v[36:39]
    buffer_load_dwordx4 v211, s[20:23], s55 offen offset:3072 lds
    v_mfma_f32_16x16x32_bf16 v[44:47], a[204:207], a[164:167], v[44:47]
    ds_read_b64_tr_b16 a[234:235], v201 offset:1024
    s_and_b32 s13, s47, 0xffff
    v_mfma_f32_16x16x32_bf16 v[52:55], a[204:207], a[168:171], v[52:55]
    ds_read_b64_tr_b16 a[236:237], v201 offset:8
    s_add_u32 s55, s55, 16384
    v_mfma_f32_16x16x32_bf16 v[60:63], a[204:207], a[172:175], v[60:63]
    ds_read_b64_tr_b16 a[238:239], v201 offset:1032
    s_add_u32 m0, s34, 12288
    v_mfma_f32_16x16x32_bf16 v[64:67], a[208:211], a[160:163], v[64:67]
    ds_read_b64_tr_b16 a[240:241], v202 offset:0
    v_mfma_f32_16x16x32_bf16 v[72:75], a[208:211], a[164:167], v[72:75]
    buffer_load_dwordx4 v208, s[20:23], s55 offen lds
    v_mfma_f32_16x16x32_bf16 v[80:83], a[208:211], a[168:171], v[80:83]
    ds_read_b64_tr_b16 a[242:243], v202 offset:1024
    v_mfma_f32_16x16x32_bf16 v[88:91], a[208:211], a[172:175], v[88:91]
    ds_read_b64_tr_b16 a[244:245], v202 offset:8
    s_mov_b32 s14, 0x200000
    v_mfma_f32_16x16x32_bf16 v[68:71], a[212:215], a[160:163], v[68:71]
    buffer_load_dwordx4 v209, s[20:23], s55 offen offset:1024 lds
    v_mfma_f32_16x16x32_bf16 v[76:79], a[212:215], a[164:167], v[76:79]
    ds_read_b64_tr_b16 a[246:247], v202 offset:1032
    v_mfma_f32_16x16x32_bf16 v[84:87], a[212:215], a[168:171], v[84:87]
    ds_read_b64_tr_b16 a[248:249], v203 offset:0
    v_mfma_f32_16x16x32_bf16 v[92:95], a[212:215], a[172:175], v[92:95]
    buffer_load_dwordx4 v210, s[20:23], s55 offen offset:2048 lds
    v_mfma_f32_16x16x32_bf16 v[96:99], a[216:219], a[160:163], v[96:99]
    ds_read_b64_tr_b16 a[250:251], v203 offset:1024
    v_mfma_f32_16x16x32_bf16 v[104:107], a[216:219], a[164:167], v[104:107]
    ds_read_b64_tr_b16 a[252:253], v203 offset:8
    v_mfma_f32_16x16x32_bf16 v[112:115], a[216:219], a[168:171], v[112:115]
    buffer_load_dwordx4 v211, s[20:23], s55 offen offset:3072 lds
    v_mfma_f32_16x16x32_bf16 v[120:123], a[216:219], a[172:175], v[120:123]
    ds_read_b64_tr_b16 a[254:255], v203 offset:1032
    s_mov_b32 s15, 0x20000
    v_mfma_f32_16x16x32_bf16 v[100:103], a[220:223], a[160:163], v[100:103]
    s_add_u32 s55, s55, 16384
    v_mfma_f32_16x16x32_bf16 v[108:111], a[220:223], a[164:167], v[108:111]
    v_mfma_f32_16x16x32_bf16 v[116:119], a[220:223], a[168:171], v[116:119]
    s_and_b32 s55, s55, 0x7ffff
    v_mfma_f32_16x16x32_bf16 v[124:127], a[220:223], a[172:175], v[124:127]
    s_waitcnt lgkmcnt(0)
    v_mfma_f32_16x16x32_bf16 v[0:3], a[224:227], a[176:179], v[0:3]
    ds_read_b128 a[160:163], v219 offset:12288
    s_add_u32 m0, s31, 0
    v_mfma_f32_16x16x32_bf16 v[8:11], a[224:227], a[180:183], v[8:11]
    ds_read_b128 a[164:167], v219 offset:12544
    v_mfma_f32_16x16x32_bf16 v[16:19], a[224:227], a[184:187], v[16:19]
    ds_read_b128 a[168:171], v219 offset:45056
    s_mov_b32 s16, s68
    v_mfma_f32_16x16x32_bf16 v[24:27], a[224:227], a[188:191], v[24:27]
    buffer_load_dwordx4 v208, s[20:23], s55 offen lds
    v_mfma_f32_16x16x32_bf16 v[4:7], a[228:231], a[176:179], v[4:7]
    ds_read_b128 a[172:175], v219 offset:45312
    v_mfma_f32_16x16x32_bf16 v[12:15], a[228:231], a[180:183], v[12:15]
    s_waitcnt vmcnt(9)
    ds_read_b64_tr_b16 a[192:193], v204 offset:0
    v_mfma_f32_16x16x32_bf16 v[20:23], a[228:231], a[184:187], v[20:23]
    buffer_load_dwordx4 v209, s[20:23], s55 offen offset:1024 lds
    v_mfma_f32_16x16x32_bf16 v[28:31], a[228:231], a[188:191], v[28:31]
    ds_read_b64_tr_b16 a[194:195], v204 offset:1024
    v_mfma_f32_16x16x32_bf16 v[32:35], a[232:235], a[176:179], v[32:35]
    ds_read_b64_tr_b16 a[196:197], v204 offset:8
    v_mfma_f32_16x16x32_bf16 v[40:43], a[232:235], a[180:183], v[40:43]
    buffer_load_dwordx4 v210, s[20:23], s55 offen offset:2048 lds
    v_mfma_f32_16x16x32_bf16 v[48:51], a[232:235], a[184:187], v[48:51]
    ds_read_b64_tr_b16 a[198:199], v204 offset:1032
    s_and_b32 s17, s69, 0xffff
    v_mfma_f32_16x16x32_bf16 v[56:59], a[232:235], a[188:191], v[56:59]
    ds_read_b64_tr_b16 a[200:201], v205 offset:0
    v_mfma_f32_16x16x32_bf16 v[36:39], a[236:239], a[176:179], v[36:39]
    buffer_load_dwordx4 v211, s[20:23], s55 offen offset:3072 lds
    v_mfma_f32_16x16x32_bf16 v[44:47], a[236:239], a[180:183], v[44:47]
    ds_read_b64_tr_b16 a[202:203], v205 offset:1024
    s_add_u32 s55, s55, 16384
    v_mfma_f32_16x16x32_bf16 v[52:55], a[236:239], a[184:187], v[52:55]
    ds_read_b64_tr_b16 a[204:205], v205 offset:8
    v_mfma_f32_16x16x32_bf16 v[60:63], a[236:239], a[188:191], v[60:63]
    ds_read_b64_tr_b16 a[206:207], v205 offset:1032
    s_add_u32 m0, s31, 16384
    v_mfma_f32_16x16x32_bf16 v[64:67], a[240:243], a[176:179], v[64:67]
    ds_read_b64_tr_b16 a[208:209], v206 offset:0
    v_mfma_f32_16x16x32_bf16 v[72:75], a[240:243], a[180:183], v[72:75]
    s_mov_b32 s18, 0x100
    v_mfma_f32_16x16x32_bf16 v[80:83], a[240:243], a[184:187], v[80:83]
    ds_read_b64_tr_b16 a[210:211], v206 offset:1024
    v_mfma_f32_16x16x32_bf16 v[88:91], a[240:243], a[188:191], v[88:91]
    buffer_load_dwordx4 v208, s[20:23], s55 offen lds
    v_mfma_f32_16x16x32_bf16 v[68:71], a[244:247], a[176:179], v[68:71]
    ds_read_b64_tr_b16 a[212:213], v206 offset:8
    v_mfma_f32_16x16x32_bf16 v[76:79], a[244:247], a[180:183], v[76:79]
    ds_read_b64_tr_b16 a[214:215], v206 offset:1032
    v_mfma_f32_16x16x32_bf16 v[84:87], a[244:247], a[184:187], v[84:87]
    buffer_load_dwordx4 v209, s[20:23], s55 offen offset:1024 lds
    v_mfma_f32_16x16x32_bf16 v[92:95], a[244:247], a[188:191], v[92:95]
    ds_read_b64_tr_b16 a[216:217], v207 offset:0
    ds_read_b64_tr_b16 a[218:219], v207 offset:1024
    v_mfma_f32_16x16x32_bf16 v[96:99], a[248:251], a[176:179], v[96:99]
    buffer_load_dwordx4 v210, s[20:23], s55 offen offset:2048 lds
    v_mfma_f32_16x16x32_bf16 v[104:107], a[248:251], a[180:183], v[104:107]
    ds_read_b64_tr_b16 a[220:221], v207 offset:8
    s_mov_b32 s19, 0x20000
    v_mfma_f32_16x16x32_bf16 v[112:115], a[248:251], a[184:187], v[112:115]
    buffer_load_dwordx4 v211, s[20:23], s55 offen offset:3072 lds
    v_mfma_f32_16x16x32_bf16 v[120:123], a[248:251], a[188:191], v[120:123]
    ds_read_b64_tr_b16 a[222:223], v207 offset:1032
    s_add_u32 s55, s55, 16384
    v_mfma_f32_16x16x32_bf16 v[100:103], a[252:255], a[176:179], v[100:103]
    v_mfma_f32_16x16x32_bf16 v[108:111], a[252:255], a[180:183], v[108:111]
    v_mfma_f32_16x16x32_bf16 v[116:119], a[252:255], a[184:187], v[116:119]
    s_and_b32 s55, s55, 0x7ffff
    v_mfma_f32_16x16x32_bf16 v[124:127], a[252:255], a[188:191], v[124:127]
    s_lshl_b32 s5, s30, 3
    s_waitcnt lgkmcnt(0)
    v_mfma_f32_16x16x32_bf16 v[0:3], a[192:195], a[160:163], v[0:3]
    ds_read_b128 a[176:179], v219 offset:14336
    s_add_u32 m0, s34, 0
    s_nop 0
    v_mfma_f32_16x16x32_bf16 v[8:11], a[192:195], a[164:167], v[8:11]
    ds_read_b128 a[180:183], v219 offset:14592
    v_mfma_f32_16x16x32_bf16 v[16:19], a[192:195], a[168:171], v[16:19]
    ds_read_b128 a[184:187], v219 offset:47104
    v_mfma_f32_16x16x32_bf16 v[24:27], a[192:195], a[172:175], v[24:27]
    buffer_load_dwordx4 v208, s[20:23], s55 offen lds
    v_mfma_f32_16x16x32_bf16 v[4:7], a[196:199], a[160:163], v[4:7]
    ds_read_b128 a[188:191], v219 offset:47360
    v_mfma_f32_16x16x32_bf16 v[12:15], a[196:199], a[164:167], v[12:15]
    s_waitcnt vmcnt(9)
    ds_read_b64_tr_b16 a[224:225], v204 offset:8192
    v_mfma_f32_16x16x32_bf16 v[20:23], a[196:199], a[168:171], v[20:23]
    buffer_load_dwordx4 v209, s[20:23], s55 offen offset:1024 lds
    v_mfma_f32_16x16x32_bf16 v[28:31], a[196:199], a[172:175], v[28:31]
    ds_read_b64_tr_b16 a[226:227], v204 offset:9216
    s_add_u32 s5, s5, s29
    v_mfma_f32_16x16x32_bf16 v[32:35], a[200:203], a[160:163], v[32:35]
    ds_read_b64_tr_b16 a[228:229], v204 offset:8200
    v_mfma_f32_16x16x32_bf16 v[40:43], a[200:203], a[164:167], v[40:43]
    buffer_load_dwordx4 v210, s[20:23], s55 offen offset:2048 lds
    v_mfma_f32_16x16x32_bf16 v[48:51], a[200:203], a[168:171], v[48:51]
    ds_read_b64_tr_b16 a[230:231], v204 offset:9224
    v_mfma_f32_16x16x32_bf16 v[56:59], a[200:203], a[172:175], v[56:59]
    ds_read_b64_tr_b16 a[232:233], v205 offset:8192
    v_mfma_f32_16x16x32_bf16 v[36:39], a[204:207], a[160:163], v[36:39]
    buffer_load_dwordx4 v211, s[20:23], s55 offen offset:3072 lds
    v_mfma_f32_16x16x32_bf16 v[44:47], a[204:207], a[164:167], v[44:47]
    ds_read_b64_tr_b16 a[234:235], v205 offset:9216
    s_add_u32 s55, s55, 16384
    v_mfma_f32_16x16x32_bf16 v[52:55], a[204:207], a[168:171], v[52:55]
    ds_read_b64_tr_b16 a[236:237], v205 offset:8200
    s_lshl_b32 s5, s5, 13
    s_nop 0
    v_mfma_f32_16x16x32_bf16 v[60:63], a[204:207], a[172:175], v[60:63]
    ds_read_b64_tr_b16 a[238:239], v205 offset:9224
    s_add_u32 m0, s34, 4096
    v_mfma_f32_16x16x32_bf16 v[64:67], a[208:211], a[160:163], v[64:67]
    ds_read_b64_tr_b16 a[240:241], v206 offset:8192
    v_mfma_f32_16x16x32_bf16 v[72:75], a[208:211], a[164:167], v[72:75]
    buffer_load_dwordx4 v208, s[20:23], s55 offen lds
    v_mfma_f32_16x16x32_bf16 v[80:83], a[208:211], a[168:171], v[80:83]
    ds_read_b64_tr_b16 a[242:243], v206 offset:9216
    v_mfma_f32_16x16x32_bf16 v[88:91], a[208:211], a[172:175], v[88:91]
    ds_read_b64_tr_b16 a[244:245], v206 offset:8200
    v_mfma_f32_16x16x32_bf16 v[68:71], a[212:215], a[160:163], v[68:71]
    buffer_load_dwordx4 v209, s[20:23], s55 offen offset:1024 lds
    v_mfma_f32_16x16x32_bf16 v[76:79], a[212:215], a[164:167], v[76:79]
    ds_read_b64_tr_b16 a[246:247], v206 offset:9224
    v_and_b32_e64 v227, 7, v220
    v_mfma_f32_16x16x32_bf16 v[84:87], a[212:215], a[168:171], v[84:87]
    ds_read_b64_tr_b16 a[248:249], v207 offset:8192
    v_mfma_f32_16x16x32_bf16 v[92:95], a[212:215], a[172:175], v[92:95]
    buffer_load_dwordx4 v210, s[20:23], s55 offen offset:2048 lds
    v_mfma_f32_16x16x32_bf16 v[96:99], a[216:219], a[160:163], v[96:99]
    ds_read_b64_tr_b16 a[250:251], v207 offset:9216
    v_mfma_f32_16x16x32_bf16 v[104:107], a[216:219], a[164:167], v[104:107]
    ds_read_b64_tr_b16 a[252:253], v207 offset:8200
    v_mfma_f32_16x16x32_bf16 v[112:115], a[216:219], a[168:171], v[112:115]
    buffer_load_dwordx4 v211, s[20:23], s55 offen offset:3072 lds
    v_mfma_f32_16x16x32_bf16 v[120:123], a[216:219], a[172:175], v[120:123]
    ds_read_b64_tr_b16 a[254:255], v207 offset:9224
    s_add_u32 s55, s55, 16384
    v_mfma_f32_16x16x32_bf16 v[100:103], a[220:223], a[160:163], v[100:103]
    v_lshrrev_b32_e64 v228, 3, v220
    v_mfma_f32_16x16x32_bf16 v[108:111], a[220:223], a[164:167], v[108:111]
    v_mfma_f32_16x16x32_bf16 v[116:119], a[220:223], a[168:171], v[116:119]
    s_and_b32 s55, s55, 0x7ffff
    v_mfma_f32_16x16x32_bf16 v[124:127], a[220:223], a[172:175], v[124:127]
    s_waitcnt lgkmcnt(0)
    s_nop 0
    v_mfma_f32_16x16x32_bf16 v[0:3], a[224:227], a[176:179], v[0:3]
    ds_read_b128 a[160:163], v219 offset:16384
    s_add_u32 m0, s34, 8192
    v_mfma_f32_16x16x32_bf16 v[8:11], a[224:227], a[180:183], v[8:11]
    ds_read_b128 a[164:167], v219 offset:16640
    v_mfma_f32_16x16x32_bf16 v[16:19], a[224:227], a[184:187], v[16:19]
    ds_read_b128 a[168:171], v219 offset:49152
    v_mfma_f32_16x16x32_bf16 v[24:27], a[224:227], a[188:191], v[24:27]
    v_lshl_add_u32 v228, s28, 4, v228
    v_mfma_f32_16x16x32_bf16 v[4:7], a[228:231], a[176:179], v[4:7]
    buffer_load_dwordx4 v208, s[20:23], s55 offen lds
    v_mfma_f32_16x16x32_bf16 v[12:15], a[228:231], a[180:183], v[12:15]
    ds_read_b128 a[172:175], v219 offset:49408
    v_mfma_f32_16x16x32_bf16 v[20:23], a[228:231], a[184:187], v[20:23]
    s_waitcnt vmcnt(9)
    s_nop 0
    ds_read_b64_tr_b16 a[192:193], v200 offset:0
    v_mfma_f32_16x16x32_bf16 v[28:31], a[228:231], a[188:191], v[28:31]
    buffer_load_dwordx4 v209, s[20:23], s55 offen offset:1024 lds
    v_mfma_f32_16x16x32_bf16 v[32:35], a[232:235], a[176:179], v[32:35]
    ds_read_b64_tr_b16 a[194:195], v200 offset:1024
    ds_read_b64_tr_b16 a[196:197], v200 offset:8
    v_mfma_f32_16x16x32_bf16 v[40:43], a[232:235], a[180:183], v[40:43]
    buffer_load_dwordx4 v210, s[20:23], s55 offen offset:2048 lds
    v_mfma_f32_16x16x32_bf16 v[48:51], a[232:235], a[184:187], v[48:51]
    ds_read_b64_tr_b16 a[198:199], v200 offset:1032
    v_lshlrev_b32_e64 v192, 10, v227
    v_mfma_f32_16x16x32_bf16 v[56:59], a[232:235], a[188:191], v[56:59]
    ds_read_b64_tr_b16 a[200:201], v201 offset:0
    v_mfma_f32_16x16x32_bf16 v[36:39], a[236:239], a[176:179], v[36:39]
    buffer_load_dwordx4 v211, s[20:23], s55 offen offset:3072 lds
    v_mfma_f32_16x16x32_bf16 v[44:47], a[236:239], a[180:183], v[44:47]
    ds_read_b64_tr_b16 a[202:203], v201 offset:1024
    s_add_u32 s55, s55, 16384
    v_mfma_f32_16x16x32_bf16 v[52:55], a[236:239], a[184:187], v[52:55]
    ds_read_b64_tr_b16 a[204:205], v201 offset:8
    v_mfma_f32_16x16x32_bf16 v[60:63], a[236:239], a[188:191], v[60:63]
    ds_read_b64_tr_b16 a[206:207], v201 offset:1032
    s_add_u32 m0, s34, 12288
    v_mfma_f32_16x16x32_bf16 v[64:67], a[240:243], a[176:179], v[64:67]
    ds_read_b64_tr_b16 a[208:209], v202 offset:0
    v_mfma_f32_16x16x32_bf16 v[72:75], a[240:243], a[180:183], v[72:75]
    v_lshl_add_u32 v192, v228, 4, v192
    v_mfma_f32_16x16x32_bf16 v[80:83], a[240:243], a[184:187], v[80:83]
    ds_read_b64_tr_b16 a[210:211], v202 offset:1024
    v_mfma_f32_16x16x32_bf16 v[88:91], a[240:243], a[188:191], v[88:91]
    buffer_load_dwordx4 v208, s[20:23], s55 offen lds
    v_mfma_f32_16x16x32_bf16 v[68:71], a[244:247], a[176:179], v[68:71]
    ds_read_b64_tr_b16 a[212:213], v202 offset:8
    v_mfma_f32_16x16x32_bf16 v[76:79], a[244:247], a[180:183], v[76:79]
    ds_read_b64_tr_b16 a[214:215], v202 offset:1032
    v_mfma_f32_16x16x32_bf16 v[84:87], a[244:247], a[184:187], v[84:87]
    buffer_load_dwordx4 v209, s[20:23], s55 offen offset:1024 lds
    v_mfma_f32_16x16x32_bf16 v[92:95], a[244:247], a[188:191], v[92:95]
    ds_read_b64_tr_b16 a[216:217], v203 offset:0
    ds_read_b64_tr_b16 a[218:219], v203 offset:1024
    v_mfma_f32_16x16x32_bf16 v[96:99], a[248:251], a[176:179], v[96:99]
    buffer_load_dwordx4 v210, s[20:23], s55 offen offset:2048 lds
    v_mfma_f32_16x16x32_bf16 v[104:107], a[248:251], a[180:183], v[104:107]
    ds_read_b64_tr_b16 a[220:221], v203 offset:8
    v_lshlrev_b32_e64 v193, 5, v228
    v_mfma_f32_16x16x32_bf16 v[112:115], a[248:251], a[184:187], v[112:115]
    buffer_load_dwordx4 v211, s[20:23], s55 offen offset:3072 lds
    v_mfma_f32_16x16x32_bf16 v[120:123], a[248:251], a[188:191], v[120:123]
    ds_read_b64_tr_b16 a[222:223], v203 offset:1032
    s_add_u32 s55, s55, 16384
    v_mfma_f32_16x16x32_bf16 v[100:103], a[252:255], a[176:179], v[100:103]
    v_mfma_f32_16x16x32_bf16 v[108:111], a[252:255], a[180:183], v[108:111]
    v_mfma_f32_16x16x32_bf16 v[116:119], a[252:255], a[184:187], v[116:119]
    s_and_b32 s55, s55, 0x7ffff
    v_mfma_f32_16x16x32_bf16 v[124:127], a[252:255], a[188:191], v[124:127]
    s_waitcnt lgkmcnt(0)
    v_mfma_f32_16x16x32_bf16 v[0:3], a[192:195], a[160:163], v[0:3]
    ds_read_b128 a[176:179], v219 offset:18432
    s_add_u32 m0, s31, 0
    v_mfma_f32_16x16x32_bf16 v[8:11], a[192:195], a[164:167], v[8:11]
    buffer_load_dword v194, v238, s[16:19], 0 offen sc1
    v_mfma_f32_16x16x32_bf16 v[16:19], a[192:195], a[168:171], v[16:19]
    ds_read_b128 a[180:183], v219 offset:18688
    ds_read_b128 a[184:187], v219 offset:51200
    v_mfma_f32_16x16x32_bf16 v[24:27], a[192:195], a[172:175], v[24:27]
    buffer_load_dwordx4 v208, s[20:23], s55 offen lds
    v_mfma_f32_16x16x32_bf16 v[4:7], a[196:199], a[160:163], v[4:7]
    ds_read_b128 a[188:191], v219 offset:51456
    v_mfma_f32_16x16x32_bf16 v[12:15], a[196:199], a[164:167], v[12:15]
    s_waitcnt vmcnt(10)
    s_nop 0
    ds_read_b64_tr_b16 a[224:225], v204 offset:0
    v_mfma_f32_16x16x32_bf16 v[20:23], a[196:199], a[168:171], v[20:23]
    buffer_load_dwordx4 v209, s[20:23], s55 offen offset:1024 lds
    v_mfma_f32_16x16x32_bf16 v[28:31], a[196:199], a[172:175], v[28:31]
    ds_read_b64_tr_b16 a[226:227], v204 offset:1024
    v_mfma_f32_16x16x32_bf16 v[32:35], a[200:203], a[160:163], v[32:35]
    ds_read_b64_tr_b16 a[228:229], v204 offset:8
    v_mfma_f32_16x16x32_bf16 v[40:43], a[200:203], a[164:167], v[40:43]
    buffer_load_dwordx4 v210, s[20:23], s55 offen offset:2048 lds
    v_mfma_f32_16x16x32_bf16 v[48:51], a[200:203], a[168:171], v[48:51]
    ds_read_b64_tr_b16 a[230:231], v204 offset:1032
    v_mfma_f32_16x16x32_bf16 v[56:59], a[200:203], a[172:175], v[56:59]
    ds_read_b64_tr_b16 a[232:233], v205 offset:0
    v_mfma_f32_16x16x32_bf16 v[36:39], a[204:207], a[160:163], v[36:39]
    buffer_load_dwordx4 v211, s[20:23], s55 offen offset:3072 lds
    v_mfma_f32_16x16x32_bf16 v[44:47], a[204:207], a[164:167], v[44:47]
    ds_read_b64_tr_b16 a[234:235], v205 offset:1024
    s_add_u32 s55, s55, 16384
    v_mfma_f32_16x16x32_bf16 v[52:55], a[204:207], a[168:171], v[52:55]
    ds_read_b64_tr_b16 a[236:237], v205 offset:8
    v_mfma_f32_16x16x32_bf16 v[60:63], a[204:207], a[172:175], v[60:63]
    ds_read_b64_tr_b16 a[238:239], v205 offset:1032
    s_add_u32 m0, s31, 16384
    v_mfma_f32_16x16x32_bf16 v[64:67], a[208:211], a[160:163], v[64:67]
    ds_read_b64_tr_b16 a[240:241], v206 offset:0
    v_mfma_f32_16x16x32_bf16 v[72:75], a[208:211], a[164:167], v[72:75]
    buffer_load_dwordx4 v208, s[20:23], s55 offen lds
    v_mfma_f32_16x16x32_bf16 v[80:83], a[208:211], a[168:171], v[80:83]
    ds_read_b64_tr_b16 a[242:243], v206 offset:1024
    v_mfma_f32_16x16x32_bf16 v[88:91], a[208:211], a[172:175], v[88:91]
    ds_read_b64_tr_b16 a[244:245], v206 offset:8
    v_mfma_f32_16x16x32_bf16 v[68:71], a[212:215], a[160:163], v[68:71]
    buffer_load_dwordx4 v209, s[20:23], s55 offen offset:1024 lds
    v_mfma_f32_16x16x32_bf16 v[76:79], a[212:215], a[164:167], v[76:79]
    ds_read_b64_tr_b16 a[246:247], v206 offset:1032
    v_mfma_f32_16x16x32_bf16 v[84:87], a[212:215], a[168:171], v[84:87]
    ds_read_b64_tr_b16 a[248:249], v207 offset:0
    v_mfma_f32_16x16x32_bf16 v[92:95], a[212:215], a[172:175], v[92:95]
    buffer_load_dwordx4 v210, s[20:23], s55 offen offset:2048 lds
    v_mfma_f32_16x16x32_bf16 v[96:99], a[216:219], a[160:163], v[96:99]
    ds_read_b64_tr_b16 a[250:251], v207 offset:1024
    v_mfma_f32_16x16x32_bf16 v[104:107], a[216:219], a[164:167], v[104:107]
    ds_read_b64_tr_b16 a[252:253], v207 offset:8
    v_mfma_f32_16x16x32_bf16 v[112:115], a[216:219], a[168:171], v[112:115]
    buffer_load_dwordx4 v211, s[20:23], s55 offen offset:3072 lds
    v_mfma_f32_16x16x32_bf16 v[120:123], a[216:219], a[172:175], v[120:123]
    ds_read_b64_tr_b16 a[254:255], v207 offset:1032
    s_add_u32 s55, s55, 16384
    v_mfma_f32_16x16x32_bf16 v[100:103], a[220:223], a[160:163], v[100:103]
    v_mfma_f32_16x16x32_bf16 v[108:111], a[220:223], a[164:167], v[108:111]
    v_mfma_f32_16x16x32_bf16 v[116:119], a[220:223], a[168:171], v[116:119]
    s_and_b32 s55, s55, 0x7ffff
    v_mfma_f32_16x16x32_bf16 v[124:127], a[220:223], a[172:175], v[124:127]
    s_waitcnt lgkmcnt(0)
    v_mfma_f32_16x16x32_bf16 v[0:3], a[224:227], a[176:179], v[0:3]
    ds_read_b128 a[160:163], v219 offset:20480
    s_add_u32 m0, s34, 0
    v_mfma_f32_16x16x32_bf16 v[8:11], a[224:227], a[180:183], v[8:11]
    ds_read_b128 a[164:167], v219 offset:20736
    v_mfma_f32_16x16x32_bf16 v[16:19], a[224:227], a[184:187], v[16:19]
    ds_read_b128 a[168:171], v219 offset:53248
    v_mfma_f32_16x16x32_bf16 v[24:27], a[224:227], a[188:191], v[24:27]
    buffer_load_dwordx4 v208, s[20:23], s55 offen lds
    v_mfma_f32_16x16x32_bf16 v[4:7], a[228:231], a[176:179], v[4:7]
    ds_read_b128 a[172:175], v219 offset:53504
    v_mfma_f32_16x16x32_bf16 v[12:15], a[228:231], a[180:183], v[12:15]
    s_waitcnt vmcnt(10)
    s_nop 0
    ds_read_b64_tr_b16 a[192:193], v204 offset:8192
    v_mfma_f32_16x16x32_bf16 v[20:23], a[228:231], a[184:187], v[20:23]
    buffer_load_dwordx4 v209, s[20:23], s55 offen offset:1024 lds
    v_mfma_f32_16x16x32_bf16 v[28:31], a[228:231], a[188:191], v[28:31]
    ds_read_b64_tr_b16 a[194:195], v204 offset:9216
    v_mfma_f32_16x16x32_bf16 v[32:35], a[232:235], a[176:179], v[32:35]
    ds_read_b64_tr_b16 a[196:197], v204 offset:8200
    v_mfma_f32_16x16x32_bf16 v[40:43], a[232:235], a[180:183], v[40:43]
    buffer_load_dwordx4 v210, s[20:23], s55 offen offset:2048 lds
    v_mfma_f32_16x16x32_bf16 v[48:51], a[232:235], a[184:187], v[48:51]
    ds_read_b64_tr_b16 a[198:199], v204 offset:9224
    v_mfma_f32_16x16x32_bf16 v[56:59], a[232:235], a[188:191], v[56:59]
    ds_read_b64_tr_b16 a[200:201], v205 offset:8192
    v_mfma_f32_16x16x32_bf16 v[36:39], a[236:239], a[176:179], v[36:39]
    buffer_load_dwordx4 v211, s[20:23], s55 offen offset:3072 lds
    v_mfma_f32_16x16x32_bf16 v[44:47], a[236:239], a[180:183], v[44:47]
    ds_read_b64_tr_b16 a[202:203], v205 offset:9216
    s_add_u32 s55, s55, 16384
    v_mfma_f32_16x16x32_bf16 v[52:55], a[236:239], a[184:187], v[52:55]
    ds_read_b64_tr_b16 a[204:205], v205 offset:8200
    v_mfma_f32_16x16x32_bf16 v[60:63], a[236:239], a[188:191], v[60:63]
    ds_read_b64_tr_b16 a[206:207], v205 offset:9224
    s_add_u32 m0, s34, 4096
    v_mfma_f32_16x16x32_bf16 v[64:67], a[240:243], a[176:179], v[64:67]
    ds_read_b64_tr_b16 a[208:209], v206 offset:8192
    v_mfma_f32_16x16x32_bf16 v[72:75], a[240:243], a[180:183], v[72:75]
    buffer_load_dwordx4 v208, s[20:23], s55 offen lds
    v_mfma_f32_16x16x32_bf16 v[80:83], a[240:243], a[184:187], v[80:83]
    ds_read_b64_tr_b16 a[210:211], v206 offset:9216
    v_mfma_f32_16x16x32_bf16 v[88:91], a[240:243], a[188:191], v[88:91]
    ds_read_b64_tr_b16 a[212:213], v206 offset:8200
    v_mfma_f32_16x16x32_bf16 v[68:71], a[244:247], a[176:179], v[68:71]
    buffer_load_dwordx4 v209, s[20:23], s55 offen offset:1024 lds
    v_mfma_f32_16x16x32_bf16 v[76:79], a[244:247], a[180:183], v[76:79]
    ds_read_b64_tr_b16 a[214:215], v206 offset:9224
    v_mfma_f32_16x16x32_bf16 v[84:87], a[244:247], a[184:187], v[84:87]
    ds_read_b64_tr_b16 a[216:217], v207 offset:8192
    v_mfma_f32_16x16x32_bf16 v[92:95], a[244:247], a[188:191], v[92:95]
    buffer_load_dwordx4 v210, s[20:23], s55 offen offset:2048 lds
    v_mfma_f32_16x16x32_bf16 v[96:99], a[248:251], a[176:179], v[96:99]
    ds_read_b64_tr_b16 a[218:219], v207 offset:9216
    v_mfma_f32_16x16x32_bf16 v[104:107], a[248:251], a[180:183], v[104:107]
    ds_read_b64_tr_b16 a[220:221], v207 offset:8200
    v_mfma_f32_16x16x32_bf16 v[112:115], a[248:251], a[184:187], v[112:115]
    buffer_load_dwordx4 v211, s[20:23], s55 offen offset:3072 lds
    v_mfma_f32_16x16x32_bf16 v[120:123], a[248:251], a[188:191], v[120:123]
    ds_read_b64_tr_b16 a[222:223], v207 offset:9224
    s_add_u32 s55, s55, 16384
    v_mfma_f32_16x16x32_bf16 v[100:103], a[252:255], a[176:179], v[100:103]
    v_mfma_f32_16x16x32_bf16 v[108:111], a[252:255], a[180:183], v[108:111]
    v_mfma_f32_16x16x32_bf16 v[116:119], a[252:255], a[184:187], v[116:119]
    s_and_b32 s55, s55, 0x7ffff
    v_mfma_f32_16x16x32_bf16 v[124:127], a[252:255], a[188:191], v[124:127]
    s_waitcnt lgkmcnt(0)
    s_nop 0
    v_mfma_f32_16x16x32_bf16 v[0:3], a[192:195], a[160:163], v[0:3]
    ds_read_b128 a[176:179], v219 offset:22528
    s_add_u32 m0, s34, 8192
    v_mfma_f32_16x16x32_bf16 v[8:11], a[192:195], a[164:167], v[8:11]
    ds_read_b128 a[180:183], v219 offset:22784
    v_mfma_f32_16x16x32_bf16 v[16:19], a[192:195], a[168:171], v[16:19]
    ds_read_b128 a[184:187], v219 offset:55296
    v_mfma_f32_16x16x32_bf16 v[24:27], a[192:195], a[172:175], v[24:27]
    buffer_load_dwordx4 v208, s[20:23], s55 offen lds
    v_mfma_f32_16x16x32_bf16 v[4:7], a[196:199], a[160:163], v[4:7]
    ds_read_b128 a[188:191], v219 offset:55552
    v_mfma_f32_16x16x32_bf16 v[12:15], a[196:199], a[164:167], v[12:15]
    s_waitcnt vmcnt(9)
    s_nop 0
    ds_read_b64_tr_b16 a[224:225], v200 offset:0
    v_mfma_f32_16x16x32_bf16 v[20:23], a[196:199], a[168:171], v[20:23]
    buffer_load_dwordx4 v209, s[20:23], s55 offen offset:1024 lds
    v_mfma_f32_16x16x32_bf16 v[28:31], a[196:199], a[172:175], v[28:31]
    ds_read_b64_tr_b16 a[226:227], v200 offset:1024
    v_mfma_f32_16x16x32_bf16 v[32:35], a[200:203], a[160:163], v[32:35]
    ds_read_b64_tr_b16 a[228:229], v200 offset:8
    v_mfma_f32_16x16x32_bf16 v[40:43], a[200:203], a[164:167], v[40:43]
    buffer_load_dwordx4 v210, s[20:23], s55 offen offset:2048 lds
    v_mfma_f32_16x16x32_bf16 v[48:51], a[200:203], a[168:171], v[48:51]
    ds_read_b64_tr_b16 a[230:231], v200 offset:1032
    v_mfma_f32_16x16x32_bf16 v[56:59], a[200:203], a[172:175], v[56:59]
    ds_read_b64_tr_b16 a[232:233], v201 offset:0
    v_mfma_f32_16x16x32_bf16 v[36:39], a[204:207], a[160:163], v[36:39]
    buffer_load_dwordx4 v211, s[20:23], s55 offen offset:3072 lds
    v_mfma_f32_16x16x32_bf16 v[44:47], a[204:207], a[164:167], v[44:47]
    ds_read_b64_tr_b16 a[234:235], v201 offset:1024
    s_add_u32 s55, s55, 16384
    v_mfma_f32_16x16x32_bf16 v[52:55], a[204:207], a[168:171], v[52:55]
    ds_read_b64_tr_b16 a[236:237], v201 offset:8
    v_mfma_f32_16x16x32_bf16 v[60:63], a[204:207], a[172:175], v[60:63]
    ds_read_b64_tr_b16 a[238:239], v201 offset:1032
    s_add_u32 m0, s34, 12288
    v_mfma_f32_16x16x32_bf16 v[64:67], a[208:211], a[160:163], v[64:67]
    ds_read_b64_tr_b16 a[240:241], v202 offset:0
    v_mfma_f32_16x16x32_bf16 v[72:75], a[208:211], a[164:167], v[72:75]
    buffer_load_dwordx4 v208, s[20:23], s55 offen lds
    v_mfma_f32_16x16x32_bf16 v[80:83], a[208:211], a[168:171], v[80:83]
    ds_read_b64_tr_b16 a[242:243], v202 offset:1024
STUB7:
    s_cbranch_execz STUB11
    s_nop 0
    v_mfma_f32_16x16x32_bf16 v[88:91], a[208:211], a[172:175], v[88:91]
    ds_read_b64_tr_b16 a[244:245], v202 offset:8
    v_mfma_f32_16x16x32_bf16 v[68:71], a[212:215], a[160:163], v[68:71]
    buffer_load_dwordx4 v209, s[20:23], s55 offen offset:1024 lds
    v_mfma_f32_16x16x32_bf16 v[76:79], a[212:215], a[164:167], v[76:79]
    ds_read_b64_tr_b16 a[246:247], v202 offset:1032
    v_mfma_f32_16x16x32_bf16 v[84:87], a[212:215], a[168:171], v[84:87]
    ds_read_b64_tr_b16 a[248:249], v203 offset:0
    v_mfma_f32_16x16x32_bf16 v[92:95], a[212:215], a[172:175], v[92:95]
    buffer_load_dwordx4 v210, s[20:23], s55 offen offset:2048 lds
    v_mfma_f32_16x16x32_bf16 v[96:99], a[216:219], a[160:163], v[96:99]
    ds_read_b64_tr_b16 a[250:251], v203 offset:1024
    v_mfma_f32_16x16x32_bf16 v[104:107], a[216:219], a[164:167], v[104:107]
    ds_read_b64_tr_b16 a[252:253], v203 offset:8
    v_mfma_f32_16x16x32_bf16 v[112:115], a[216:219], a[168:171], v[112:115]
    buffer_load_dwordx4 v211, s[20:23], s55 offen offset:3072 lds
    v_mfma_f32_16x16x32_bf16 v[120:123], a[216:219], a[172:175], v[120:123]
    ds_read_b64_tr_b16 a[254:255], v203 offset:1032
    s_add_u32 s55, s55, 16384
    v_mfma_f32_16x16x32_bf16 v[100:103], a[220:223], a[160:163], v[100:103]
    v_mfma_f32_16x16x32_bf16 v[108:111], a[220:223], a[164:167], v[108:111]
    v_mfma_f32_16x16x32_bf16 v[116:119], a[220:223], a[168:171], v[116:119]
    s_and_b32 s55, s55, 0x7ffff
    v_mfma_f32_16x16x32_bf16 v[124:127], a[220:223], a[172:175], v[124:127]
    s_waitcnt lgkmcnt(0)
    v_mfma_f32_16x16x32_bf16 v[0:3], a[224:227], a[176:179], v[0:3]
    ds_read_b128 a[160:163], v219 offset:24576
    s_add_u32 m0, s31, 0
    v_mfma_f32_16x16x32_bf16 v[8:11], a[224:227], a[180:183], v[8:11]
    ds_read_b128 a[164:167], v219 offset:24832
    v_mfma_f32_16x16x32_bf16 v[16:19], a[224:227], a[184:187], v[16:19]
    ds_read_b128 a[168:171], v219 offset:57344
    v_mfma_f32_16x16x32_bf16 v[24:27], a[224:227], a[188:191], v[24:27]
    buffer_load_dwordx4 v208, s[20:23], s55 offen lds
    v_mfma_f32_16x16x32_bf16 v[4:7], a[228:231], a[176:179], v[4:7]
    ds_read_b128 a[172:175], v219 offset:57600
    v_mfma_f32_16x16x32_bf16 v[12:15], a[228:231], a[180:183], v[12:15]
    s_waitcnt vmcnt(9)
    s_nop 0
    ds_read_b64_tr_b16 a[192:193], v204 offset:0
    v_mfma_f32_16x16x32_bf16 v[20:23], a[228:231], a[184:187], v[20:23]
    buffer_load_dwordx4 v209, s[20:23], s55 offen offset:1024 lds
    v_mfma_f32_16x16x32_bf16 v[28:31], a[228:231], a[188:191], v[28:31]
    ds_read_b64_tr_b16 a[194:195], v204 offset:1024
    v_mfma_f32_16x16x32_bf16 v[32:35], a[232:235], a[176:179], v[32:35]
    ds_read_b64_tr_b16 a[196:197], v204 offset:8
    v_mfma_f32_16x16x32_bf16 v[40:43], a[232:235], a[180:183], v[40:43]
    buffer_load_dwordx4 v210, s[20:23], s55 offen offset:2048 lds
    v_mfma_f32_16x16x32_bf16 v[48:51], a[232:235], a[184:187], v[48:51]
    ds_read_b64_tr_b16 a[198:199], v204 offset:1032
    v_mfma_f32_16x16x32_bf16 v[56:59], a[232:235], a[188:191], v[56:59]
    ds_read_b64_tr_b16 a[200:201], v205 offset:0
    v_mfma_f32_16x16x32_bf16 v[36:39], a[236:239], a[176:179], v[36:39]
    buffer_load_dwordx4 v211, s[20:23], s55 offen offset:3072 lds
    v_mfma_f32_16x16x32_bf16 v[44:47], a[236:239], a[180:183], v[44:47]
    ds_read_b64_tr_b16 a[202:203], v205 offset:1024
    s_add_u32 s55, s55, 16384
    v_mfma_f32_16x16x32_bf16 v[52:55], a[236:239], a[184:187], v[52:55]
    ds_read_b64_tr_b16 a[204:205], v205 offset:8
    v_mfma_f32_16x16x32_bf16 v[60:63], a[236:239], a[188:191], v[60:63]
    ds_read_b64_tr_b16 a[206:207], v205 offset:1032
    s_add_u32 m0, s31, 16384
    v_mfma_f32_16x16x32_bf16 v[64:67], a[240:243], a[176:179], v[64:67]
    ds_read_b64_tr_b16 a[208:209], v206 offset:0
    v_mfma_f32_16x16x32_bf16 v[72:75], a[240:243], a[180:183], v[72:75]
    buffer_load_dwordx4 v208, s[20:23], s55 offen lds
    v_mfma_f32_16x16x32_bf16 v[80:83], a[240:243], a[184:187], v[80:83]
    ds_read_b64_tr_b16 a[210:211], v206 offset:1024
    v_mfma_f32_16x16x32_bf16 v[88:91], a[240:243], a[188:191], v[88:91]
    ds_read_b64_tr_b16 a[212:213], v206 offset:8
    v_mfma_f32_16x16x32_bf16 v[68:71], a[244:247], a[176:179], v[68:71]
    buffer_load_dwordx4 v209, s[20:23], s55 offen offset:1024 lds
    v_mfma_f32_16x16x32_bf16 v[76:79], a[244:247], a[180:183], v[76:79]
    ds_read_b64_tr_b16 a[214:215], v206 offset:1032
    v_mfma_f32_16x16x32_bf16 v[84:87], a[244:247], a[184:187], v[84:87]
    ds_read_b64_tr_b16 a[216:217], v207 offset:0
    v_mfma_f32_16x16x32_bf16 v[92:95], a[244:247], a[188:191], v[92:95]
    buffer_load_dwordx4 v210, s[20:23], s55 offen offset:2048 lds
    v_mfma_f32_16x16x32_bf16 v[96:99], a[248:251], a[176:179], v[96:99]
    ds_read_b64_tr_b16 a[218:219], v207 offset:1024
    v_mfma_f32_16x16x32_bf16 v[104:107], a[248:251], a[180:183], v[104:107]
    ds_read_b64_tr_b16 a[220:221], v207 offset:8
    v_mfma_f32_16x16x32_bf16 v[112:115], a[248:251], a[184:187], v[112:115]
    buffer_load_dwordx4 v211, s[20:23], s55 offen offset:3072 lds
    v_mfma_f32_16x16x32_bf16 v[120:123], a[248:251], a[188:191], v[120:123]
    ds_read_b64_tr_b16 a[222:223], v207 offset:1032
    s_add_u32 s55, s55, 16384
    v_mfma_f32_16x16x32_bf16 v[100:103], a[252:255], a[176:179], v[100:103]
    v_mfma_f32_16x16x32_bf16 v[108:111], a[252:255], a[180:183], v[108:111]
    v_mfma_f32_16x16x32_bf16 v[116:119], a[252:255], a[184:187], v[116:119]
    s_and_b32 s55, s55, 0x7ffff
    v_mfma_f32_16x16x32_bf16 v[124:127], a[252:255], a[188:191], v[124:127]
    s_waitcnt lgkmcnt(0)
    v_mfma_f32_16x16x32_bf16 v[0:3], a[192:195], a[160:163], v[0:3]
    ds_read_b128 a[176:179], v219 offset:26624
    s_add_u32 m0, s34, 0
    v_mfma_f32_16x16x32_bf16 v[8:11], a[192:195], a[164:167], v[8:11]
    ds_read_b128 a[180:183], v219 offset:26880
    v_mfma_f32_16x16x32_bf16 v[16:19], a[192:195], a[168:171], v[16:19]
    ds_read_b128 a[184:187], v219 offset:59392
    v_mfma_f32_16x16x32_bf16 v[24:27], a[192:195], a[172:175], v[24:27]
    buffer_load_dwordx4 v208, s[20:23], s55 offen lds
    v_mfma_f32_16x16x32_bf16 v[4:7], a[196:199], a[160:163], v[4:7]
    ds_read_b128 a[188:191], v219 offset:59648
    v_mfma_f32_16x16x32_bf16 v[12:15], a[196:199], a[164:167], v[12:15]
    s_waitcnt vmcnt(9)
    s_nop 0
    ds_read_b64_tr_b16 a[224:225], v204 offset:8192
    v_mfma_f32_16x16x32_bf16 v[20:23], a[196:199], a[168:171], v[20:23]
    buffer_load_dwordx4 v209, s[20:23], s55 offen offset:1024 lds
    v_mfma_f32_16x16x32_bf16 v[28:31], a[196:199], a[172:175], v[28:31]
    ds_read_b64_tr_b16 a[226:227], v204 offset:9216
    v_mfma_f32_16x16x32_bf16 v[32:35], a[200:203], a[160:163], v[32:35]
    ds_read_b64_tr_b16 a[228:229], v204 offset:8200
    v_mfma_f32_16x16x32_bf16 v[40:43], a[200:203], a[164:167], v[40:43]
    buffer_load_dwordx4 v210, s[20:23], s55 offen offset:2048 lds
    v_mfma_f32_16x16x32_bf16 v[48:51], a[200:203], a[168:171], v[48:51]
    ds_read_b64_tr_b16 a[230:231], v204 offset:9224
    v_mfma_f32_16x16x32_bf16 v[56:59], a[200:203], a[172:175], v[56:59]
    ds_read_b64_tr_b16 a[232:233], v205 offset:8192
    v_mfma_f32_16x16x32_bf16 v[36:39], a[204:207], a[160:163], v[36:39]
    buffer_load_dwordx4 v211, s[20:23], s55 offen offset:3072 lds
    v_mfma_f32_16x16x32_bf16 v[44:47], a[204:207], a[164:167], v[44:47]
    ds_read_b64_tr_b16 a[234:235], v205 offset:9216
    s_add_u32 s55, s55, 16384
    v_mfma_f32_16x16x32_bf16 v[52:55], a[204:207], a[168:171], v[52:55]
    ds_read_b64_tr_b16 a[236:237], v205 offset:8200
    v_mfma_f32_16x16x32_bf16 v[60:63], a[204:207], a[172:175], v[60:63]
    ds_read_b64_tr_b16 a[238:239], v205 offset:9224
    s_add_u32 m0, s34, 4096
    v_mfma_f32_16x16x32_bf16 v[64:67], a[208:211], a[160:163], v[64:67]
    ds_read_b64_tr_b16 a[240:241], v206 offset:8192
    v_mfma_f32_16x16x32_bf16 v[72:75], a[208:211], a[164:167], v[72:75]
    buffer_load_dwordx4 v208, s[20:23], s55 offen lds
    v_mfma_f32_16x16x32_bf16 v[80:83], a[208:211], a[168:171], v[80:83]
    ds_read_b64_tr_b16 a[242:243], v206 offset:9216
    v_mfma_f32_16x16x32_bf16 v[88:91], a[208:211], a[172:175], v[88:91]
    ds_read_b64_tr_b16 a[244:245], v206 offset:8200
    v_mfma_f32_16x16x32_bf16 v[68:71], a[212:215], a[160:163], v[68:71]
    buffer_load_dwordx4 v209, s[20:23], s55 offen offset:1024 lds
    v_mfma_f32_16x16x32_bf16 v[76:79], a[212:215], a[164:167], v[76:79]
    ds_read_b64_tr_b16 a[246:247], v206 offset:9224
    v_mfma_f32_16x16x32_bf16 v[84:87], a[212:215], a[168:171], v[84:87]
    ds_read_b64_tr_b16 a[248:249], v207 offset:8192
    v_mfma_f32_16x16x32_bf16 v[92:95], a[212:215], a[172:175], v[92:95]
    buffer_load_dwordx4 v210, s[20:23], s55 offen offset:2048 lds
    v_mfma_f32_16x16x32_bf16 v[96:99], a[216:219], a[160:163], v[96:99]
    ds_read_b64_tr_b16 a[250:251], v207 offset:9216
    v_mfma_f32_16x16x32_bf16 v[104:107], a[216:219], a[164:167], v[104:107]
    ds_read_b64_tr_b16 a[252:253], v207 offset:8200
    v_mfma_f32_16x16x32_bf16 v[112:115], a[216:219], a[168:171], v[112:115]
    buffer_load_dwordx4 v211, s[20:23], s55 offen offset:3072 lds
    v_mfma_f32_16x16x32_bf16 v[120:123], a[216:219], a[172:175], v[120:123]
    ds_read_b64_tr_b16 a[254:255], v207 offset:9224
    s_add_u32 s55, s55, 16384
    v_mfma_f32_16x16x32_bf16 v[100:103], a[220:223], a[160:163], v[100:103]
    v_mfma_f32_16x16x32_bf16 v[108:111], a[220:223], a[164:167], v[108:111]
    v_mfma_f32_16x16x32_bf16 v[116:119], a[220:223], a[168:171], v[116:119]
    s_and_b32 s55, s55, 0x7ffff
    v_mfma_f32_16x16x32_bf16 v[124:127], a[220:223], a[172:175], v[124:127]
    s_waitcnt lgkmcnt(0)
    v_mfma_f32_16x16x32_bf16 v[0:3], a[224:227], a[176:179], v[0:3]
    ds_read_b128 a[160:163], v219 offset:28672
    v_mfma_f32_16x16x32_bf16 v[8:11], a[224:227], a[180:183], v[8:11]
    s_mov_b32 s3, 0
    s_branch CCHK
CPOLL:
    buffer_load_dword v194, v238, s[16:19], 0 offen sc1
    s_waitcnt vmcnt(0)
CCHK:
    s_add_u32 s3, s3, 1
    v_cmp_gt_u32 vcc, 0x100, v194
    s_cmp_gt_u32 s3, 0x8000
    s_cbranch_scc1 CDONE
    s_nop 2
    s_cbranch_vccnz CPOLL
CDONE:
    v_mfma_f32_16x16x32_bf16 v[16:19], a[224:227], a[184:187], v[16:19]
    ds_read_b128 a[164:167], v219 offset:28928
    ds_read_b128 a[168:171], v219 offset:61440
    v_mfma_f32_16x16x32_bf16 v[24:27], a[224:227], a[188:191], v[24:27]
    ds_read_b128 a[172:175], v219 offset:61696
    v_mfma_f32_16x16x32_bf16 v[4:7], a[228:231], a[176:179], v[4:7]
    s_waitcnt vmcnt(8)
    s_nop 0
    ds_read_b64_tr_b16 a[192:193], v200 offset:0
    v_mfma_f32_16x16x32_bf16 v[12:15], a[228:231], a[180:183], v[12:15]
    buffer_load_dwordx4 v[128:131], v192, s[12:15], s5 offen offset:0
    v_mfma_f32_16x16x32_bf16 v[20:23], a[228:231], a[184:187], v[20:23]
    ds_read_b64_tr_b16 a[194:195], v200 offset:1024
    ds_read_b64_tr_b16 a[196:197], v200 offset:8
    v_mfma_f32_16x16x32_bf16 v[28:31], a[228:231], a[188:191], v[28:31]
    buffer_load_dwordx4 v[132:135], v192, s[12:15], s5 offen offset:128
    v_mfma_f32_16x16x32_bf16 v[32:35], a[232:235], a[176:179], v[32:35]
    ds_read_b64_tr_b16 a[198:199], v200 offset:1032
    ds_read_b64_tr_b16 a[200:201], v201 offset:0
    v_mfma_f32_16x16x32_bf16 v[40:43], a[232:235], a[180:183], v[40:43]
    ds_read_b64_tr_b16 a[202:203], v201 offset:1024
    s_mov_b32 s4, 4096
    v_mfma_f32_16x16x32_bf16 v[48:51], a[232:235], a[184:187], v[48:51]
    v_mfma_f32_16x16x32_bf16 v[56:59], a[232:235], a[188:191], v[56:59]
    ds_read_b64_tr_b16 a[204:205], v201 offset:8
    v_mfma_f32_16x16x32_bf16 v[36:39], a[236:239], a[176:179], v[36:39]
    ds_read_b64_tr_b16 a[206:207], v201 offset:1032
    v_mfma_f32_16x16x32_bf16 v[44:47], a[236:239], a[180:183], v[44:47]
    buffer_load_dwordx4 v[136:139], v193, s[24:27], s4 offen offset:0 sc1
    v_mfma_f32_16x16x32_bf16 v[52:55], a[236:239], a[184:187], v[52:55]
    ds_read_b64_tr_b16 a[208:209], v202 offset:0
    v_mfma_f32_16x16x32_bf16 v[60:63], a[236:239], a[188:191], v[60:63]
    ds_read_b64_tr_b16 a[210:211], v202 offset:1024
    ds_read_b64_tr_b16 a[212:213], v202 offset:8
    v_mfma_f32_16x16x32_bf16 v[64:67], a[240:243], a[176:179], v[64:67]
    buffer_load_dwordx4 v[140:143], v193, s[24:27], s4 offen offset:16 sc1
    v_mfma_f32_16x16x32_bf16 v[72:75], a[240:243], a[180:183], v[72:75]
    ds_read_b64_tr_b16 a[214:215], v202 offset:1032
    ds_read_b64_tr_b16 a[216:217], v203 offset:0
    v_mfma_f32_16x16x32_bf16 v[80:83], a[240:243], a[184:187], v[80:83]
    buffer_load_dwordx4 v[144:147], v193, s[24:27], s4 offen offset:256 sc1
    v_mfma_f32_16x16x32_bf16 v[88:91], a[240:243], a[188:191], v[88:91]
    ds_read_b64_tr_b16 a[218:219], v203 offset:1024
    ds_read_b64_tr_b16 a[220:221], v203 offset:8
    v_mfma_f32_16x16x32_bf16 v[68:71], a[244:247], a[176:179], v[68:71]
    buffer_load_dwordx4 v[148:151], v193, s[24:27], s4 offen offset:272 sc1
    v_mfma_f32_16x16x32_bf16 v[76:79], a[244:247], a[180:183], v[76:79]
    ds_read_b64_tr_b16 a[222:223], v203 offset:1032
    s_mov_b32 s4, 8192
    v_mfma_f32_16x16x32_bf16 v[84:87], a[244:247], a[184:187], v[84:87]
    ds_read_b128 a[32:35], v219 offset:30720
    v_mfma_f32_16x16x32_bf16 v[92:95], a[244:247], a[188:191], v[92:95]
    ds_read_b128 a[36:39], v219 offset:30976
    v_mfma_f32_16x16x32_bf16 v[96:99], a[248:251], a[176:179], v[96:99]
    ds_read_b128 a[40:43], v219 offset:63488
    v_mfma_f32_16x16x32_bf16 v[104:107], a[248:251], a[180:183], v[104:107]
    buffer_load_dwordx4 v[152:155], v193, s[24:27], s4 offen offset:0 sc1
    v_mfma_f32_16x16x32_bf16 v[112:115], a[248:251], a[184:187], v[112:115]
    ds_read_b128 a[44:47], v219 offset:63744
    v_mfma_f32_16x16x32_bf16 v[120:123], a[248:251], a[188:191], v[120:123]
    s_waitcnt vmcnt(7)
    s_nop 0
    ds_read_b64_tr_b16 a[0:1], v204 offset:0
    v_mfma_f32_16x16x32_bf16 v[100:103], a[252:255], a[176:179], v[100:103]
    buffer_load_dwordx4 v[156:159], v193, s[24:27], s4 offen offset:16 sc1
    v_mfma_f32_16x16x32_bf16 v[108:111], a[252:255], a[180:183], v[108:111]
    ds_read_b64_tr_b16 a[2:3], v204 offset:1024
    ds_read_b64_tr_b16 a[4:5], v204 offset:8
    v_mfma_f32_16x16x32_bf16 v[116:119], a[252:255], a[184:187], v[116:119]
    buffer_load_dwordx4 v[160:163], v193, s[24:27], s4 offen offset:256 sc1
    v_mfma_f32_16x16x32_bf16 v[124:127], a[252:255], a[188:191], v[124:127]
    ds_read_b64_tr_b16 a[6:7], v204 offset:1032
    s_waitcnt lgkmcnt(8)
    s_nop 0
    v_mfma_f32_16x16x32_bf16 v[0:3], a[192:195], a[160:163], v[0:3]
    ds_read_b64_tr_b16 a[8:9], v205 offset:0
    ds_read_b64_tr_b16 a[10:11], v205 offset:1024
    v_mfma_f32_16x16x32_bf16 v[8:11], a[192:195], a[164:167], v[8:11]
    buffer_load_dwordx4 v[164:167], v193, s[24:27], s4 offen offset:272 sc1
    v_mfma_f32_16x16x32_bf16 v[16:19], a[192:195], a[168:171], v[16:19]
    ds_read_b64_tr_b16 a[12:13], v205 offset:8
    ds_read_b64_tr_b16 a[14:15], v205 offset:1032
    v_mfma_f32_16x16x32_bf16 v[24:27], a[192:195], a[172:175], v[24:27]
    s_mov_b32 s4, 6144
    v_mfma_f32_16x16x32_bf16 v[4:7], a[196:199], a[160:163], v[4:7]
    ds_read_b64_tr_b16 a[16:17], v206 offset:0
    v_mfma_f32_16x16x32_bf16 v[12:15], a[196:199], a[164:167], v[12:15]
    buffer_load_dwordx4 v[168:171], v193, s[24:27], s4 offen offset:0 sc1
    v_mfma_f32_16x16x32_bf16 v[20:23], a[196:199], a[168:171], v[20:23]
    ds_read_b64_tr_b16 a[18:19], v206 offset:1024
    v_mfma_f32_16x16x32_bf16 v[28:31], a[196:199], a[172:175], v[28:31]
    ds_read_b64_tr_b16 a[20:21], v206 offset:8
    s_waitcnt lgkmcnt(9)
    s_nop 0
    v_mfma_f32_16x16x32_bf16 v[0:3], a[0:3], a[32:35], v[0:3]
    buffer_load_dwordx4 v[172:175], v193, s[24:27], s4 offen offset:16 sc1
    v_mfma_f32_16x16x32_bf16 v[8:11], a[0:3], a[36:39], v[8:11]
    ds_read_b64_tr_b16 a[22:23], v206 offset:1032
    v_mfma_f32_16x16x32_bf16 v[16:19], a[0:3], a[40:43], v[16:19]
    ds_read_b64_tr_b16 a[24:25], v207 offset:0
    v_mfma_f32_16x16x32_bf16 v[24:27], a[0:3], a[44:47], v[24:27]
    buffer_load_dwordx4 v[176:179], v193, s[24:27], s4 offen offset:256 sc1
    s_waitcnt lgkmcnt(9)
    s_nop 0
    v_mfma_f32_16x16x32_bf16 v[4:7], a[4:7], a[32:35], v[4:7]
    ds_read_b64_tr_b16 a[26:27], v207 offset:1024
    v_mfma_f32_16x16x32_bf16 v[12:15], a[4:7], a[36:39], v[12:15]
    buffer_load_dwordx4 v[180:183], v193, s[24:27], s4 offen offset:272 sc1
    v_mfma_f32_16x16x32_bf16 v[20:23], a[4:7], a[40:43], v[20:23]
    ds_read_b64_tr_b16 a[28:29], v207 offset:8
    ds_read_b64_tr_b16 a[30:31], v207 offset:1032
    v_mfma_f32_16x16x32_bf16 v[28:31], a[4:7], a[44:47], v[28:31]
    v_mfma_f32_16x16x32_bf16 v[32:35], a[200:203], a[160:163], v[32:35]
    v_mfma_f32_16x16x32_bf16 v[40:43], a[200:203], a[164:167], v[40:43]
    v_mfma_f32_16x16x32_bf16 v[48:51], a[200:203], a[168:171], v[48:51]
    v_cmp_nlt_f32 vcc, |v0|, v239
    s_nop 0
    s_or_b64 s[62:63], s[62:63], vcc
    v_mfma_f32_16x16x32_bf16 v[56:59], a[200:203], a[172:175], v[56:59]
    v_cmp_nlt_f32 vcc, |v8|, v239
    s_nop 0
    s_or_b64 s[62:63], s[62:63], vcc
    v_mfma_f32_16x16x32_bf16 v[36:39], a[204:207], a[160:163], v[36:39]
    v_cmp_nlt_f32 vcc, |v16|, v239
    s_nop 0
    s_or_b64 s[62:63], s[62:63], vcc
    v_mfma_f32_16x16x32_bf16 v[44:47], a[204:207], a[164:167], v[44:47]
    v_cmp_nlt_f32 vcc, |v24|, v239
    s_nop 0
    s_or_b64 s[62:63], s[62:63], vcc
    s_cselect_b32 s3, 1, 0
    v_mov_b32 v236, s3
    v_mfma_f32_16x16x32_bf16 v[52:55], a[204:207], a[168:171], v[52:55]
    s_add_u32 s33, s51, 0
    v_cvt_pk_bf16_f32 v0, v0, v1
    v_mfma_f32_16x16x32_bf16 v[60:63], a[204:207], a[172:175], v[60:63]
    v_cvt_pk_bf16_f32 v1, v2, v3
    v_cvt_pk_bf16_f32 v2, v4, v5
    s_waitcnt lgkmcnt(10)
    v_mfma_f32_16x16x32_bf16 v[32:35], a[8:11], a[32:35], v[32:35]
    v_cvt_pk_bf16_f32 v3, v6, v7
    v_mfma_f32_16x16x32_bf16 v[40:43], a[8:11], a[36:39], v[40:43]
    buffer_store_dwordx4 v[0:3], v231, s[24:27], s33 offen offset:0 sc1
    v_mfma_f32_16x16x32_bf16 v[48:51], a[8:11], a[40:43], v[48:51]
    v_cvt_pk_bf16_f32 v8, v8, v9
    v_cvt_pk_bf16_f32 v9, v10, v11
    v_mfma_f32_16x16x32_bf16 v[56:59], a[8:11], a[44:47], v[56:59]
    v_cvt_pk_bf16_f32 v10, v12, v13
    v_cvt_pk_bf16_f32 v11, v14, v15
    s_waitcnt lgkmcnt(8)
    s_nop 0
    v_mfma_f32_16x16x32_bf16 v[36:39], a[12:15], a[32:35], v[36:39]
    buffer_store_dwordx4 v[8:11], v231, s[24:27], s33 offen offset:256 sc1
    v_mfma_f32_16x16x32_bf16 v[44:47], a[12:15], a[36:39], v[44:47]
    s_add_u32 s33, s51, 32768
    v_cvt_pk_bf16_f32 v16, v16, v17
    v_mfma_f32_16x16x32_bf16 v[52:55], a[12:15], a[40:43], v[52:55]
    v_cvt_pk_bf16_f32 v17, v18, v19
    v_cvt_pk_bf16_f32 v18, v20, v21
    v_mfma_f32_16x16x32_bf16 v[60:63], a[12:15], a[44:47], v[60:63]
    v_cvt_pk_bf16_f32 v19, v22, v23
    v_mfma_f32_16x16x32_bf16 v[64:67], a[208:211], a[160:163], v[64:67]
    buffer_store_dwordx4 v[16:19], v231, s[24:27], s33 offen offset:0 sc1
    v_mfma_f32_16x16x32_bf16 v[72:75], a[208:211], a[164:167], v[72:75]
    v_cvt_pk_bf16_f32 v24, v24, v25
    v_cvt_pk_bf16_f32 v25, v26, v27
    v_cvt_pk_bf16_f32 v26, v28, v29
    v_cvt_pk_bf16_f32 v27, v30, v31
    buffer_store_dwordx4 v[24:27], v231, s[24:27], s33 offen offset:256 sc1
    v_mfma_f32_16x16x32_bf16 v[80:83], a[208:211], a[168:171], v[80:83]
    s_add_u32 s33, s51, 2048
    v_cvt_pk_bf16_f32 v32, v32, v33
    v_mfma_f32_16x16x32_bf16 v[88:91], a[208:211], a[172:175], v[88:91]
    v_cvt_pk_bf16_f32 v33, v34, v35
    v_mfma_f32_16x16x32_bf16 v[68:71], a[212:215], a[160:163], v[68:71]
    v_cvt_pk_bf16_f32 v34, v36, v37
    v_cvt_pk_bf16_f32 v35, v38, v39
    v_mfma_f32_16x16x32_bf16 v[76:79], a[212:215], a[164:167], v[76:79]
    buffer_store_dwordx4 v[32:35], v231, s[24:27], s33 offen offset:0 sc1
    v_mfma_f32_16x16x32_bf16 v[84:87], a[212:215], a[168:171], v[84:87]
    v_cvt_pk_bf16_f32 v40, v40, v41
    v_cvt_pk_bf16_f32 v41, v42, v43
    v_mfma_f32_16x16x32_bf16 v[92:95], a[212:215], a[172:175], v[92:95]
    v_cvt_pk_bf16_f32 v42, v44, v45
    s_waitcnt lgkmcnt(6)
    s_nop 0
    v_mfma_f32_16x16x32_bf16 v[64:67], a[16:19], a[32:35], v[64:67]
    v_cvt_pk_bf16_f32 v43, v46, v47
    v_mfma_f32_16x16x32_bf16 v[72:75], a[16:19], a[36:39], v[72:75]
    buffer_store_dwordx4 v[40:43], v231, s[24:27], s33 offen offset:256 sc1
    v_mfma_f32_16x16x32_bf16 v[80:83], a[16:19], a[40:43], v[80:83]
    s_add_u32 s33, s51, 34816
    v_cvt_pk_bf16_f32 v48, v48, v49
    v_mfma_f32_16x16x32_bf16 v[88:91], a[16:19], a[44:47], v[88:91]
    v_cvt_pk_bf16_f32 v49, v50, v51
    s_waitcnt lgkmcnt(4)
    s_nop 0
    v_mfma_f32_16x16x32_bf16 v[68:71], a[20:23], a[32:35], v[68:71]
    v_cvt_pk_bf16_f32 v50, v52, v53
    v_cvt_pk_bf16_f32 v51, v54, v55
    v_mfma_f32_16x16x32_bf16 v[76:79], a[20:23], a[36:39], v[76:79]
    buffer_store_dwordx4 v[48:51], v231, s[24:27], s33 offen offset:0 sc1
    v_mfma_f32_16x16x32_bf16 v[84:87], a[20:23], a[40:43], v[84:87]
    v_cvt_pk_bf16_f32 v56, v56, v57
    v_cvt_pk_bf16_f32 v57, v58, v59
    v_mfma_f32_16x16x32_bf16 v[92:95], a[20:23], a[44:47], v[92:95]
    v_cvt_pk_bf16_f32 v58, v60, v61
    v_mfma_f32_16x16x32_bf16 v[96:99], a[216:219], a[160:163], v[96:99]
    v_cvt_pk_bf16_f32 v59, v62, v63
    v_mfma_f32_16x16x32_bf16 v[104:107], a[216:219], a[164:167], v[104:107]
    buffer_store_dwordx4 v[56:59], v231, s[24:27], s33 offen offset:256 sc1
    v_mfma_f32_16x16x32_bf16 v[112:115], a[216:219], a[168:171], v[112:115]
    s_add_u32 s33, s51, 4096
    v_cvt_pk_bf16_f32 v64, v64, v65
    v_mfma_f32_16x16x32_bf16 v[120:123], a[216:219], a[172:175], v[120:123]
    v_cvt_pk_bf16_f32 v65, v66, v67
    v_cvt_pk_bf16_f32 v66, v68, v69
    v_mfma_f32_16x16x32_bf16 v[100:103], a[220:223], a[160:163], v[100:103]
    v_cvt_pk_bf16_f32 v67, v70, v71
    v_mfma_f32_16x16x32_bf16 v[108:111], a[220:223], a[164:167], v[108:111]
    buffer_store_dwordx4 v[64:67], v231, s[24:27], s33 offen offset:0 sc1
    v_mfma_f32_16x16x32_bf16 v[116:119], a[220:223], a[168:171], v[116:119]
    v_cvt_pk_bf16_f32 v72, v72, v73
    v_cvt_pk_bf16_f32 v73, v74, v75
    v_mfma_f32_16x16x32_bf16 v[124:127], a[220:223], a[172:175], v[124:127]
    v_cvt_pk_bf16_f32 v74, v76, v77
    v_cvt_pk_bf16_f32 v75, v78, v79
    s_waitcnt lgkmcnt(2)
    s_nop 0
    v_mfma_f32_16x16x32_bf16 v[96:99], a[24:27], a[32:35], v[96:99]
    buffer_store_dwordx4 v[72:75], v231, s[24:27], s33 offen offset:256 sc1
    v_mfma_f32_16x16x32_bf16 v[104:107], a[24:27], a[36:39], v[104:107]
    s_add_u32 s33, s51, 36864
    v_cvt_pk_bf16_f32 v80, v80, v81
    v_mfma_f32_16x16x32_bf16 v[112:115], a[24:27], a[40:43], v[112:115]
    v_cvt_pk_bf16_f32 v81, v82, v83
    v_cvt_pk_bf16_f32 v82, v84, v85
    v_mfma_f32_16x16x32_bf16 v[120:123], a[24:27], a[44:47], v[120:123]
    v_cvt_pk_bf16_f32 v83, v86, v87
    s_waitcnt lgkmcnt(0)
    s_nop 0
    v_mfma_f32_16x16x32_bf16 v[100:103], a[28:31], a[32:35], v[100:103]
    buffer_store_dwordx4 v[80:83], v231, s[24:27], s33 offen offset:0 sc1
    v_mfma_f32_16x16x32_bf16 v[108:111], a[28:31], a[36:39], v[108:111]
    v_cvt_pk_bf16_f32 v88, v88, v89
    v_cvt_pk_bf16_f32 v89, v90, v91
    v_mfma_f32_16x16x32_bf16 v[116:119], a[28:31], a[40:43], v[116:119]
    v_cvt_pk_bf16_f32 v90, v92, v93
    v_cvt_pk_bf16_f32 v91, v94, v95
    v_mfma_f32_16x16x32_bf16 v[124:127], a[28:31], a[44:47], v[124:127]
    buffer_store_dwordx4 v[88:91], v231, s[24:27], s33 offen offset:256 sc1
    ds_write_b32 v237, v236
    s_add_u32 s33, s51, 6144
    v_cvt_pk_bf16_f32 v96, v96, v97
    v_cvt_pk_bf16_f32 v97, v98, v99
    v_cvt_pk_bf16_f32 v98, v100, v101
    v_cvt_pk_bf16_f32 v99, v102, v103
    buffer_store_dwordx4 v[96:99], v231, s[24:27], s33 offen offset:0 sc1
    v_cvt_pk_bf16_f32 v104, v104, v105
    v_cvt_pk_bf16_f32 v105, v106, v107
    v_cvt_pk_bf16_f32 v106, v108, v109
    v_cvt_pk_bf16_f32 v107, v110, v111
    buffer_store_dwordx4 v[104:107], v231, s[24:27], s33 offen offset:256 sc1
    s_add_u32 s33, s51, 38912
    v_cvt_pk_bf16_f32 v112, v112, v113
    v_cvt_pk_bf16_f32 v113, v114, v115
    v_cvt_pk_bf16_f32 v114, v116, v117
    v_cvt_pk_bf16_f32 v115, v118, v119
    buffer_store_dwordx4 v[112:115], v231, s[24:27], s33 offen offset:0 sc1
    v_cvt_pk_bf16_f32 v120, v120, v121
    v_cvt_pk_bf16_f32 v121, v122, v123
    v_cvt_pk_bf16_f32 v122, v124, v125
    v_cvt_pk_bf16_f32 v123, v126, v127
    buffer_store_dwordx4 v[120:123], v231, s[24:27], s33 offen offset:256 sc1
    s_waitcnt lgkmcnt(0)
    s_barrier
    ds_read_b32 v244, v243
    s_waitcnt lgkmcnt(0)
    v_cmp_lt_u32 vcc, s39, v244
    s_nop 4
    s_cbranch_vccnz FALLBACK
    s_lshl_b32 s3, s30, 3
    s_add_u32 s3, s3, s29
    s_lshr_b32 s4, s3, 2
    s_lshl_b32 s4, s4, 15
    s_and_b32 s6, s3, 3
    s_lshl_b32 s6, s6, 7
    s_add_u32 s4, s4, s6
    s_lshl_b32 s7, s3, 7
    s_add_u32 s7, s7, 0x20000
    s_lshl_b32 s6, s30, 10
    s_add_u32 s6, s6, 0x20000
    s_mov_b32 s20, s70
    s_and_b32 s21, s71, 0xffff
    s_mov_b32 s22, 0x100000
    s_mov_b32 s23, 0x20000
    s_mov_b32 s46, s8
    s_mov_b32 s47, s9
    v_lshlrev_b32 v248, 7, v220
    v_mov_b32 v250, 1
    v_lshl_add_u32 v251, s28, 6, v220
    v_lshlrev_b32_e64 v251, 20, v251
    s_and_b32 s31, s2, 7
    s_lshr_b32 s33, s2, 3
    s_and_b32 s29, s31, 3
    s_lshl_b32 s29, s29, 2
    s_and_b32 s30, s33, 3
    s_add_u32 s29, s29, s30
    s_lshr_b32 s30, s31, 2
    s_lshl_b32 s30, s30, 3
    s_lshr_b32 s33, s33, 2
    s_add_u32 s30, s30, s33
    s_and_b32 s33, s33, 7
    s_mov_b32 s36, s33
    s_mov_b32 s39, s33
    s_lshr_b32 s37, s28, 1
    s_and_b32 s31, s28, 1
    s_lshl_b32 s32, s29, 7
    s_mul_i32 s35, s31, 114688
    s_add_u32 s32, s32, s35
    s_mul_i32 s66, s29, 96
    s_add_u32 s66, s66, s35
    v_lshrrev_b32_e64 v237, 3, v220
    v_bfe_u32 v238, v220, 4, 1
    v_lshlrev_b32 v238, 2, v238
    v_and_b32 v239, 7, v220
    v_xor_b32 v239, v239, v238
    s_lshl_b32 s35, s37, 1
    v_xor_b32_e64 v240, s35, v239
    v_mul_u32_u24 v224, 3584, v237
    v_lshl_add_u32 v224, v240, 4, v224
    v_add_u32_e64 v224, s32, v224
    v_add_u32 v225, 27648, v224
    v_add_u32 v226, 55296, v224
    v_add_u32 v227, 82944, v224
    v_lshlrev_b32_e64 v252, 10, v237
    v_lshl_add_u32 v252, v239, 4, v252
    s_mov_b32 s35, 10923
    v_add_u32 v237, 0, v220
    v_mul_u32_u24 v238, s35, v237
    v_lshrrev_b32 v238, 16, v238
    v_mul_u32_u24 v239, 6, v238
    v_sub_u32_e64 v239, v237, v239
    v_mul_u32_u24 v238, 3584, v238
    v_lshl_add_u32 v238, v239, 4, v238
    v_add_u32_e64 v238, s66, v238
    v_add_u32 v228, 2048, v238
    v_add_u32 v237, 64, v220
    v_mul_u32_u24 v238, s35, v237
    v_lshrrev_b32 v238, 16, v238
    v_mul_u32_u24 v239, 6, v238
    v_sub_u32_e64 v239, v237, v239
    v_mul_u32_u24 v238, 3584, v238
    v_lshl_add_u32 v238, v239, 4, v238
    v_add_u32_e64 v238, s66, v238
    v_add_u32 v229, 1024, v238
    v_add_u32 v237, 128, v220
    v_mul_u32_u24 v238, s35, v237
    v_lshrrev_b32 v238, 16, v238
    v_mul_u32_u24 v239, 6, v238
    v_sub_u32 v239, v237, v239
    v_mul_u32_u24 v238, 3584, v238
    v_lshl_add_u32 v238, v239, 4, v238
    v_add_u32 v238, s66, v238
    v_add_u32_e64 v230, 0, v238
    s_lshl_b32 s35, s37, 16
    s_lshl_b32 s32, s31, 12
    s_add_u32 s64, s35, s32
    s_mul_i32 s32, s31, 3072
    s_mul_i32 s65, s37, 65664
    s_add_u32 s65, s65, s32
    s_mul_i32 s35, s37, 12416
    s_add_u32 s35, s35, s32
    s_add_u32 s35, s35, 131072
    s_cmp_eq_u32 s37, 0
    s_cselect_b32 s8, s40, s44
    s_cselect_b32 s9, s41, s45
    s_and_b32 s9, s9, 0xffff
    s_mov_b32 s10, 1835008
    s_mov_b32 s11, 0x20000
    s_lshl_b32 s32, s30, 2
    s_add_u32 s32, s32, s28
    s_lshl_b32 s32, s32, 15
    s_add_u32 s38, s32, 0x1600000
    s_lshl_b32 s34, s30, 11
    s_add_u32 s34, s34, 0x28000
    v_bfe_u32 v240, v220, 2, 2
    v_and_b32 v241, 1, v220
    v_lshlrev_b32_e64 v241, 1, v241
    v_bfe_u32 v244, v220, 1, 1
    v_or_b32_e64 v241, v241, v244
    v_bfe_u32 v242, v220, 4, 1
    v_lshrrev_b32_e64 v243, 5, v220
    v_lshl_add_u32 v244, v243, 3, v240
    v_lshlrev_b32_e64 v237, 7, v244
STUB8:
    s_cbranch_execz STUB12
    s_nop 0
    v_lshl_add_u32 v237, v242, 16, v237
    v_lshl_add_u32 v237, v241, 3, v237
    v_lshrrev_b32_e64 v238, 1, v240
    v_lshl_add_u32 v237, v238, 6, v237
    v_lshl_add_u32 v231, v242, 5, v237
    v_xor_b32 v232, 32, v231
    v_xor_b32 v233, 64, v231
    v_xor_b32 v234, 96, v231
    v_mul_u32_u24 v237, 96, v244
    v_lshl_add_u32 v237, v241, 3, v237
    v_mul_u32_u24 v238, 65664, v242
    v_add_u32_e64 v235, v237, v238
    v_mul_u32_u24 v238, 12416, v242
    v_add_u32_e64 v236, v237, v238
    v_add_u32 v236, 131072, v236
    s_waitcnt vmcnt(0)
    s_barrier
    buffer_store_dword v250, v251, s[20:23], s7 offen sc1
    v_and_b32 v1, 7, v220
    v_lshrrev_b32 v7, 3, v220
    v_lshl_add_u32 v7, s28, 4, v7
    v_lshlrev_b32_e64 v3, 9, v7
    v_lshl_add_u32 v3, v1, 4, v3
    v_add_u32 v2, 4096, v3
    v_lshlrev_b32_e64 v8, 4, v1
    v_add_u32 v8, 163584, v8
    v_lshl_add_u32 v9, s28, 2, v8
    s_mul_i32 s31, s33, 229376
    s_add_u32 m0, s64, 0
    s_add_u32 s33, s33, 1
    s_and_b32 s33, s33, 7
    buffer_load_dwordx4 v224, s[8:11], s31 offen offset:0 lds
    buffer_load_dwordx4 v225, s[8:11], s31 offen offset:1024 lds
    buffer_load_dwordx4 v226, s[8:11], s31 offen offset:2048 lds
    buffer_load_dwordx4 v227, s[8:11], s31 offen offset:3072 lds
    s_mul_i32 s31, s33, 229376
    s_add_u32 m0, s64, 8192
    s_add_u32 s33, s33, 1
    s_and_b32 s33, s33, 7
    buffer_load_dwordx4 v224, s[8:11], s31 offen offset:0 lds
    buffer_load_dwordx4 v225, s[8:11], s31 offen offset:1024 lds
    buffer_load_dwordx4 v226, s[8:11], s31 offen offset:2048 lds
    buffer_load_dwordx4 v227, s[8:11], s31 offen offset:3072 lds
    s_mul_i32 s31, s33, 229376
    s_add_u32 m0, s64, 16384
    s_add_u32 s33, s33, 1
    s_and_b32 s33, s33, 7
    buffer_load_dwordx4 v224, s[8:11], s31 offen offset:0 lds
    buffer_load_dwordx4 v225, s[8:11], s31 offen offset:1024 lds
    buffer_load_dwordx4 v226, s[8:11], s31 offen offset:2048 lds
    buffer_load_dwordx4 v227, s[8:11], s31 offen offset:3072 lds
    s_mul_i32 s31, s33, 229376
    s_add_u32 m0, s64, 24576
    s_add_u32 s33, s33, 1
    s_and_b32 s33, s33, 7
    buffer_load_dwordx4 v224, s[8:11], s31 offen offset:0 lds
    buffer_load_dwordx4 v225, s[8:11], s31 offen offset:1024 lds
    buffer_load_dwordx4 v226, s[8:11], s31 offen offset:2048 lds
    buffer_load_dwordx4 v227, s[8:11], s31 offen offset:3072 lds
    s_mul_i32 s31, s33, 229376
    s_add_u32 m0, s64, 32768
    s_add_u32 s33, s33, 1
    s_and_b32 s33, s33, 7
    buffer_load_dwordx4 v224, s[8:11], s31 offen offset:0 lds
    buffer_load_dwordx4 v225, s[8:11], s31 offen offset:1024 lds
    buffer_load_dwordx4 v226, s[8:11], s31 offen offset:2048 lds
    buffer_load_dwordx4 v227, s[8:11], s31 offen offset:3072 lds
    s_mul_i32 s31, s33, 229376
    s_add_u32 m0, s64, 40960
    s_add_u32 s33, s33, 1
    s_and_b32 s33, s33, 7
    buffer_load_dwordx4 v224, s[8:11], s31 offen offset:0 lds
    buffer_load_dwordx4 v225, s[8:11], s31 offen offset:1024 lds
    buffer_load_dwordx4 v226, s[8:11], s31 offen offset:2048 lds
    buffer_load_dwordx4 v227, s[8:11], s31 offen offset:3072 lds
    s_mul_i32 s31, s33, 229376
    s_add_u32 m0, s64, 49152
    s_add_u32 s33, s33, 1
    s_and_b32 s33, s33, 7
    buffer_load_dwordx4 v224, s[8:11], s31 offen offset:0 lds
    buffer_load_dwordx4 v225, s[8:11], s31 offen offset:1024 lds
    buffer_load_dwordx4 v226, s[8:11], s31 offen offset:2048 lds
    buffer_load_dwordx4 v227, s[8:11], s31 offen offset:3072 lds
    s_mul_i32 s31, s33, 229376
    s_add_u32 m0, s64, 57344
    s_add_u32 s33, s33, 1
    s_and_b32 s33, s33, 7
    buffer_load_dwordx4 v224, s[8:11], s31 offen offset:0 lds
    buffer_load_dwordx4 v225, s[8:11], s31 offen offset:1024 lds
    buffer_load_dwordx4 v226, s[8:11], s31 offen offset:2048 lds
    buffer_load_dwordx4 v227, s[8:11], s31 offen offset:3072 lds
    s_cmp_lg_u32 s28, 0
    s_cbranch_scc1 NOPOLL_1
    s_mov_b64 exec, 0xff
    s_mov_b32 s3, 0
POLL_1:
    buffer_load_dword v249, v248, s[24:27], s6 offen sc1
    s_add_u32 s3, s3, 1
    s_waitcnt vmcnt(0)
    v_cmp_eq_u32_e64 vcc, 0, v249
    s_cmp_gt_u32 s3, 0x8000
    s_cbranch_scc1 POLLED_1
    s_nop 2
    s_cbranch_vccz POLLED_1
    s_sleep 4
    s_branch POLL_1
POLLED_1:
    s_mov_b64 exec, -1
NOPOLL_1:
    s_barrier
    s_nop 0
    s_add_u32 s66, s4, 0x400000
    buffer_load_dwordx4 v[64:67], v3, s[24:27], s66 offen sc1
    buffer_load_dwordx4 v[68:71], v2, s[24:27], s66 offen sc1
    s_add_u32 s66, s66, 0x200000
    buffer_load_dwordx4 v[72:75], v3, s[24:27], s66 offen sc1
    buffer_load_dwordx4 v[76:79], v2, s[24:27], s66 offen sc1
    s_add_u32 s66, s66, 0x200000
    buffer_load_dwordx4 v[80:83], v3, s[24:27], s66 offen sc1
    buffer_load_dwordx4 v[84:87], v2, s[24:27], s66 offen sc1
    s_add_u32 s66, s66, 0x200000
    buffer_load_dwordx4 v[88:91], v3, s[24:27], s66 offen sc1
    buffer_load_dwordx4 v[92:95], v2, s[24:27], s66 offen sc1
    s_add_u32 s66, s66, 0x200000
    buffer_load_dwordx4 v[96:99], v3, s[24:27], s66 offen sc1
    buffer_load_dwordx4 v[100:103], v2, s[24:27], s66 offen sc1
    s_add_u32 s66, s66, 0x200000
    buffer_load_dwordx4 v[104:107], v3, s[24:27], s66 offen sc1
    buffer_load_dwordx4 v[108:111], v2, s[24:27], s66 offen sc1
    s_add_u32 s66, s66, 0x200000
    buffer_load_dwordx4 v[112:115], v3, s[24:27], s66 offen sc1
    buffer_load_dwordx4 v[116:119], v2, s[24:27], s66 offen sc1
    s_add_u32 s66, s66, 0x200000
    buffer_load_dwordx4 v[120:123], v3, s[24:27], s66 offen sc1
    buffer_load_dwordx4 v[124:127], v2, s[24:27], s66 offen sc1
    s_mov_b32 s67, 0xffff0000
    s_waitcnt vmcnt(15)
    v_lshlrev_b32 v24, 16, v64
    v_and_b32 v25, s67, v64
    v_lshlrev_b32 v26, 16, v65
    v_and_b32 v27, s67, v65
    v_lshlrev_b32 v28, 16, v66
    v_and_b32 v29, s67, v66
    v_lshlrev_b32 v30, 16, v67
    v_and_b32 v31, s67, v67
    s_waitcnt vmcnt(14)
    v_lshlrev_b32 v32, 16, v68
    v_and_b32 v33, s67, v68
    v_lshlrev_b32 v34, 16, v69
    v_and_b32 v35, s67, v69
    v_lshlrev_b32 v36, 16, v70
    v_and_b32 v37, s67, v70
    v_lshlrev_b32 v38, 16, v71
    v_and_b32 v39, s67, v71
    s_waitcnt vmcnt(13)
    v_lshlrev_b32 v10, 16, v72
    v_and_b32_e64 v11, s67, v72
    v_pk_add_f32 v[24:25], v[24:25], v[10:11]
    v_lshlrev_b32 v12, 16, v73
    v_and_b32 v13, s67, v73
    v_pk_add_f32 v[26:27], v[26:27], v[12:13]
    v_lshlrev_b32 v10, 16, v74
    v_and_b32 v11, s67, v74
    v_pk_add_f32 v[28:29], v[28:29], v[10:11]
    v_lshlrev_b32 v12, 16, v75
    v_and_b32 v13, s67, v75
    v_pk_add_f32 v[30:31], v[30:31], v[12:13]
    s_waitcnt vmcnt(12)
    v_lshlrev_b32 v10, 16, v76
    v_and_b32_e64 v11, s67, v76
    v_pk_add_f32 v[32:33], v[32:33], v[10:11]
    v_lshlrev_b32 v12, 16, v77
    v_and_b32 v13, s67, v77
    v_pk_add_f32 v[34:35], v[34:35], v[12:13]
    v_lshlrev_b32 v10, 16, v78
    v_and_b32 v11, s67, v78
    v_pk_add_f32 v[36:37], v[36:37], v[10:11]
    v_lshlrev_b32 v12, 16, v79
    v_and_b32 v13, s67, v79
    v_pk_add_f32 v[38:39], v[38:39], v[12:13]
    s_waitcnt vmcnt(11)
    v_lshlrev_b32 v10, 16, v80
    v_and_b32_e64 v11, s67, v80
    v_pk_add_f32 v[24:25], v[24:25], v[10:11]
    v_lshlrev_b32 v12, 16, v81
    v_and_b32 v13, s67, v81
    v_pk_add_f32 v[26:27], v[26:27], v[12:13]
    v_lshlrev_b32 v10, 16, v82
    v_and_b32 v11, s67, v82
    v_pk_add_f32 v[28:29], v[28:29], v[10:11]
    v_lshlrev_b32 v12, 16, v83
    v_and_b32 v13, s67, v83
    v_pk_add_f32 v[30:31], v[30:31], v[12:13]
    s_waitcnt vmcnt(10)
    v_lshlrev_b32 v10, 16, v84
    v_and_b32_e64 v11, s67, v84
    v_pk_add_f32 v[32:33], v[32:33], v[10:11]
    v_lshlrev_b32 v12, 16, v85
    v_and_b32 v13, s67, v85
    v_pk_add_f32 v[34:35], v[34:35], v[12:13]
    v_lshlrev_b32 v10, 16, v86
    v_and_b32 v11, s67, v86
    v_pk_add_f32 v[36:37], v[36:37], v[10:11]
    v_lshlrev_b32 v12, 16, v87
    v_and_b32 v13, s67, v87
    v_pk_add_f32 v[38:39], v[38:39], v[12:13]
    s_waitcnt vmcnt(9)
    v_lshlrev_b32 v10, 16, v88
    v_and_b32_e64 v11, s67, v88
    v_pk_add_f32 v[24:25], v[24:25], v[10:11]
    v_lshlrev_b32 v12, 16, v89
    v_and_b32 v13, s67, v89
    v_pk_add_f32 v[26:27], v[26:27], v[12:13]
    v_lshlrev_b32 v10, 16, v90
    v_and_b32 v11, s67, v90
    v_pk_add_f32 v[28:29], v[28:29], v[10:11]
    v_lshlrev_b32 v12, 16, v91
    v_and_b32 v13, s67, v91
    v_pk_add_f32 v[30:31], v[30:31], v[12:13]
    s_waitcnt vmcnt(8)
    v_lshlrev_b32 v10, 16, v92
    v_and_b32_e64 v11, s67, v92
    v_pk_add_f32 v[32:33], v[32:33], v[10:11]
    v_lshlrev_b32 v12, 16, v93
    v_and_b32 v13, s67, v93
    v_pk_add_f32 v[34:35], v[34:35], v[12:13]
    v_lshlrev_b32 v10, 16, v94
    v_and_b32 v11, s67, v94
    v_pk_add_f32 v[36:37], v[36:37], v[10:11]
    v_lshlrev_b32 v12, 16, v95
    v_and_b32 v13, s67, v95
    v_pk_add_f32 v[38:39], v[38:39], v[12:13]
    s_waitcnt vmcnt(7)
    v_lshlrev_b32 v10, 16, v96
    v_and_b32_e64 v11, s67, v96
    v_pk_add_f32 v[24:25], v[24:25], v[10:11]
    v_lshlrev_b32 v12, 16, v97
    v_and_b32 v13, s67, v97
    v_pk_add_f32 v[26:27], v[26:27], v[12:13]
    v_lshlrev_b32 v10, 16, v98
    v_and_b32 v11, s67, v98
    v_pk_add_f32 v[28:29], v[28:29], v[10:11]
    v_lshlrev_b32 v12, 16, v99
    v_and_b32 v13, s67, v99
    v_pk_add_f32 v[30:31], v[30:31], v[12:13]
    s_waitcnt vmcnt(6)
    v_lshlrev_b32 v10, 16, v100
    v_and_b32_e64 v11, s67, v100
    v_pk_add_f32 v[32:33], v[32:33], v[10:11]
    v_lshlrev_b32 v12, 16, v101
    v_and_b32 v13, s67, v101
    v_pk_add_f32 v[34:35], v[34:35], v[12:13]
    v_lshlrev_b32 v10, 16, v102
    v_and_b32 v11, s67, v102
    v_pk_add_f32 v[36:37], v[36:37], v[10:11]
    v_lshlrev_b32 v12, 16, v103
    v_and_b32 v13, s67, v103
    v_pk_add_f32 v[38:39], v[38:39], v[12:13]
    s_waitcnt vmcnt(5)
    v_lshlrev_b32 v10, 16, v104
    v_and_b32_e64 v11, s67, v104
    v_pk_add_f32 v[24:25], v[24:25], v[10:11]
    v_lshlrev_b32 v12, 16, v105
    v_and_b32 v13, s67, v105
    v_pk_add_f32 v[26:27], v[26:27], v[12:13]
    v_lshlrev_b32 v10, 16, v106
    v_and_b32 v11, s67, v106
    v_pk_add_f32 v[28:29], v[28:29], v[10:11]
    v_lshlrev_b32 v12, 16, v107
    v_and_b32 v13, s67, v107
    v_pk_add_f32 v[30:31], v[30:31], v[12:13]
    s_waitcnt vmcnt(4)
    v_lshlrev_b32 v10, 16, v108
    v_and_b32_e64 v11, s67, v108
    v_pk_add_f32 v[32:33], v[32:33], v[10:11]
    v_lshlrev_b32 v12, 16, v109
    v_and_b32 v13, s67, v109
    v_pk_add_f32 v[34:35], v[34:35], v[12:13]
    v_lshlrev_b32 v10, 16, v110
    v_and_b32 v11, s67, v110
    v_pk_add_f32 v[36:37], v[36:37], v[10:11]
    v_lshlrev_b32 v12, 16, v111
    v_and_b32 v13, s67, v111
    v_pk_add_f32 v[38:39], v[38:39], v[12:13]
    s_waitcnt vmcnt(3)
    v_lshlrev_b32 v10, 16, v112
    v_and_b32_e64 v11, s67, v112
    v_pk_add_f32 v[24:25], v[24:25], v[10:11]
    v_lshlrev_b32 v12, 16, v113
    v_and_b32 v13, s67, v113
    v_pk_add_f32 v[26:27], v[26:27], v[12:13]
    v_lshlrev_b32 v10, 16, v114
    v_and_b32 v11, s67, v114
    v_pk_add_f32 v[28:29], v[28:29], v[10:11]
    v_lshlrev_b32 v12, 16, v115
    v_and_b32 v13, s67, v115
    v_pk_add_f32 v[30:31], v[30:31], v[12:13]
    s_waitcnt vmcnt(2)
    v_lshlrev_b32 v10, 16, v116
    v_and_b32_e64 v11, s67, v116
    v_pk_add_f32 v[32:33], v[32:33], v[10:11]
    v_lshlrev_b32 v12, 16, v117
    v_and_b32 v13, s67, v117
    v_pk_add_f32 v[34:35], v[34:35], v[12:13]
    v_lshlrev_b32 v10, 16, v118
    v_and_b32 v11, s67, v118
    v_pk_add_f32 v[36:37], v[36:37], v[10:11]
    v_lshlrev_b32 v12, 16, v119
    v_and_b32 v13, s67, v119
    v_pk_add_f32 v[38:39], v[38:39], v[12:13]
    s_waitcnt vmcnt(1)
    v_lshlrev_b32 v10, 16, v120
    v_and_b32_e64 v11, s67, v120
    v_pk_add_f32 v[24:25], v[24:25], v[10:11]
    v_lshlrev_b32 v12, 16, v121
    v_and_b32 v13, s67, v121
    v_pk_add_f32 v[26:27], v[26:27], v[12:13]
    v_lshlrev_b32 v10, 16, v122
    v_and_b32 v11, s67, v122
    v_pk_add_f32 v[28:29], v[28:29], v[10:11]
    v_lshlrev_b32 v12, 16, v123
    v_and_b32 v13, s67, v123
    v_pk_add_f32 v[30:31], v[30:31], v[12:13]
    s_waitcnt vmcnt(0)
    v_lshlrev_b32 v10, 16, v124
    v_and_b32_e64 v11, s67, v124
    v_pk_add_f32 v[32:33], v[32:33], v[10:11]
    v_lshlrev_b32 v12, 16, v125
    v_and_b32 v13, s67, v125
    v_pk_add_f32 v[34:35], v[34:35], v[12:13]
    v_lshlrev_b32 v10, 16, v126
    v_and_b32 v11, s67, v126
    v_pk_add_f32 v[36:37], v[36:37], v[10:11]
    v_lshlrev_b32 v12, 16, v127
    v_and_b32 v13, s67, v127
    v_pk_add_f32 v[38:39], v[38:39], v[12:13]
    v_lshlrev_b32 v10, 16, v128
    v_and_b32 v11, s67, v128
    v_pk_fma_f32 v[10:11], v[24:25], v[136:137], v[10:11]
    v_cvt_pk_bf16_f32 v128, v10, v11
    v_lshlrev_b32 v24, 16, v128
    v_and_b32 v25, s67, v128
    v_lshlrev_b32 v10, 16, v129
    v_and_b32 v11, s67, v129
    v_pk_fma_f32 v[10:11], v[26:27], v[138:139], v[10:11]
    v_cvt_pk_bf16_f32 v129, v10, v11
    v_lshlrev_b32 v26, 16, v129
    v_and_b32 v27, s67, v129
    v_lshlrev_b32 v10, 16, v130
    v_and_b32 v11, s67, v130
    v_pk_fma_f32 v[10:11], v[28:29], v[140:141], v[10:11]
    v_cvt_pk_bf16_f32 v130, v10, v11
    v_lshlrev_b32 v28, 16, v130
    v_and_b32 v29, s67, v130
    v_lshlrev_b32 v10, 16, v131
    v_and_b32 v11, s67, v131
    v_pk_fma_f32 v[10:11], v[30:31], v[142:143], v[10:11]
    v_cvt_pk_bf16_f32 v131, v10, v11
    v_lshlrev_b32 v30, 16, v131
    v_and_b32 v31, s67, v131
    v_lshlrev_b32 v10, 16, v132
    v_and_b32 v11, s67, v132
    v_pk_fma_f32 v[10:11], v[32:33], v[144:145], v[10:11]
    v_cvt_pk_bf16_f32 v132, v10, v11
    v_lshlrev_b32 v32, 16, v132
    v_and_b32 v33, s67, v132
    v_lshlrev_b32 v10, 16, v133
    v_and_b32 v11, s67, v133
    v_pk_fma_f32 v[10:11], v[34:35], v[146:147], v[10:11]
    v_cvt_pk_bf16_f32 v133, v10, v11
    v_lshlrev_b32 v34, 16, v133
    v_and_b32 v35, s67, v133
    v_lshlrev_b32 v10, 16, v134
    v_and_b32 v11, s67, v134
    v_pk_fma_f32 v[10:11], v[36:37], v[148:149], v[10:11]
    v_cvt_pk_bf16_f32 v134, v10, v11
    v_lshlrev_b32 v36, 16, v134
    v_and_b32 v37, s67, v134
    v_lshlrev_b32 v10, 16, v135
    v_and_b32 v11, s67, v135
    v_pk_fma_f32 v[10:11], v[38:39], v[150:151], v[10:11]
    v_cvt_pk_bf16_f32 v135, v10, v11
    v_lshlrev_b32 v38, 16, v135
    v_and_b32 v39, s67, v135
    s_add_u32 s66, s4, 0x1400000
    buffer_store_dwordx4 v[128:131], v3, s[24:27], s66 offen sc1
    buffer_store_dwordx4 v[132:135], v2, s[24:27], s66 offen sc1
    v_pk_add_f32 v[10:11], v[24:25], v[26:27]
    v_pk_add_f32 v[10:11], v[10:11], v[28:29]
    v_pk_add_f32 v[10:11], v[10:11], v[30:31]
    v_pk_add_f32 v[10:11], v[10:11], v[32:33]
    v_pk_add_f32 v[10:11], v[10:11], v[34:35]
    v_pk_add_f32 v[10:11], v[10:11], v[36:37]
    v_pk_add_f32 v[10:11], v[10:11], v[38:39]
    v_add_f32 v10, v10, v11
    s_nop 1
    v_add_f32_dpp v10, v10, v10 row_ror:8 row_mask:0xf bank_mask:0xf
    v_mov_b32 v11, v10
    s_nop 1
    v_permlane16_swap_b32 v10, v11
    v_add_f32 v10, v10, v11
    v_mov_b32 v11, v10
    s_nop 1
    v_permlane32_swap_b32 v10, v11
    v_add_f32 v10, v10, v11
    ds_write_b32 v9, v10 offset:0
    s_waitcnt lgkmcnt(0)
    s_barrier
    ds_read_b128 v[12:15], v8 offset:0
    s_waitcnt lgkmcnt(0)
    v_add_f32 v12, v12, v13
    v_add_f32 v14, v14, v15
    v_add_f32 v10, v12, v14
    v_mul_f32 v58, 0xbb000000, v10
    v_mov_b32_e64 v59, v58
    v_pk_add_f32 v[24:25], v[24:25], v[58:59]
    v_pk_add_f32 v[26:27], v[26:27], v[58:59]
    v_pk_add_f32 v[28:29], v[28:29], v[58:59]
    v_pk_add_f32 v[30:31], v[30:31], v[58:59]
    v_pk_add_f32 v[32:33], v[32:33], v[58:59]
    v_pk_add_f32 v[34:35], v[34:35], v[58:59]
    v_pk_add_f32 v[36:37], v[36:37], v[58:59]
    v_pk_add_f32 v[38:39], v[38:39], v[58:59]
    v_pk_mul_f32 v[10:11], v[24:25], v[24:25]
    v_pk_fma_f32 v[10:11], v[26:27], v[26:27], v[10:11]
    v_pk_fma_f32 v[10:11], v[28:29], v[28:29], v[10:11]
    v_pk_fma_f32 v[10:11], v[30:31], v[30:31], v[10:11]
    v_pk_fma_f32 v[10:11], v[32:33], v[32:33], v[10:11]
    v_pk_fma_f32 v[10:11], v[34:35], v[34:35], v[10:11]
    v_pk_fma_f32 v[10:11], v[36:37], v[36:37], v[10:11]
    v_pk_fma_f32 v[10:11], v[38:39], v[38:39], v[10:11]
    v_add_f32 v10, v10, v11
    s_nop 1
    v_add_f32_dpp v10, v10, v10 row_ror:8 row_mask:0xf bank_mask:0xf
    v_mov_b32 v11, v10
    s_nop 1
    v_permlane16_swap_b32 v10, v11
    v_add_f32 v10, v10, v11
    v_mov_b32 v11, v10
    s_nop 1
    v_permlane32_swap_b32 v10, v11
    v_add_f32 v10, v10, v11
    ds_write_b32 v9, v10 offset:128
    s_waitcnt lgkmcnt(0)
    s_barrier
    ds_read_b128 v[12:15], v8 offset:128
    s_waitcnt lgkmcnt(0)
    v_add_f32 v12, v12, v13
    v_add_f32 v14, v14, v15
    v_add_f32 v10, v12, v14
    v_mov_b32 v11, 0x3727c5ac
    v_fmac_f32 v11, 0x3b000000, v10
    v_rsq_f32 v56, v11
    s_nop 0
    v_mov_b32_e64 v57, v56
    v_pk_mul_f32 v[24:25], v[24:25], v[56:57]
    v_pk_fma_f32 v[24:25], v[24:25], v[152:153], v[168:169]
    v_cvt_pk_bf16_f32 v136, v24, v25
    v_pk_mul_f32 v[26:27], v[26:27], v[56:57]
    v_pk_fma_f32 v[26:27], v[26:27], v[154:155], v[170:171]
    v_cvt_pk_bf16_f32 v137, v26, v27
    v_pk_mul_f32 v[28:29], v[28:29], v[56:57]
    v_pk_fma_f32 v[28:29], v[28:29], v[156:157], v[172:173]
    v_cvt_pk_bf16_f32 v138, v28, v29
    v_pk_mul_f32 v[30:31], v[30:31], v[56:57]
    v_pk_fma_f32 v[30:31], v[30:31], v[158:159], v[174:175]
    v_cvt_pk_bf16_f32 v139, v30, v31
    v_pk_mul_f32 v[32:33], v[32:33], v[56:57]
    v_pk_fma_f32 v[32:33], v[32:33], v[160:161], v[176:177]
    v_cvt_pk_bf16_f32 v140, v32, v33
    v_pk_mul_f32 v[34:35], v[34:35], v[56:57]
    v_pk_fma_f32 v[34:35], v[34:35], v[162:163], v[178:179]
    v_cvt_pk_bf16_f32 v141, v34, v35
    v_pk_mul_f32 v[36:37], v[36:37], v[56:57]
    v_pk_fma_f32 v[36:37], v[36:37], v[164:165], v[180:181]
    v_cvt_pk_bf16_f32 v142, v36, v37
    v_pk_mul_f32 v[38:39], v[38:39], v[56:57]
    v_pk_fma_f32 v[38:39], v[38:39], v[166:167], v[182:183]
    v_cvt_pk_bf16_f32 v143, v38, v39
    s_add_u32 s66, s4, 0x1600000
    buffer_store_dwordx4 v[136:139], v3, s[24:27], s66 offen sc1
    buffer_store_dwordx4 v[140:143], v2, s[24:27], s66 offen sc1
    s_add_u32 s7, s7, 0x8000
    s_waitcnt vmcnt(0)
    s_barrier
    buffer_store_dword v250, v251, s[20:23], s7 offen sc1
    s_mul_i32 s31, s36, 229376
    s_add_u32 m0, s35, 0
    s_add_u32 s36, s36, 1
    s_and_b32 s36, s36, 7
    buffer_load_dwordx4 v228, s[8:11], s31 offen offset:0 lds
    buffer_load_dwordx4 v229, s[8:11], s31 offen offset:1024 lds
    buffer_load_dwordx4 v230, s[8:11], s31 offen offset:2048 lds
    s_mul_i32 s31, s36, 229376
    s_add_u32 m0, s35, 6144
    s_add_u32 s36, s36, 1
    s_and_b32 s36, s36, 7
    buffer_load_dwordx4 v228, s[8:11], s31 offen offset:0 lds
    buffer_load_dwordx4 v229, s[8:11], s31 offen offset:1024 lds
    buffer_load_dwordx4 v230, s[8:11], s31 offen offset:2048 lds
    s_cmp_lg_u32 s28, 0
    s_cbranch_scc1 NOPOLL_2
    s_mov_b64 exec, 0xffff
    s_mov_b32 s3, 0
POLL_2:
    buffer_load_dword v249, v248, s[24:27], s34 offen sc1
    s_add_u32 s3, s3, 1
    s_waitcnt vmcnt(0)
    v_cmp_eq_u32_e64 vcc, 0, v249
    s_cmp_gt_u32 s3, 0x8000
    s_cbranch_scc1 POLLED_2
    s_nop 2
    s_cbranch_vccz POLLED_2
    s_sleep 4
    s_branch POLL_2
POLLED_2:
    s_mov_b64 exec, -1
NOPOLL_2:
    s_barrier
    s_lshl_b32 s32, s39, 12
    s_add_u32 s32, s32, s38
    s_add_u32 s39, s39, 1
    s_and_b32 s39, s39, 7
    buffer_load_dwordx4 a[0:3], v216, s[24:27], s32 offen offset:0 sc1
    buffer_load_dwordx4 a[4:7], v216, s[24:27], s32 offen offset:1024 sc1
    buffer_load_dwordx4 a[8:11], v216, s[24:27], s32 offen offset:2048 sc1
    buffer_load_dwordx4 a[12:15], v216, s[24:27], s32 offen offset:3072 sc1
    s_lshl_b32 s32, s39, 12
    s_add_u32 s32, s32, s38
    s_add_u32 s39, s39, 1
    s_and_b32 s39, s39, 7
    buffer_load_dwordx4 a[16:19], v216, s[24:27], s32 offen offset:0 sc1
    buffer_load_dwordx4 a[20:23], v216, s[24:27], s32 offen offset:1024 sc1
    buffer_load_dwordx4 a[24:27], v216, s[24:27], s32 offen offset:2048 sc1
    buffer_load_dwordx4 a[28:31], v216, s[24:27], s32 offen offset:3072 sc1
    s_lshl_b32 s32, s39, 12
    s_add_u32 s32, s32, s38
    s_add_u32 s39, s39, 1
    s_and_b32 s39, s39, 7
    s_nop 0
    buffer_load_dwordx4 a[32:35], v216, s[24:27], s32 offen offset:0 sc1
    buffer_load_dwordx4 a[36:39], v216, s[24:27], s32 offen offset:1024 sc1
    buffer_load_dwordx4 a[40:43], v216, s[24:27], s32 offen offset:2048 sc1
    buffer_load_dwordx4 a[44:47], v216, s[24:27], s32 offen offset:3072 sc1
    ds_read_b64_tr_b16 a[128:129], v231 offset:0
    ds_read_b64_tr_b16 a[130:131], v231 offset:512
    ds_read_b64_tr_b16 a[132:133], v232 offset:0
    ds_read_b64_tr_b16 a[134:135], v232 offset:512
    ds_read_b64_tr_b16 a[136:137], v233 offset:0
    ds_read_b64_tr_b16 a[138:139], v233 offset:512
    ds_read_b64_tr_b16 a[140:141], v234 offset:0
    ds_read_b64_tr_b16 a[142:143], v234 offset:512
    s_waitcnt vmcnt(11) lgkmcnt(6)
    v_mfma_f32_32x32x16_bf16 v[0:15], a[128:131], a[0:3], 0
    ds_read_b64_tr_b16 a[144:145], v231 offset:2048
    ds_read_b64_tr_b16 a[146:147], v231 offset:2560
    ds_read_b64_tr_b16 a[148:149], v232 offset:2048
    s_lshl_b32 s32, s39, 12
    s_add_u32 s32, s32, s38
    s_waitcnt lgkmcnt(7)
    v_mfma_f32_32x32x16_bf16 v[16:31], a[132:135], a[0:3], 0
    ds_read_b64_tr_b16 a[150:151], v232 offset:2560
    ds_read_b64_tr_b16 a[152:153], v233 offset:2048
    s_add_u32 s39, s39, 1
    s_and_b32 s39, s39, 7
    s_waitcnt lgkmcnt(7)
    v_mfma_f32_32x32x16_bf16 v[32:47], a[136:139], a[0:3], 0
    buffer_load_dwordx4 a[48:51], v216, s[24:27], s32 offen offset:0 sc1
    ds_read_b64_tr_b16 a[154:155], v233 offset:2560
    ds_read_b64_tr_b16 a[156:157], v234 offset:2048
    s_waitcnt lgkmcnt(7)
    v_mfma_f32_32x32x16_bf16 v[48:63], a[140:143], a[0:3], 0
    buffer_load_dwordx4 a[52:55], v216, s[24:27], s32 offen offset:1024 sc1
    ds_read_b64_tr_b16 a[158:159], v234 offset:2560
    s_waitcnt vmcnt(12) lgkmcnt(0)
    s_nop 0
    v_mfma_f32_32x32x16_bf16 v[0:15], a[144:147], a[4:7], v[0:15]
    buffer_load_dwordx4 a[56:59], v216, s[24:27], s32 offen offset:2048 sc1
    ds_read_b64_tr_b16 a[160:161], v231 offset:4096
    ds_read_b64_tr_b16 a[162:163], v231 offset:4608
    ds_read_b64_tr_b16 a[164:165], v232 offset:4096
    v_mfma_f32_32x32x16_bf16 v[16:31], a[148:151], a[4:7], v[16:31]
    buffer_load_dwordx4 a[60:63], v216, s[24:27], s32 offen offset:3072 sc1
    ds_read_b64_tr_b16 a[166:167], v232 offset:4608
    ds_read_b64_tr_b16 a[168:169], v233 offset:4096
    v_mfma_f32_32x32x16_bf16 v[32:47], a[152:155], a[4:7], v[32:47]
    ds_read_b64_tr_b16 a[170:171], v233 offset:4608
    ds_read_b64_tr_b16 a[172:173], v234 offset:4096
    s_lshl_b32 s32, s39, 12
    s_add_u32 s32, s32, s38
    v_mfma_f32_32x32x16_bf16 v[48:63], a[156:159], a[4:7], v[48:63]
    ds_read_b64_tr_b16 a[174:175], v234 offset:4608
    s_add_u32 s39, s39, 1
    s_and_b32 s39, s39, 7
    s_waitcnt vmcnt(13) lgkmcnt(0)
    s_nop 0
    v_mfma_f32_32x32x16_bf16 v[0:15], a[160:163], a[8:11], v[0:15]
    buffer_load_dwordx4 a[64:67], v216, s[24:27], s32 offen offset:0 sc1
    ds_read_b64_tr_b16 a[176:177], v231 offset:6144
    ds_read_b64_tr_b16 a[178:179], v231 offset:6656
    ds_read_b64_tr_b16 a[180:181], v232 offset:6144
    v_mfma_f32_32x32x16_bf16 v[16:31], a[164:167], a[8:11], v[16:31]
    buffer_load_dwordx4 a[68:71], v216, s[24:27], s32 offen offset:1024 sc1
    ds_read_b64_tr_b16 a[182:183], v232 offset:6656
    ds_read_b64_tr_b16 a[184:185], v233 offset:6144
    v_mfma_f32_32x32x16_bf16 v[32:47], a[168:171], a[8:11], v[32:47]
    s_and_b32 s52, s2, 7
    s_lshr_b32 s53, s2, 3
    s_and_b32 s50, s52, 1
    s_lshl_b32 s50, s50, 2
    s_and_b32 s51, s53, 3
    s_add_u32 s50, s50, s51
    s_lshr_b32 s51, s52, 1
    s_lshl_b32 s51, s51, 3
    s_lshr_b32 s53, s53, 2
    s_add_u32 s51, s51, s53
    v_mfma_f32_32x32x16_bf16 v[48:63], a[172:175], a[8:11], v[48:63]
    ds_read_b64_tr_b16 a[186:187], v233 offset:6656
    ds_read_b64_tr_b16 a[188:189], v234 offset:6144
    ds_read_b64_tr_b16 a[190:191], v234 offset:6656
    s_waitcnt vmcnt(14) lgkmcnt(0)
    v_mfma_f32_32x32x16_bf16 v[0:15], a[176:179], a[12:15], v[0:15]
    ds_read_b64_tr_b16 a[128:129], v231 offset:8192
    ds_read_b64_tr_b16 a[130:131], v231 offset:8704
    s_mov_b32 s12, s46
    s_and_b32 s13, s47, 0xffff
    s_mov_b32 s14, 0x1c0000
    s_mov_b32 s15, 0x20000
    v_mfma_f32_32x32x16_bf16 v[16:31], a[180:183], a[12:15], v[16:31]
    buffer_load_dwordx4 a[72:75], v216, s[24:27], s32 offen offset:2048 sc1
    buffer_load_dwordx4 a[76:79], v216, s[24:27], s32 offen offset:3072 sc1
    ds_read_b64_tr_b16 a[132:133], v232 offset:8192
    v_mfma_f32_32x32x16_bf16 v[32:47], a[184:187], a[12:15], v[32:47]
    ds_read_b64_tr_b16 a[134:135], v232 offset:8704
    ds_read_b64_tr_b16 a[136:137], v233 offset:8192
    s_mov_b32 s16, s48
    s_nop 0
    s_and_b32 s17, s49, 0xffff
    s_mov_b32 s18, 0x200000
    s_mov_b32 s19, 0x20000
    v_mfma_f32_32x32x16_bf16 v[48:63], a[188:191], a[12:15], v[48:63]
    ds_read_b64_tr_b16 a[138:139], v233 offset:8704
    ds_read_b64_tr_b16 a[140:141], v234 offset:8192
    ds_read_b64_tr_b16 a[142:143], v234 offset:8704
    s_lshl_b32 s32, s39, 12
    s_add_u32 s32, s32, s38
    s_waitcnt vmcnt(15) lgkmcnt(0)
    v_mfma_f32_32x32x16_bf16 v[0:15], a[128:131], a[16:19], v[0:15]
    ds_read_b64_tr_b16 a[144:145], v231 offset:10240
    ds_read_b64_tr_b16 a[146:147], v231 offset:10752
    ds_read_b64_tr_b16 a[148:149], v232 offset:10240
    s_add_u32 s39, s39, 1
    s_and_b32 s39, s39, 7
    s_lshl_b32 s52, s50, 7
    v_mfma_f32_32x32x16_bf16 v[16:31], a[132:135], a[16:19], v[16:31]
    buffer_load_dwordx4 a[80:83], v216, s[24:27], s32 offen offset:0 sc1
    buffer_load_dwordx4 a[84:87], v216, s[24:27], s32 offen offset:1024 sc1
    v_add_u32_e64 v160, s52, v252
    v_mfma_f32_32x32x16_bf16 v[32:47], a[136:139], a[16:19], v[32:47]
    buffer_load_dwordx4 a[88:91], v216, s[24:27], s32 offen offset:2048 sc1
    ds_read_b64_tr_b16 a[150:151], v232 offset:10752
    ds_read_b64_tr_b16 a[152:153], v233 offset:10240
    ds_read_b64_tr_b16 a[154:155], v233 offset:10752
    v_mfma_f32_32x32x16_bf16 v[48:63], a[140:143], a[16:19], v[48:63]
    ds_read_b64_tr_b16 a[156:157], v234 offset:10240
    ds_read_b64_tr_b16 a[158:159], v234 offset:10752
    v_add_u32 v161, 7168, v160
STUB9:
    s_cbranch_execz WARM_RET
    s_nop 0
    s_lshl_b32 s56, s28, 12
    s_waitcnt vmcnt(17) lgkmcnt(0)
    v_mfma_f32_32x32x16_bf16 v[0:15], a[144:147], a[20:23], v[0:15]
    buffer_load_dwordx4 a[92:95], v216, s[24:27], s32 offen offset:3072 sc1
    ds_read_b64_tr_b16 a[160:161], v231 offset:12288
    s_lshl_b32 s32, s39, 12
    s_add_u32 s32, s32, s38
    v_mfma_f32_32x32x16_bf16 v[16:31], a[148:151], a[20:23], v[16:31]
    ds_read_b64_tr_b16 a[162:163], v231 offset:12800
    ds_read_b64_tr_b16 a[164:165], v232 offset:12288
    ds_read_b64_tr_b16 a[166:167], v232 offset:12800
    ds_read_b64_tr_b16 a[168:169], v233 offset:12288
    s_add_u32 s39, s39, 1
    s_and_b32 s39, s39, 7
    v_mfma_f32_32x32x16_bf16 v[32:47], a[152:155], a[20:23], v[32:47]
    buffer_load_dwordx4 a[96:99], v216, s[24:27], s32 offen offset:0 sc1
    ds_read_b64_tr_b16 a[170:171], v233 offset:12800
    ds_read_b64_tr_b16 a[172:173], v234 offset:12288
    v_add_u32 v168, 114688, v216
    v_mfma_f32_32x32x16_bf16 v[48:63], a[156:159], a[20:23], v[48:63]
    buffer_load_dwordx4 a[100:103], v216, s[24:27], s32 offen offset:1024 sc1
    ds_read_b64_tr_b16 a[174:175], v234 offset:12800
    s_waitcnt vmcnt(19) lgkmcnt(0)
    s_nop 0
    v_mfma_f32_32x32x16_bf16 v[0:15], a[160:163], a[24:27], v[0:15]
    ds_read_b64_tr_b16 a[176:177], v231 offset:14336
    ds_read_b64_tr_b16 a[178:179], v231 offset:14848
    ds_read_b64_tr_b16 a[180:181], v232 offset:14336
    s_mul_i32 s57, s51, 229376
    s_add_u32 s57, s57, 0x1800000
    v_mfma_f32_32x32x16_bf16 v[16:31], a[164:167], a[24:27], v[16:31]
    buffer_load_dwordx4 a[104:107], v216, s[24:27], s32 offen offset:2048 sc1
    buffer_load_dwordx4 a[108:111], v216, s[24:27], s32 offen offset:3072 sc1
    ds_read_b64_tr_b16 a[182:183], v232 offset:14848
    v_mfma_f32_32x32x16_bf16 v[32:47], a[168:171], a[24:27], v[32:47]
    ds_read_b64_tr_b16 a[184:185], v233 offset:14336
    ds_read_b64_tr_b16 a[186:187], v233 offset:14848
    ds_read_b64_tr_b16 a[188:189], v234 offset:14336
    s_lshl_b32 s32, s39, 12
    s_add_u32 s32, s32, s38
    s_lshl_b32 s58, s28, 2
    v_mfma_f32_32x32x16_bf16 v[48:63], a[172:175], a[24:27], v[48:63]
    ds_read_b64_tr_b16 a[190:191], v234 offset:14848
    s_add_u32 s39, s39, 1
    s_and_b32 s39, s39, 7
    s_waitcnt vmcnt(20) lgkmcnt(0)
    v_mfma_f32_32x32x16_bf16 v[0:15], a[176:179], a[28:31], v[0:15]
    ds_read_b64_tr_b16 a[128:129], v231 offset:16384
    ds_read_b64_tr_b16 a[130:131], v231 offset:16896
    ds_read_b64_tr_b16 a[132:133], v232 offset:16384
    s_add_u32 s52, s50, 0
    s_and_b32 s52, s52, 3
    s_add_u32 s72, s52, s58
    v_mfma_f32_32x32x16_bf16 v[16:31], a[180:183], a[28:31], v[16:31]
    buffer_load_dwordx4 a[112:115], v216, s[24:27], s32 offen offset:0 sc1
    ds_read_b64_tr_b16 a[134:135], v232 offset:16896
    ds_read_b64_tr_b16 a[136:137], v233 offset:16384
    v_mfma_f32_32x32x16_bf16 v[32:47], a[184:187], a[28:31], v[32:47]
    buffer_load_dwordx4 a[116:119], v216, s[24:27], s32 offen offset:1024 sc1
    s_add_u32 s52, s50, 1
    s_and_b32 s52, s52, 3
    s_add_u32 s73, s52, s58
    v_mfma_f32_32x32x16_bf16 v[48:63], a[188:191], a[28:31], v[48:63]
    buffer_load_dwordx4 a[120:123], v216, s[24:27], s32 offen offset:2048 sc1
    buffer_load_dwordx4 a[124:127], v216, s[24:27], s32 offen offset:3072 sc1
    ds_read_b64_tr_b16 a[138:139], v233 offset:16896
    ds_read_b64_tr_b16 a[140:141], v234 offset:16384
    ds_read_b64_tr_b16 a[142:143], v234 offset:16896
    s_waitcnt vmcnt(23) lgkmcnt(0)
    v_mfma_f32_32x32x16_bf16 v[0:15], a[128:131], a[32:35], v[0:15]
    ds_read_b64_tr_b16 a[144:145], v231 offset:18432
    ds_read_b64_tr_b16 a[146:147], v231 offset:18944
    ds_read_b64_tr_b16 a[148:149], v232 offset:18432
    s_add_u32 s52, s50, 2
    s_and_b32 s52, s52, 3
    s_add_u32 s74, s52, s58
    v_mfma_f32_32x32x16_bf16 v[16:31], a[132:135], a[32:35], v[16:31]
    ds_read_b64_tr_b16 a[150:151], v232 offset:18944
    ds_read_b64_tr_b16 a[152:153], v233 offset:18432
    s_add_u32 s52, s50, 3
    s_and_b32 s52, s52, 3
    s_add_u32 s75, s52, s58
    v_mfma_f32_32x32x16_bf16 v[32:47], a[136:139], a[32:35], v[32:47]
    s_barrier
    ds_read_b64_tr_b16 a[154:155], v233 offset:18944
    ds_read_b64_tr_b16 a[156:157], v234 offset:18432
    s_mul_i32 s31, s36, 229376
    s_add_u32 m0, s65, 0
    v_lshl_add_u32 v170, v243, 3, v240
    v_mfma_f32_32x32x16_bf16 v[48:63], a[140:143], a[32:35], v[48:63]
    ds_read_b64_tr_b16 a[158:159], v234 offset:18944
    s_add_u32 s36, s36, 1
    s_and_b32 s36, s36, 7
    s_waitcnt vmcnt(22) lgkmcnt(0)
    v_mfma_f32_32x32x16_bf16 v[0:15], a[144:147], a[36:39], v[0:15]
    ds_read_b64_tr_b16 a[160:161], v231 offset:20480
    ds_read_b64_tr_b16 a[162:163], v231 offset:20992
    ds_read_b64_tr_b16 a[164:165], v232 offset:20480
    v_lshlrev_b32_e64 v162, 7, v170
    v_mfma_f32_32x32x16_bf16 v[16:31], a[148:151], a[36:39], v[16:31]
    buffer_load_dwordx4 v228, s[8:11], s31 offen offset:0 lds
    ds_read_b64_tr_b16 a[166:167], v232 offset:20992
    ds_read_b64_tr_b16 a[168:169], v233 offset:20480
    v_mfma_f32_32x32x16_bf16 v[32:47], a[152:155], a[36:39], v[32:47]
    ds_read_b64_tr_b16 a[170:171], v233 offset:20992
    ds_read_b64_tr_b16 a[172:173], v234 offset:20480
    v_lshl_add_u32 v171, v242, 2, v241
    v_mfma_f32_32x32x16_bf16 v[48:63], a[156:159], a[36:39], v[48:63]
    buffer_load_dwordx4 v229, s[8:11], s31 offen offset:1024 lds
    ds_read_b64_tr_b16 a[174:175], v234 offset:20992
    s_waitcnt vmcnt(23) lgkmcnt(0)
    s_nop 0
    v_mfma_f32_32x32x16_bf16 v[0:15], a[160:163], a[40:43], v[0:15]
    ds_read_b64_tr_b16 a[176:177], v231 offset:22528
    ds_read_b64_tr_b16 a[178:179], v231 offset:23040
    ds_read_b64_tr_b16 a[180:181], v232 offset:22528
    v_lshl_add_u32 v162, v171, 3, v162
    v_mfma_f32_32x32x16_bf16 v[16:31], a[164:167], a[40:43], v[16:31]
    buffer_load_dwordx4 v230, s[8:11], s31 offen offset:2048 lds
    ds_read_b64_tr_b16 a[182:183], v232 offset:23040
    ds_read_b64_tr_b16 a[184:185], v233 offset:22528
    v_mfma_f32_32x32x16_bf16 v[32:47], a[168:171], a[40:43], v[32:47]
    ds_read_b64_tr_b16 a[186:187], v233 offset:23040
    ds_read_b64_tr_b16 a[188:189], v234 offset:22528
    s_mul_i32 s31, s36, 229376
    s_add_u32 m0, s65, 8192
    v_lshrrev_b32_e64 v170, 1, v240
    v_mfma_f32_32x32x16_bf16 v[48:63], a[172:175], a[40:43], v[48:63]
    ds_read_b64_tr_b16 a[190:191], v234 offset:23040
    s_add_u32 s36, s36, 1
    s_and_b32 s36, s36, 7
    v_lshl_add_u32 v162, v170, 6, v162
    s_waitcnt vmcnt(23) lgkmcnt(0)
    s_nop 0
    v_mfma_f32_32x32x16_bf16 v[0:15], a[176:179], a[44:47], v[0:15]
    ds_read_b64_tr_b16 a[128:129], v231 offset:24576
    ds_read_b64_tr_b16 a[130:131], v231 offset:25088
    ds_read_b64_tr_b16 a[132:133], v232 offset:24576
    v_mfma_f32_32x32x16_bf16 v[16:31], a[180:183], a[44:47], v[16:31]
    buffer_load_dwordx4 v228, s[8:11], s31 offen offset:0 lds
    ds_read_b64_tr_b16 a[134:135], v232 offset:25088
    ds_read_b64_tr_b16 a[136:137], v233 offset:24576
    v_add_u32_e64 v162, s56, v162
    v_mfma_f32_32x32x16_bf16 v[32:47], a[184:187], a[44:47], v[32:47]
    ds_read_b64_tr_b16 a[138:139], v233 offset:25088
    ds_read_b64_tr_b16 a[140:141], v234 offset:24576
    v_mfma_f32_32x32x16_bf16 v[48:63], a[188:191], a[44:47], v[48:63]
    buffer_load_dwordx4 v229, s[8:11], s31 offen offset:1024 lds
    ds_read_b64_tr_b16 a[142:143], v234 offset:25088
    v_xor_b32 v163, 64, v162
    s_waitcnt vmcnt(24) lgkmcnt(0)
    v_mfma_f32_32x32x16_bf16 v[0:15], a[128:131], a[48:51], v[0:15]
    buffer_load_dwordx4 v230, s[8:11], s31 offen offset:2048 lds
    ds_read_b64_tr_b16 a[144:145], v231 offset:26624
    ds_read_b64_tr_b16 a[146:147], v231 offset:27136
    ds_read_b64_tr_b16 a[148:149], v232 offset:26624
    v_mfma_f32_32x32x16_bf16 v[16:31], a[132:135], a[48:51], v[16:31]
    ds_read_b64_tr_b16 a[150:151], v232 offset:27136
    ds_read_b64_tr_b16 a[152:153], v233 offset:26624
    v_add_u32 v164, 65536, v162
    v_mfma_f32_32x32x16_bf16 v[32:47], a[136:139], a[48:51], v[32:47]
    ds_read_b64_tr_b16 a[154:155], v233 offset:27136
    ds_read_b64_tr_b16 a[156:157], v234 offset:26624
    v_mfma_f32_32x32x16_bf16 v[48:63], a[140:143], a[48:51], v[48:63]
    ds_read_b64_tr_b16 a[158:159], v234 offset:27136
    v_add_u32 v165, 65536, v163
    s_waitcnt vmcnt(24) lgkmcnt(0)
    s_nop 0
    v_mfma_f32_32x32x16_bf16 v[0:15], a[144:147], a[52:55], v[0:15]
    ds_read_b64_tr_b16 a[160:161], v231 offset:28672
    ds_read_b64_tr_b16 a[162:163], v231 offset:29184
    ds_read_b64_tr_b16 a[164:165], v232 offset:28672
    v_mfma_f32_32x32x16_bf16 v[16:31], a[148:151], a[52:55], v[16:31]
    ds_read_b64_tr_b16 a[166:167], v232 offset:29184
    ds_read_b64_tr_b16 a[168:169], v233 offset:28672
    v_add_u32 v166, 131072, v162
    v_mfma_f32_32x32x16_bf16 v[32:47], a[152:155], a[52:55], v[32:47]
    ds_read_b64_tr_b16 a[170:171], v233 offset:29184
    ds_read_b64_tr_b16 a[172:173], v234 offset:28672
    v_mfma_f32_32x32x16_bf16 v[48:63], a[156:159], a[52:55], v[48:63]
    ds_read_b64_tr_b16 a[174:175], v234 offset:29184
    v_add_u32 v167, 131072, v163
    s_waitcnt vmcnt(23) lgkmcnt(0)
    v_mfma_f32_32x32x16_bf16 v[0:15], a[160:163], a[56:59], v[0:15]
    ds_read_b64_tr_b16 a[176:177], v231 offset:30720
    ds_read_b64_tr_b16 a[178:179], v231 offset:31232
    ds_read_b64_tr_b16 a[180:181], v232 offset:30720
    s_lshr_b32 s59, s51, 1
    s_lshl_b32 s59, s59, 2
    s_add_u32 s59, s59, s28
    v_mfma_f32_32x32x16_bf16 v[16:31], a[164:167], a[56:59], v[16:31]
    ds_read_b64_tr_b16 a[182:183], v232 offset:31232
    ds_read_b64_tr_b16 a[184:185], v233 offset:30720
    v_mfma_f32_32x32x16_bf16 v[32:47], a[168:171], a[56:59], v[32:47]
    ds_read_b64_tr_b16 a[186:187], v233 offset:31232
    ds_read_b64_tr_b16 a[188:189], v234 offset:30720
    s_lshl_b32 s59, s59, 9
    s_add_u32 s59, s59, 0x30000
    s_add_u32 s61, s59, 0x8000
    v_mfma_f32_32x32x16_bf16 v[48:63], a[172:175], a[56:59], v[48:63]
    ds_read_b64_tr_b16 a[190:191], v234 offset:31232
    s_waitcnt vmcnt(22) lgkmcnt(0)
    v_mfma_f32_32x32x16_bf16 v[0:15], a[176:179], a[60:63], v[0:15]
    ds_read_b64_tr_b16 a[128:129], v231 offset:32768
    ds_read_b64_tr_b16 a[130:131], v231 offset:33280
    ds_read_b64_tr_b16 a[132:133], v232 offset:32768
    s_lshl_b32 s60, s30, 4
    s_add_u32 s60, s60, s29
    s_lshl_b32 s60, s60, 7
    s_nop 0
    v_mfma_f32_32x32x16_bf16 v[16:31], a[180:183], a[60:63], v[16:31]
    ds_read_b64_tr_b16 a[134:135], v232 offset:33280
    ds_read_b64_tr_b16 a[136:137], v233 offset:32768
    v_mfma_f32_32x32x16_bf16 v[32:47], a[184:187], a[60:63], v[32:47]
    ds_read_b64_tr_b16 a[138:139], v233 offset:33280
    ds_read_b64_tr_b16 a[140:141], v234 offset:32768
    s_add_u32 s60, s60, 0x30000
    s_add_u32 s62, s60, 0x8000
    v_mfma_f32_32x32x16_bf16 v[48:63], a[188:191], a[60:63], v[48:63]
    ds_read_b64_tr_b16 a[142:143], v234 offset:33280
    s_waitcnt vmcnt(21) lgkmcnt(0)
    s_nop 0
    v_mfma_f32_32x32x16_bf16 v[0:15], a[128:131], a[64:67], v[0:15]
    ds_read_b64_tr_b16 a[144:145], v231 offset:34816
    ds_read_b64_tr_b16 a[146:147], v231 offset:35328
    ds_read_b64_tr_b16 a[148:149], v232 offset:34816
    v_mfma_f32_32x32x16_bf16 v[16:31], a[132:135], a[64:67], v[16:31]
    ds_read_b64_tr_b16 a[150:151], v232 offset:35328
    ds_read_b64_tr_b16 a[152:153], v233 offset:34816
    v_mfma_f32_32x32x16_bf16 v[32:47], a[136:139], a[64:67], v[32:47]
    s_barrier
    ds_read_b64_tr_b16 a[154:155], v233 offset:35328
    ds_read_b64_tr_b16 a[156:157], v234 offset:34816
    s_mul_i32 s31, s36, 229376
    s_add_u32 m0, s65, 16384
    v_mfma_f32_32x32x16_bf16 v[48:63], a[140:143], a[64:67], v[48:63]
    ds_read_b64_tr_b16 a[158:159], v234 offset:35328
    s_add_u32 s36, s36, 1
    s_and_b32 s36, s36, 7
    s_mov_b32 s40, 0xbdd2d3e8
    s_mov_b32 s41, s40
    s_waitcnt vmcnt(20) lgkmcnt(0)
    s_nop 0
    v_mfma_f32_32x32x16_bf16 v[0:15], a[144:147], a[68:71], v[0:15]
    ds_read_b64_tr_b16 a[160:161], v231 offset:36864
    ds_read_b64_tr_b16 a[162:163], v231 offset:37376
    ds_read_b64_tr_b16 a[164:165], v232 offset:36864
    v_mfma_f32_32x32x16_bf16 v[16:31], a[148:151], a[68:71], v[16:31]
    buffer_load_dwordx4 v228, s[8:11], s31 offen offset:0 lds
    ds_read_b64_tr_b16 a[166:167], v232 offset:37376
    ds_read_b64_tr_b16 a[168:169], v233 offset:36864
    v_mfma_f32_32x32x16_bf16 v[32:47], a[152:155], a[68:71], v[32:47]
    ds_read_b64_tr_b16 a[170:171], v233 offset:37376
    ds_read_b64_tr_b16 a[172:173], v234 offset:36864
    v_mfma_f32_32x32x16_bf16 v[48:63], a[156:159], a[68:71], v[48:63]
    buffer_load_dwordx4 v229, s[8:11], s31 offen offset:1024 lds
    ds_read_b64_tr_b16 a[174:175], v234 offset:37376
    s_waitcnt vmcnt(21) lgkmcnt(0)
    s_nop 0
    v_mfma_f32_32x32x16_bf16 v[0:15], a[160:163], a[72:75], v[0:15]
    ds_read_b64_tr_b16 a[176:177], v231 offset:38912
    ds_read_b64_tr_b16 a[178:179], v231 offset:39424
    ds_read_b64_tr_b16 a[180:181], v232 offset:38912
    v_mov_b32 v246, 0x409d30fc
    v_mfma_f32_32x32x16_bf16 v[16:31], a[164:167], a[72:75], v[16:31]
    buffer_load_dwordx4 v230, s[8:11], s31 offen offset:2048 lds
    ds_read_b64_tr_b16 a[182:183], v232 offset:39424
    ds_read_b64_tr_b16 a[184:185], v233 offset:38912
    v_mfma_f32_32x32x16_bf16 v[32:47], a[168:171], a[72:75], v[32:47]
    ds_read_b64_tr_b16 a[186:187], v233 offset:39424
    ds_read_b64_tr_b16 a[188:189], v234 offset:38912
    s_mul_i32 s31, s36, 229376
    s_add_u32 m0, s65, 24576
    v_mfma_f32_32x32x16_bf16 v[48:63], a[172:175], a[72:75], v[48:63]
    ds_read_b64_tr_b16 a[190:191], v234 offset:39424
    s_add_u32 s36, s36, 1
    s_and_b32 s36, s36, 7
    s_waitcnt vmcnt(21) lgkmcnt(0)
    s_nop 0
    v_mfma_f32_32x32x16_bf16 v[0:15], a[176:179], a[76:79], v[0:15]
    ds_read_b64_tr_b16 a[128:129], v231 offset:40960
    ds_read_b64_tr_b16 a[130:131], v231 offset:41472
    ds_read_b64_tr_b16 a[132:133], v232 offset:40960
    v_mfma_f32_32x32x16_bf16 v[16:31], a[180:183], a[76:79], v[16:31]
    buffer_load_dwordx4 v228, s[8:11], s31 offen offset:0 lds
    ds_read_b64_tr_b16 a[134:135], v232 offset:41472
    ds_read_b64_tr_b16 a[136:137], v233 offset:40960
    v_mfma_f32_32x32x16_bf16 v[32:47], a[184:187], a[76:79], v[32:47]
    ds_read_b64_tr_b16 a[138:139], v233 offset:41472
    ds_read_b64_tr_b16 a[140:141], v234 offset:40960
    v_mov_b32 v247, 0x409d30fc
    v_mfma_f32_32x32x16_bf16 v[48:63], a[188:191], a[76:79], v[48:63]
    buffer_load_dwordx4 v229, s[8:11], s31 offen offset:1024 lds
    ds_read_b64_tr_b16 a[142:143], v234 offset:41472
    s_waitcnt vmcnt(22) lgkmcnt(0)
    s_nop 0
    v_mfma_f32_32x32x16_bf16 v[0:15], a[128:131], a[80:83], v[0:15]
    buffer_load_dwordx4 v230, s[8:11], s31 offen offset:2048 lds
    ds_read_b64_tr_b16 a[144:145], v231 offset:43008
    ds_read_b64_tr_b16 a[146:147], v231 offset:43520
    ds_read_b64_tr_b16 a[148:149], v232 offset:43008
    v_mfma_f32_32x32x16_bf16 v[16:31], a[132:135], a[80:83], v[16:31]
    ds_read_b64_tr_b16 a[150:151], v232 offset:43520
    ds_read_b64_tr_b16 a[152:153], v233 offset:43008
    v_mfma_f32_32x32x16_bf16 v[32:47], a[136:139], a[80:83], v[32:47]
    ds_read_b64_tr_b16 a[154:155], v233 offset:43520
    ds_read_b64_tr_b16 a[156:157], v234 offset:43008
    v_mfma_f32_32x32x16_bf16 v[48:63], a[140:143], a[80:83], v[48:63]
    ds_read_b64_tr_b16 a[158:159], v234 offset:43520
    s_waitcnt vmcnt(22) lgkmcnt(0)
    v_mfma_f32_32x32x16_bf16 v[0:15], a[144:147], a[84:87], v[0:15]
    ds_read_b64_tr_b16 a[160:161], v231 offset:45056
    ds_read_b64_tr_b16 a[162:163], v231 offset:45568
    ds_read_b64_tr_b16 a[164:165], v232 offset:45056
    s_lshl_b32 s42, s30, 2
    s_add_u32 s42, s42, s28
    s_nop 0
    s_mul_i32 s42, s42, 114688
    v_mfma_f32_32x32x16_bf16 v[16:31], a[148:151], a[84:87], v[16:31]
    ds_read_b64_tr_b16 a[166:167], v232 offset:45568
    ds_read_b64_tr_b16 a[168:169], v233 offset:45056
    v_mfma_f32_32x32x16_bf16 v[32:47], a[152:155], a[84:87], v[32:47]
    ds_read_b64_tr_b16 a[170:171], v233 offset:45568
    ds_read_b64_tr_b16 a[172:173], v234 offset:45056
    v_mfma_f32_32x32x16_bf16 v[48:63], a[156:159], a[84:87], v[48:63]
    ds_read_b64_tr_b16 a[174:175], v234 offset:45568
    s_waitcnt vmcnt(21) lgkmcnt(0)
    s_nop 0
    v_mfma_f32_32x32x16_bf16 v[0:15], a[160:163], a[88:91], v[0:15]
    ds_read_b64_tr_b16 a[176:177], v231 offset:47104
    ds_read_b64_tr_b16 a[178:179], v231 offset:47616
    ds_read_b64_tr_b16 a[180:181], v232 offset:47104
    v_mfma_f32_32x32x16_bf16 v[16:31], a[164:167], a[88:91], v[16:31]
    ds_read_b64_tr_b16 a[182:183], v232 offset:47616
    ds_read_b64_tr_b16 a[184:185], v233 offset:47104
    v_mfma_f32_32x32x16_bf16 v[32:47], a[168:171], a[88:91], v[32:47]
    ds_read_b64_tr_b16 a[186:187], v233 offset:47616
    ds_read_b64_tr_b16 a[188:189], v234 offset:47104
    s_add_u32 s42, s42, 0x1800000
    s_mul_i32 s43, s29, 3072
    s_add_u32 s43, s43, s42
    v_mfma_f32_32x32x16_bf16 v[48:63], a[172:175], a[88:91], v[48:63]
    ds_read_b64_tr_b16 a[190:191], v234 offset:47616
    s_waitcnt vmcnt(20) lgkmcnt(0)
    v_mfma_f32_32x32x16_bf16 v[0:15], a[176:179], a[92:95], v[0:15]
    ds_read_b64_tr_b16 a[128:129], v231 offset:49152
    ds_read_b64_tr_b16 a[130:131], v231 offset:49664
    ds_read_b64_tr_b16 a[132:133], v232 offset:49152
    v_mfma_f32_32x32x16_bf16 v[16:31], a[180:183], a[92:95], v[16:31]
    ds_read_b64_tr_b16 a[134:135], v232 offset:49664
    ds_read_b64_tr_b16 a[136:137], v233 offset:49152
    v_mfma_f32_32x32x16_bf16 v[32:47], a[184:187], a[92:95], v[32:47]
    ds_read_b64_tr_b16 a[138:139], v233 offset:49664
    ds_read_b64_tr_b16 a[140:141], v234 offset:49152
    v_mfma_f32_32x32x16_bf16 v[48:63], a[188:191], a[92:95], v[48:63]
    ds_read_b64_tr_b16 a[142:143], v234 offset:49664
    s_waitcnt vmcnt(19) lgkmcnt(0)
    v_mfma_f32_32x32x16_bf16 v[0:15], a[128:131], a[96:99], v[0:15]
    ds_read_b64_tr_b16 a[144:145], v231 offset:51200
    ds_read_b64_tr_b16 a[146:147], v231 offset:51712
    ds_read_b64_tr_b16 a[148:149], v232 offset:51200
    s_add_u32 s43, s43, 65536
    s_lshl_b32 s44, s29, 12
    s_add_u32 s42, s42, s44
    v_mfma_f32_32x32x16_bf16 v[16:31], a[132:135], a[96:99], v[16:31]
    ds_read_b64_tr_b16 a[150:151], v232 offset:51712
    ds_read_b64_tr_b16 a[152:153], v233 offset:51200
    v_mfma_f32_32x32x16_bf16 v[32:47], a[136:139], a[96:99], v[32:47]
    s_barrier
    ds_read_b64_tr_b16 a[154:155], v233 offset:51712
    ds_read_b64_tr_b16 a[156:157], v234 offset:51200
    s_mul_i32 s31, s36, 229376
    s_add_u32 m0, s65, 32768
    v_mfma_f32_32x32x16_bf16 v[48:63], a[140:143], a[96:99], v[48:63]
    ds_read_b64_tr_b16 a[158:159], v234 offset:51712
    s_add_u32 s36, s36, 1
    s_and_b32 s36, s36, 7
    s_waitcnt vmcnt(18) lgkmcnt(0)
    s_nop 0
    v_mfma_f32_32x32x16_bf16 v[0:15], a[144:147], a[100:103], v[0:15]
    ds_read_b64_tr_b16 a[160:161], v231 offset:53248
    ds_read_b64_tr_b16 a[162:163], v231 offset:53760
    ds_read_b64_tr_b16 a[164:165], v232 offset:53248
    v_mfma_f32_32x32x16_bf16 v[16:31], a[148:151], a[100:103], v[16:31]
    buffer_load_dwordx4 v228, s[8:11], s31 offen offset:0 lds
    ds_read_b64_tr_b16 a[166:167], v232 offset:53760
    ds_read_b64_tr_b16 a[168:169], v233 offset:53248
    v_mfma_f32_32x32x16_bf16 v[32:47], a[152:155], a[100:103], v[32:47]
    ds_read_b64_tr_b16 a[170:171], v233 offset:53760
    ds_read_b64_tr_b16 a[172:173], v234 offset:53248
    v_mfma_f32_32x32x16_bf16 v[48:63], a[156:159], a[100:103], v[48:63]
    buffer_load_dwordx4 v229, s[8:11], s31 offen offset:1024 lds
    ds_read_b64_tr_b16 a[174:175], v234 offset:53760
    s_waitcnt vmcnt(19) lgkmcnt(0)
    s_nop 0
    v_mfma_f32_32x32x16_bf16 v[0:15], a[160:163], a[104:107], v[0:15]
    buffer_load_dwordx4 v230, s[8:11], s31 offen offset:2048 lds
    ds_read_b64_tr_b16 a[176:177], v231 offset:55296
    ds_read_b64_tr_b16 a[178:179], v231 offset:55808
    ds_read_b64_tr_b16 a[180:181], v232 offset:55296
    v_mfma_f32_32x32x16_bf16 v[16:31], a[164:167], a[104:107], v[16:31]
    ds_read_b64_tr_b16 a[182:183], v232 offset:55808
    ds_read_b64_tr_b16 a[184:185], v233 offset:55296
    v_mfma_f32_32x32x16_bf16 v[32:47], a[168:171], a[104:107], v[32:47]
    ds_read_b64_tr_b16 a[186:187], v233 offset:55808
    ds_read_b64_tr_b16 a[188:189], v234 offset:55296
    s_mul_i32 s31, s36, 229376
    s_add_u32 m0, s65, 40960
    v_mfma_f32_32x32x16_bf16 v[48:63], a[172:175], a[104:107], v[48:63]
    ds_read_b64_tr_b16 a[190:191], v234 offset:55808
    s_add_u32 s36, s36, 1
    s_and_b32 s36, s36, 7
    s_waitcnt vmcnt(19) lgkmcnt(0)
    s_nop 0
    v_mfma_f32_32x32x16_bf16 v[0:15], a[176:179], a[108:111], v[0:15]
    ds_read_b64_tr_b16 a[128:129], v231 offset:57344
    ds_read_b64_tr_b16 a[130:131], v231 offset:57856
    ds_read_b64_tr_b16 a[132:133], v232 offset:57344
    v_mfma_f32_32x32x16_bf16 v[16:31], a[180:183], a[108:111], v[16:31]
    buffer_load_dwordx4 v228, s[8:11], s31 offen offset:0 lds
    ds_read_b64_tr_b16 a[134:135], v232 offset:57856
    ds_read_b64_tr_b16 a[136:137], v233 offset:57344
    v_mfma_f32_32x32x16_bf16 v[32:47], a[184:187], a[108:111], v[32:47]
    ds_read_b64_tr_b16 a[138:139], v233 offset:57856
    ds_read_b64_tr_b16 a[140:141], v234 offset:57344
    v_mfma_f32_32x32x16_bf16 v[48:63], a[188:191], a[108:111], v[48:63]
    buffer_load_dwordx4 v229, s[8:11], s31 offen offset:1024 lds
    ds_read_b64_tr_b16 a[142:143], v234 offset:57856
    s_waitcnt vmcnt(20) lgkmcnt(0)
    s_nop 0
    v_mfma_f32_32x32x16_bf16 v[0:15], a[128:131], a[112:115], v[0:15]
    buffer_load_dwordx4 v230, s[8:11], s31 offen offset:2048 lds
    ds_read_b64_tr_b16 a[144:145], v231 offset:59392
    ds_read_b64_tr_b16 a[146:147], v231 offset:59904
    ds_read_b64_tr_b16 a[148:149], v232 offset:59392
    v_mfma_f32_32x32x16_bf16 v[16:31], a[132:135], a[112:115], v[16:31]
    ds_read_b64_tr_b16 a[150:151], v232 offset:59904
    ds_read_b64_tr_b16 a[152:153], v233 offset:59392
    v_mfma_f32_32x32x16_bf16 v[32:47], a[136:139], a[112:115], v[32:47]
    ds_read_b64_tr_b16 a[154:155], v233 offset:59904
    ds_read_b64_tr_b16 a[156:157], v234 offset:59392
    v_mfma_f32_32x32x16_bf16 v[48:63], a[140:143], a[112:115], v[48:63]
    ds_read_b64_tr_b16 a[158:159], v234 offset:59904
    s_waitcnt vmcnt(20) lgkmcnt(0)
    s_nop 0
    v_mfma_f32_32x32x16_bf16 v[0:15], a[144:147], a[116:119], v[0:15]
    ds_read_b64_tr_b16 a[160:161], v231 offset:61440
    ds_read_b64_tr_b16 a[162:163], v231 offset:61952
    ds_read_b64_tr_b16 a[164:165], v232 offset:61440
    v_mfma_f32_32x32x16_bf16 v[16:31], a[148:151], a[116:119], v[16:31]
    ds_read_b64_tr_b16 a[166:167], v232 offset:61952
    ds_read_b64_tr_b16 a[168:169], v233 offset:61440
    v_mfma_f32_32x32x16_bf16 v[32:47], a[152:155], a[116:119], v[32:47]
    ds_read_b64_tr_b16 a[170:171], v233 offset:61952
    ds_read_b64_tr_b16 a[172:173], v234 offset:61440
    v_mfma_f32_32x32x16_bf16 v[48:63], a[156:159], a[116:119], v[48:63]
    ds_read_b64_tr_b16 a[174:175], v234 offset:61952
    s_waitcnt vmcnt(19) lgkmcnt(0)
    v_mfma_f32_32x32x16_bf16 v[0:15], a[160:163], a[120:123], v[0:15]
    s_barrier
    ds_read_b64_tr_b16 a[176:177], v231 offset:63488
    ds_read_b64_tr_b16 a[178:179], v231 offset:64000
    ds_read_b64_tr_b16 a[180:181], v232 offset:63488
    ds_read_b64_tr_b16 a[182:183], v232 offset:64000
    v_mfma_f32_32x32x16_bf16 v[16:31], a[164:167], a[120:123], v[16:31]
    ds_read_b64_tr_b16 a[184:185], v233 offset:63488
    ds_read_b64_tr_b16 a[186:187], v233 offset:64000
    ds_read_b64_tr_b16 a[188:189], v234 offset:63488
    ds_read_b64_tr_b16 a[190:191], v234 offset:64000
    ds_read_b64_tr_b16 a[128:129], v236 offset:0
    v_mfma_f32_32x32x16_bf16 v[32:47], a[168:171], a[120:123], v[32:47]
    ds_read_b64_tr_b16 a[130:131], v236 offset:384
    ds_read_b64_tr_b16 a[132:133], v236 offset:32
    ds_read_b64_tr_b16 a[134:135], v236 offset:416
    v_mfma_f32_32x32x16_bf16 v[48:63], a[172:175], a[120:123], v[48:63]
    ds_read_b64_tr_b16 a[136:137], v236 offset:64
    ds_read_b64_tr_b16 a[138:139], v236 offset:448
    s_waitcnt vmcnt(18) lgkmcnt(6)
    s_nop 0
    v_mfma_f32_32x32x16_bf16 v[0:15], a[176:179], a[124:127], v[0:15]
    ds_read_b64_tr_b16 a[144:145], v236 offset:1536
    ds_read_b64_tr_b16 a[146:147], v236 offset:1920
    v_mfma_f32_32x32x16_bf16 v[16:31], a[180:183], a[124:127], v[16:31]
    ds_read_b64_tr_b16 a[148:149], v236 offset:1568
    ds_read_b64_tr_b16 a[150:151], v236 offset:1952
    v_mfma_f32_32x32x16_bf16 v[32:47], a[184:187], a[124:127], v[32:47]
    ds_read_b64_tr_b16 a[152:153], v236 offset:1600
    v_mfma_f32_32x32x16_bf16 v[48:63], a[188:191], a[124:127], v[48:63]
    ds_read_b64_tr_b16 a[154:155], v236 offset:1984
    s_waitcnt lgkmcnt(6)
    s_nop 0
    v_mfma_f32_32x32x16_bf16 v[64:79], a[128:131], a[0:3], 0
    ds_read_b64_tr_b16 a[160:161], v236 offset:3072
    ds_read_b64_tr_b16 a[162:163], v236 offset:3456
    ds_read_b64_tr_b16 a[164:165], v236 offset:3104
    v_mfma_f32_32x32x16_bf16 v[80:95], a[132:135], a[0:3], 0
    ds_read_b64_tr_b16 a[166:167], v236 offset:3488
    ds_read_b64_tr_b16 a[168:169], v236 offset:3136
    v_mfma_f32_32x32x16_bf16 v[96:111], a[136:139], a[0:3], 0
    ds_read_b64_tr_b16 a[170:171], v236 offset:3520
    v_fma_f32 v136, v0, v0, v246
    v_fma_f32 v137, v1, v1, v246
    v_fma_f32 v138, v2, v2, v246
    v_fma_f32 v139, v3, v3, v246
    s_waitcnt lgkmcnt(6)
    s_nop 0
    v_mfma_f32_32x32x16_bf16 v[64:79], a[144:147], a[4:7], v[64:79]
    ds_read_b64_tr_b16 a[176:177], v236 offset:4608
    ds_read_b64_tr_b16 a[178:179], v236 offset:4992
    ds_read_b64_tr_b16 a[180:181], v236 offset:4640
    v_fma_f32 v140, v4, v4, v246
    v_fma_f32 v141, v5, v5, v246
    v_fma_f32 v142, v6, v6, v246
    v_mfma_f32_32x32x16_bf16 v[80:95], a[148:151], a[4:7], v[80:95]
    ds_read_b64_tr_b16 a[182:183], v236 offset:5024
    ds_read_b64_tr_b16 a[184:185], v236 offset:4672
    v_fma_f32 v143, v7, v7, v246
    v_mul_f32 v136, v136, v0
    v_mul_f32 v137, v137, v1
    v_mul_f32_e64 v138, v138, v2
    v_mfma_f32_32x32x16_bf16 v[96:111], a[152:155], a[4:7], v[96:111]
    ds_read_b64_tr_b16 a[186:187], v236 offset:5056
    v_mul_f32 v139, v139, v3
    v_mul_f32 v140, v140, v4
    v_mul_f32 v141, v141, v5
    v_mul_f32_e64 v142, v142, v6
    s_waitcnt lgkmcnt(6)
    v_mfma_f32_32x32x16_bf16 v[64:79], a[160:163], a[8:11], v[64:79]
    ds_read_b64_tr_b16 a[128:129], v236 offset:6144
    ds_read_b64_tr_b16 a[130:131], v236 offset:6528
    ds_read_b64_tr_b16 a[132:133], v236 offset:6176
    v_mul_f32_e64 v143, v143, v7
    v_exp_f32 v136, -v136
    v_mfma_f32_32x32x16_bf16 v[80:95], a[164:167], a[8:11], v[80:95]
    ds_read_b64_tr_b16 a[134:135], v236 offset:6560
    ds_read_b64_tr_b16 a[136:137], v236 offset:6208
    v_mul_f32_e64 v0, v0, v8
    v_exp_f32 v137, -v137
    v_mul_f32_e64 v1, v1, v9
    v_mfma_f32_32x32x16_bf16 v[96:111], a[168:171], a[8:11], v[96:111]
    ds_read_b64_tr_b16 a[138:139], v236 offset:6592
    v_exp_f32 v138, -v138
    v_mul_f32 v2, v2, v10
    s_waitcnt lgkmcnt(6)
    v_mfma_f32_32x32x16_bf16 v[64:79], a[176:179], a[12:15], v[64:79]
    ds_read_b64_tr_b16 a[144:145], v236 offset:7680
    v_exp_f32 v139, -v139
    v_mul_f32_e64 v3, v3, v11
    v_exp_f32 v140, -v140
    v_mfma_f32_32x32x16_bf16 v[80:95], a[180:183], a[12:15], v[80:95]
    ds_read_b64_tr_b16 a[146:147], v236 offset:8064
    ds_read_b64_tr_b16 a[148:149], v236 offset:7712
    v_mul_f32_e64 v4, v4, v12
    v_exp_f32 v141, -v141
    v_mul_f32_e64 v5, v5, v13
    v_mfma_f32_32x32x16_bf16 v[96:111], a[184:187], a[12:15], v[96:111]
    ds_read_b64_tr_b16 a[150:151], v236 offset:8096
    ds_read_b64_tr_b16 a[152:153], v236 offset:7744
    ds_read_b64_tr_b16 a[154:155], v236 offset:8128
    v_exp_f32 v142, -v142
    s_waitcnt lgkmcnt(6)
    v_mfma_f32_32x32x16_bf16 v[64:79], a[128:131], a[16:19], v[64:79]
    v_mul_f32 v6, v6, v14
    v_exp_f32 v143, -v143
    v_mul_f32 v7, v7, v15
    v_add_f32 v136, 1.0, v136
    v_add_f32_e64 v137, 1.0, v137
    v_mfma_f32_32x32x16_bf16 v[80:95], a[132:135], a[16:19], v[80:95]
STUB10:
    s_cbranch_execz WARM_RET
    s_nop 0
    ds_read_b64_tr_b16 a[160:161], v236 offset:9216
    v_rcp_f32 v136, v136
    v_add_f32 v138, 1.0, v138
    v_rcp_f32_e64 v137, v137
    v_mfma_f32_32x32x16_bf16 v[96:111], a[136:139], a[16:19], v[96:111]
    ds_read_b64_tr_b16 a[162:163], v236 offset:9600
    ds_read_b64_tr_b16 a[164:165], v236 offset:9248
    ds_read_b64_tr_b16 a[166:167], v236 offset:9632
    ds_read_b64_tr_b16 a[168:169], v236 offset:9280
    ds_read_b64_tr_b16 a[170:171], v236 offset:9664
    s_waitcnt lgkmcnt(6)
    v_mfma_f32_32x32x16_bf16 v[64:79], a[144:147], a[20:23], v[64:79]
    v_add_f32 v139, 1.0, v139
    v_rcp_f32 v138, v138
    v_add_f32 v140, 1.0, v140
    v_rcp_f32_e64 v139, v139
    v_mfma_f32_32x32x16_bf16 v[80:95], a[148:151], a[20:23], v[80:95]
    v_add_f32 v141, 1.0, v141
    v_rcp_f32 v140, v140
    v_add_f32 v142, 1.0, v142
    v_rcp_f32 v141, v141
    v_mfma_f32_32x32x16_bf16 v[96:111], a[152:155], a[20:23], v[96:111]
    ds_read_b64_tr_b16 a[176:177], v236 offset:10752
    ds_read_b64_tr_b16 a[178:179], v236 offset:11136
    ds_read_b64_tr_b16 a[180:181], v236 offset:10784
    ds_read_b64_tr_b16 a[182:183], v236 offset:11168
    ds_read_b64_tr_b16 a[184:185], v236 offset:10816
    ds_read_b64_tr_b16 a[186:187], v236 offset:11200
    s_waitcnt lgkmcnt(6)
    v_mfma_f32_32x32x16_bf16 v[64:79], a[160:163], a[24:27], v[64:79]
    s_waitcnt vmcnt(12)
    s_barrier
    ds_read_b64_tr_b16 a[128:129], v235 offset:0
    v_add_f32 v143, 1.0, v143
    v_rcp_f32_e64 v142, v142
    v_mfma_f32_32x32x16_bf16 v[80:95], a[164:167], a[24:27], v[80:95]
    v_rcp_f32 v143, v143
    v_mul_f32 v0, v0, v136
    v_mul_f32 v1, v1, v137
    v_mul_f32 v2, v2, v138
    v_mul_f32_e64 v3, v3, v139
    v_mfma_f32_32x32x16_bf16 v[96:111], a[168:171], a[24:27], v[96:111]
    ds_read_b64_tr_b16 a[130:131], v235 offset:384
    ds_read_b64_tr_b16 a[132:133], v235 offset:32
    ds_read_b64_tr_b16 a[134:135], v235 offset:416
    ds_read_b64_tr_b16 a[136:137], v235 offset:64
    ds_read_b64_tr_b16 a[138:139], v235 offset:448
    v_mul_f32 v4, v4, v140
    v_mul_f32 v5, v5, v141
    v_mul_f32 v6, v6, v142
    s_waitcnt lgkmcnt(6)
    v_mfma_f32_32x32x16_bf16 v[64:79], a[176:179], a[28:31], v[64:79]
    ds_read_b64_tr_b16 a[144:145], v235 offset:1536
    v_mul_f32_e64 v7, v7, v143
    v_cvt_pk_bf16_f32 v152, v0, v1
    v_cvt_pk_bf16_f32 v153, v2, v3
    v_cvt_pk_bf16_f32 v154, v4, v5
    v_cvt_pk_bf16_f32 v155, v6, v7
    v_mfma_f32_32x32x16_bf16 v[80:95], a[180:183], a[28:31], v[80:95]
    buffer_store_dwordx4 v[152:155], v216, s[24:27], s42 offen offset:0 sc1
    v_fma_f32 v144, v16, v16, v246
    v_fma_f32 v145, v17, v17, v246
    v_fma_f32 v146, v18, v18, v246
    v_mfma_f32_32x32x16_bf16 v[96:111], a[184:187], a[28:31], v[96:111]
    ds_read_b64_tr_b16 a[146:147], v235 offset:1920
    ds_read_b64_tr_b16 a[148:149], v235 offset:1568
    ds_read_b64_tr_b16 a[150:151], v235 offset:1952
    ds_read_b64_tr_b16 a[152:153], v235 offset:1600
    ds_read_b64_tr_b16 a[154:155], v235 offset:1984
    v_fma_f32 v147, v19, v19, v246
    v_fma_f32 v148, v20, v20, v246
    v_fma_f32 v149, v21, v21, v246
    s_waitcnt lgkmcnt(6)
    v_mfma_f32_32x32x16_bf16 v[64:79], a[128:131], a[32:35], v[64:79]
    v_fma_f32 v150, v22, v22, v246
    v_fma_f32 v151, v23, v23, v246
    v_mul_f32 v144, v144, v16
    v_mul_f32 v145, v145, v17
    v_mul_f32 v146, v146, v18
    v_mul_f32_e64 v147, v147, v19
    v_mfma_f32_32x32x16_bf16 v[80:95], a[132:135], a[32:35], v[80:95]
    v_mul_f32 v148, v148, v20
    v_mul_f32 v149, v149, v21
    v_mul_f32 v150, v150, v22
    v_mul_f32 v151, v151, v23
    v_exp_f32 v144, -v144
    v_mfma_f32_32x32x16_bf16 v[96:111], a[136:139], a[32:35], v[96:111]
    ds_read_b64_tr_b16 a[160:161], v235 offset:3072
    ds_read_b64_tr_b16 a[162:163], v235 offset:3456
    ds_read_b64_tr_b16 a[164:165], v235 offset:3104
    ds_read_b64_tr_b16 a[166:167], v235 offset:3488
    ds_read_b64_tr_b16 a[168:169], v235 offset:3136
    ds_read_b64_tr_b16 a[170:171], v235 offset:3520
    v_mul_f32 v16, v16, v24
    s_waitcnt lgkmcnt(6)
    v_mfma_f32_32x32x16_bf16 v[64:79], a[144:147], a[36:39], v[64:79]
    v_exp_f32 v145, -v145
    v_mul_f32_e64 v17, v17, v25
    v_exp_f32 v146, -v146
    v_mul_f32_e64 v18, v18, v26
    v_mfma_f32_32x32x16_bf16 v[80:95], a[148:151], a[36:39], v[80:95]
    v_exp_f32 v147, -v147
    v_mul_f32_e64 v19, v19, v27
    v_exp_f32 v148, -v148
    v_mul_f32_e64 v20, v20, v28
    v_mfma_f32_32x32x16_bf16 v[96:111], a[152:155], a[36:39], v[96:111]
    ds_read_b64_tr_b16 a[176:177], v235 offset:4608
    ds_read_b64_tr_b16 a[178:179], v235 offset:4992
    ds_read_b64_tr_b16 a[180:181], v235 offset:4640
    ds_read_b64_tr_b16 a[182:183], v235 offset:5024
    ds_read_b64_tr_b16 a[184:185], v235 offset:4672
    ds_read_b64_tr_b16 a[186:187], v235 offset:5056
    v_exp_f32 v149, -v149
    v_mul_f32_e64 v21, v21, v29
    v_exp_f32 v150, -v150
    v_mul_f32 v22, v22, v30
    s_waitcnt lgkmcnt(6)
    v_mfma_f32_32x32x16_bf16 v[64:79], a[160:163], a[40:43], v[64:79]
    ds_read_b64_tr_b16 a[128:129], v235 offset:8192
    v_exp_f32 v151, -v151
    v_mul_f32 v23, v23, v31
    v_add_f32 v144, 1.0, v144
    v_add_f32_e64 v145, 1.0, v145
    v_mfma_f32_32x32x16_bf16 v[80:95], a[164:167], a[40:43], v[80:95]
    v_rcp_f32 v144, v144
    v_add_f32 v146, 1.0, v146
    v_rcp_f32 v145, v145
    v_add_f32 v147, 1.0, v147
    v_mfma_f32_32x32x16_bf16 v[96:111], a[168:171], a[40:43], v[96:111]
    ds_read_b64_tr_b16 a[130:131], v235 offset:8576
    ds_read_b64_tr_b16 a[132:133], v235 offset:8224
    ds_read_b64_tr_b16 a[134:135], v235 offset:8608
    ds_read_b64_tr_b16 a[136:137], v235 offset:8256
    ds_read_b64_tr_b16 a[138:139], v235 offset:8640
    v_rcp_f32 v146, v146
    v_add_f32 v148, 1.0, v148
    v_rcp_f32 v147, v147
    s_waitcnt lgkmcnt(6)
    v_mfma_f32_32x32x16_bf16 v[64:79], a[176:179], a[44:47], v[64:79]
    v_add_f32 v149, 1.0, v149
    v_rcp_f32 v148, v148
    v_add_f32 v150, 1.0, v150
    v_rcp_f32 v149, v149
    v_mfma_f32_32x32x16_bf16 v[80:95], a[180:183], a[44:47], v[80:95]
    v_add_f32 v151, 1.0, v151
    v_rcp_f32 v150, v150
    v_rcp_f32 v151, v151
    v_mul_f32 v16, v16, v144
    v_mfma_f32_32x32x16_bf16 v[96:111], a[184:187], a[44:47], v[96:111]
    ds_read_b64_tr_b16 a[144:145], v235 offset:9728
    ds_read_b64_tr_b16 a[146:147], v235 offset:10112
    ds_read_b64_tr_b16 a[148:149], v235 offset:9760
    ds_read_b64_tr_b16 a[150:151], v235 offset:10144
    ds_read_b64_tr_b16 a[152:153], v235 offset:9792
    ds_read_b64_tr_b16 a[154:155], v235 offset:10176
    v_mul_f32 v17, v17, v145
    v_mul_f32 v18, v18, v146
    v_mul_f32 v19, v19, v147
    v_mul_f32 v20, v20, v148
    s_mul_i32 s52, s72, 65536
    s_add_u32 s52, s52, 0
    s_add_u32 m0, s56, 49152
    s_waitcnt lgkmcnt(6)
    v_mfma_f32_32x32x16_bf16 v[64:79], a[128:131], a[48:51], v[64:79]
    v_mul_f32 v21, v21, v149
    v_mul_f32 v22, v22, v150
    v_mul_f32_e64 v23, v23, v151
    v_cvt_pk_bf16_f32 v156, v16, v17
    v_cvt_pk_bf16_f32 v157, v18, v19
    v_cvt_pk_bf16_f32 v158, v20, v21
    v_mfma_f32_32x32x16_bf16 v[80:95], a[132:135], a[48:51], v[80:95]
    buffer_load_dwordx4 v160, s[12:15], s52 offen lds
    buffer_load_dwordx4 v161, s[12:15], s52 offen offset:1024 lds
    v_cvt_pk_bf16_f32 v159, v22, v23
    v_mfma_f32_32x32x16_bf16 v[96:111], a[136:139], a[48:51], v[96:111]
    buffer_store_dwordx4 v[156:159], v216, s[24:27], s42 offen offset:1024 sc1
    ds_read_b64_tr_b16 a[160:161], v235 offset:11264
    ds_read_b64_tr_b16 a[162:163], v235 offset:11648
    ds_read_b64_tr_b16 a[164:165], v235 offset:11296
    ds_read_b64_tr_b16 a[166:167], v235 offset:11680
    ds_read_b64_tr_b16 a[168:169], v235 offset:11328
    ds_read_b64_tr_b16 a[170:171], v235 offset:11712
    v_fma_f32 v136, v32, v32, v246
    v_fma_f32 v137, v33, v33, v246
    v_fma_f32 v138, v34, v34, v246
    v_fma_f32 v139, v35, v35, v246
    s_waitcnt lgkmcnt(6)
    v_mfma_f32_32x32x16_bf16 v[64:79], a[144:147], a[52:55], v[64:79]
    v_fma_f32 v140, v36, v36, v246
    v_fma_f32 v141, v37, v37, v246
    v_fma_f32 v142, v38, v38, v246
    v_fma_f32 v143, v39, v39, v246
    v_mul_f32 v136, v136, v32
    v_mul_f32_e64 v137, v137, v33
    v_mfma_f32_32x32x16_bf16 v[80:95], a[148:151], a[52:55], v[80:95]
    v_mul_f32 v138, v138, v34
    v_mul_f32 v139, v139, v35
    v_mul_f32_e64 v140, v140, v36
    s_mul_i32 s52, s72, 65536
    s_add_u32 s52, s52, 16384
    s_add_u32 m0, s56, 51200
    v_mfma_f32_32x32x16_bf16 v[96:111], a[152:155], a[52:55], v[96:111]
    buffer_load_dwordx4 v160, s[12:15], s52 offen lds
    ds_read_b64_tr_b16 a[176:177], v235 offset:12800
    ds_read_b64_tr_b16 a[178:179], v235 offset:13184
    ds_read_b64_tr_b16 a[180:181], v235 offset:12832
    ds_read_b64_tr_b16 a[182:183], v235 offset:13216
    ds_read_b64_tr_b16 a[184:185], v235 offset:12864
    ds_read_b64_tr_b16 a[186:187], v235 offset:13248
    v_mul_f32 v141, v141, v37
    v_mul_f32 v142, v142, v38
    v_mul_f32 v143, v143, v39
    s_waitcnt lgkmcnt(6)
    v_mfma_f32_32x32x16_bf16 v[64:79], a[160:163], a[56:59], v[64:79]
    s_waitcnt vmcnt(11)
    s_barrier
    v_exp_f32 v136, -v136
    v_mul_f32_e64 v32, v32, v40
    v_exp_f32 v137, -v137
    v_mul_f32_e64 v33, v33, v41
    v_mfma_f32_32x32x16_bf16 v[80:95], a[164:167], a[56:59], v[80:95]
    buffer_load_dwordx4 v161, s[12:15], s52 offen offset:1024 lds
    v_exp_f32 v138, -v138
    v_mul_f32_e64 v34, v34, v42
    v_exp_f32 v139, -v139
    v_mul_f32_e64 v35, v35, v43
    v_mfma_f32_32x32x16_bf16 v[96:111], a[168:171], a[56:59], v[96:111]
    ds_read_b64_tr_b16 a[128:129], v235 offset:16384
    ds_read_b64_tr_b16 a[130:131], v235 offset:16768
    ds_read_b64_tr_b16 a[132:133], v235 offset:16416
    ds_read_b64_tr_b16 a[134:135], v235 offset:16800
    ds_read_b64_tr_b16 a[136:137], v235 offset:16448
    ds_read_b64_tr_b16 a[138:139], v235 offset:16832
    v_exp_f32 v140, -v140
    v_mul_f32_e64 v36, v36, v44
    v_exp_f32 v141, -v141
    v_mul_f32_e64 v37, v37, v45
    s_mul_i32 s52, s72, 65536
    s_add_u32 s52, s52, 32768
    s_add_u32 m0, s56, 114688
    s_waitcnt lgkmcnt(6)
    v_mfma_f32_32x32x16_bf16 v[64:79], a[176:179], a[60:63], v[64:79]
    v_exp_f32 v142, -v142
    v_mul_f32 v38, v38, v46
    v_exp_f32 v143, -v143
    v_mul_f32_e64 v39, v39, v47
    v_mfma_f32_32x32x16_bf16 v[80:95], a[180:183], a[60:63], v[80:95]
    buffer_load_dwordx4 v160, s[12:15], s52 offen lds
    v_add_f32 v136, 1.0, v136
    v_add_f32 v137, 1.0, v137
    v_rcp_f32_e64 v136, v136
    v_mfma_f32_32x32x16_bf16 v[96:111], a[184:187], a[60:63], v[96:111]
    buffer_load_dwordx4 v161, s[12:15], s52 offen offset:1024 lds
    s_mul_i32 s52, s72, 65536
    s_add_u32 s52, s52, 49152
    s_add_u32 m0, s56, 116736
    s_nop 0
    s_nop 0
    buffer_load_dwordx4 v160, s[12:15], s52 offen lds
    buffer_load_dwordx4 v161, s[12:15], s52 offen offset:1024 lds
    ds_read_b64_tr_b16 a[144:145], v235 offset:17920
    ds_read_b64_tr_b16 a[146:147], v235 offset:18304
    ds_read_b64_tr_b16 a[148:149], v235 offset:17952
    ds_read_b64_tr_b16 a[150:151], v235 offset:18336
    ds_read_b64_tr_b16 a[152:153], v235 offset:17984
    ds_read_b64_tr_b16 a[154:155], v235 offset:18368
    v_add_f32 v138, 1.0, v138
    v_rcp_f32 v137, v137
    v_add_f32 v139, 1.0, v139
    v_rcp_f32_e64 v138, v138
    s_waitcnt lgkmcnt(6)
    v_mfma_f32_32x32x16_bf16 v[64:79], a[128:131], a[64:67], v[64:79]
    v_add_f32 v140, 1.0, v140
    v_rcp_f32 v139, v139
    v_add_f32 v141, 1.0, v141
    v_rcp_f32 v140, v140
    v_mfma_f32_32x32x16_bf16 v[80:95], a[132:135], a[64:67], v[80:95]
    v_add_f32 v142, 1.0, v142
    v_rcp_f32 v141, v141
    v_add_f32 v143, 1.0, v143
    v_rcp_f32 v142, v142
    v_mfma_f32_32x32x16_bf16 v[96:111], a[136:139], a[64:67], v[96:111]
    ds_read_b64_tr_b16 a[160:161], v235 offset:19456
    ds_read_b64_tr_b16 a[162:163], v235 offset:19840
    ds_read_b64_tr_b16 a[164:165], v235 offset:19488
    ds_read_b64_tr_b16 a[166:167], v235 offset:19872
    ds_read_b64_tr_b16 a[168:169], v235 offset:19520
    ds_read_b64_tr_b16 a[170:171], v235 offset:19904
    v_rcp_f32 v143, v143
    v_mul_f32 v32, v32, v136
    v_mul_f32 v33, v33, v137
    v_mul_f32_e64 v34, v34, v138
    s_waitcnt lgkmcnt(6)
    v_mfma_f32_32x32x16_bf16 v[64:79], a[144:147], a[68:71], v[64:79]
    v_mul_f32 v35, v35, v139
    v_mul_f32 v36, v36, v140
    v_mul_f32 v37, v37, v141
    v_mul_f32 v38, v38, v142
    v_mul_f32_e64 v39, v39, v143
    v_cvt_pk_bf16_f32 v152, v32, v33
    v_mfma_f32_32x32x16_bf16 v[80:95], a[148:151], a[68:71], v[80:95]
    v_cvt_pk_bf16_f32 v153, v34, v35
    v_cvt_pk_bf16_f32 v154, v36, v37
    v_cvt_pk_bf16_f32 v155, v38, v39
    s_mul_i32 s52, s73, 65536
    s_add_u32 s52, s52, 0
    s_nop 0
    s_add_u32 m0, s56, 131072
    v_mfma_f32_32x32x16_bf16 v[96:111], a[152:155], a[68:71], v[96:111]
    buffer_store_dwordx4 v[152:155], v216, s[24:27], s42 offen offset:2048 sc1
    ds_read_b64_tr_b16 a[176:177], v235 offset:20992
    ds_read_b64_tr_b16 a[178:179], v235 offset:21376
    ds_read_b64_tr_b16 a[180:181], v235 offset:21024
    ds_read_b64_tr_b16 a[182:183], v235 offset:21408
    ds_read_b64_tr_b16 a[184:185], v235 offset:21056
    ds_read_b64_tr_b16 a[186:187], v235 offset:21440
    v_fma_f32 v144, v48, v48, v246
    v_fma_f32 v145, v49, v49, v246
    s_waitcnt lgkmcnt(6)
    s_nop 0
    v_mfma_f32_32x32x16_bf16 v[64:79], a[160:163], a[72:75], v[64:79]
    v_fma_f32 v146, v50, v50, v246
    v_fma_f32 v147, v51, v51, v246
    v_fma_f32 v148, v52, v52, v246
    v_fma_f32 v149, v53, v53, v246
    v_fma_f32 v150, v54, v54, v246
    v_fma_f32 v151, v55, v55, v246
    v_mfma_f32_32x32x16_bf16 v[80:95], a[164:167], a[72:75], v[80:95]
    v_mul_f32 v144, v144, v48
    v_mul_f32 v145, v145, v49
    v_mul_f32 v146, v146, v50
    v_mul_f32 v147, v147, v51
    v_mul_f32 v148, v148, v52
    v_mul_f32 v149, v149, v53
    v_mfma_f32_32x32x16_bf16 v[96:111], a[168:171], a[72:75], v[96:111]
    ds_read_b64_tr_b16 a[128:129], v235 offset:24576
    ds_read_b64_tr_b16 a[130:131], v235 offset:24960
    ds_read_b64_tr_b16 a[132:133], v235 offset:24608
    ds_read_b64_tr_b16 a[134:135], v235 offset:24992
    ds_read_b64_tr_b16 a[136:137], v235 offset:24640
    ds_read_b64_tr_b16 a[138:139], v235 offset:25024
    s_waitcnt lgkmcnt(6)
    v_mfma_f32_32x32x16_bf16 v[64:79], a[176:179], a[76:79], v[64:79]
    buffer_load_dwordx4 v160, s[12:15], s52 offen lds
    v_mul_f32 v150, v150, v54
    v_mul_f32_e64 v151, v151, v55
    v_exp_f32 v144, -v144
    v_mul_f32_e64 v48, v48, v56
    v_mfma_f32_32x32x16_bf16 v[80:95], a[180:183], a[76:79], v[80:95]
    v_exp_f32 v145, -v145
    v_mul_f32_e64 v49, v49, v57
    v_exp_f32 v146, -v146
    v_mul_f32_e64 v50, v50, v58
    v_mfma_f32_32x32x16_bf16 v[96:111], a[184:187], a[76:79], v[96:111]
    ds_read_b64_tr_b16 a[144:145], v235 offset:26112
    ds_read_b64_tr_b16 a[146:147], v235 offset:26496
    ds_read_b64_tr_b16 a[148:149], v235 offset:26144
    ds_read_b64_tr_b16 a[150:151], v235 offset:26528
    ds_read_b64_tr_b16 a[152:153], v235 offset:26176
    ds_read_b64_tr_b16 a[154:155], v235 offset:26560
    v_exp_f32 v147, -v147
    v_mul_f32_e64 v51, v51, v59
    v_exp_f32 v148, -v148
    v_mul_f32 v52, v52, v60
    s_waitcnt lgkmcnt(6)
    v_mfma_f32_32x32x16_bf16 v[64:79], a[128:131], a[80:83], v[64:79]
    buffer_load_dwordx4 v161, s[12:15], s52 offen offset:1024 lds
    v_exp_f32 v149, -v149
    v_mul_f32_e64 v53, v53, v61
    v_exp_f32 v150, -v150
    v_mul_f32_e64 v54, v54, v62
    v_mfma_f32_32x32x16_bf16 v[80:95], a[132:135], a[80:83], v[80:95]
    ds_read_b64_tr_b16 a[160:161], v235 offset:27648
    v_exp_f32 v151, -v151
    v_mul_f32 v55, v55, v63
    v_add_f32 v144, 1.0, v144
    v_add_f32_e64 v145, 1.0, v145
    v_mfma_f32_32x32x16_bf16 v[96:111], a[136:139], a[80:83], v[96:111]
    ds_read_b64_tr_b16 a[162:163], v235 offset:28032
    ds_read_b64_tr_b16 a[164:165], v235 offset:27680
    ds_read_b64_tr_b16 a[166:167], v235 offset:28064
    ds_read_b64_tr_b16 a[168:169], v235 offset:27712
    ds_read_b64_tr_b16 a[170:171], v235 offset:28096
    v_rcp_f32 v144, v144
    v_add_f32 v146, 1.0, v146
    v_rcp_f32 v145, v145
    s_waitcnt lgkmcnt(6)
    v_mfma_f32_32x32x16_bf16 v[64:79], a[144:147], a[84:87], v[64:79]
    v_add_f32 v147, 1.0, v147
    v_rcp_f32 v146, v146
    v_add_f32 v148, 1.0, v148
    v_rcp_f32 v147, v147
    v_add_f32 v149, 1.0, v149
    v_rcp_f32 v148, v148
    v_add_f32 v150, 1.0, v150
    v_rcp_f32 v149, v149
    v_add_f32 v151, 1.0, v151
    v_rcp_f32 v150, v150
    v_rcp_f32 v151, v151
    v_mul_f32 v48, v48, v144
    v_mul_f32 v49, v49, v145
    v_mul_f32 v50, v50, v146
    v_mul_f32 v51, v51, v147
    v_mul_f32 v52, v52, v148
    v_mul_f32 v53, v53, v149
    v_mul_f32 v54, v54, v150
    v_mul_f32_e64 v55, v55, v151
    v_cvt_pk_bf16_f32 v156, v48, v49
    v_cvt_pk_bf16_f32 v157, v50, v51
    v_cvt_pk_bf16_f32 v158, v52, v53
    v_cvt_pk_bf16_f32 v159, v54, v55
    buffer_store_dwordx4 v[156:159], v216, s[24:27], s42 offen offset:3072 sc1
    s_mul_i32 s52, s73, 65536
    s_add_u32 s52, s52, 16384
    s_add_u32 m0, s56, 133120
    v_mfma_f32_32x32x16_bf16 v[80:95], a[148:151], a[84:87], v[80:95]
    buffer_load_dwordx4 v160, s[12:15], s52 offen lds
    ds_read_b64_tr_b16 a[176:177], v235 offset:29184
    ds_read_b64_tr_b16 a[178:179], v235 offset:29568
    ds_read_b64_tr_b16 a[180:181], v235 offset:29216
    v_mfma_f32_32x32x16_bf16 v[96:111], a[152:155], a[84:87], v[96:111]
    buffer_load_dwordx4 v161, s[12:15], s52 offen offset:1024 lds
    ds_read_b64_tr_b16 a[182:183], v235 offset:29600
    ds_read_b64_tr_b16 a[184:185], v235 offset:29248
    ds_read_b64_tr_b16 a[186:187], v235 offset:29632
    s_waitcnt lgkmcnt(6)
    v_mfma_f32_32x32x16_bf16 v[64:79], a[160:163], a[88:91], v[64:79]
    s_waitcnt vmcnt(16)
    s_barrier
    s_nop 0
    ds_read_b64_tr_b16 a[128:129], v235 offset:32768
    ds_read_b64_tr_b16 a[130:131], v235 offset:33152
    ds_read_b64_tr_b16 a[132:133], v235 offset:32800
    v_mfma_f32_32x32x16_bf16 v[80:95], a[164:167], a[88:91], v[80:95]
    ds_read_b64_tr_b16 a[134:135], v235 offset:33184
    ds_read_b64_tr_b16 a[136:137], v235 offset:32832
    s_mul_i32 s52, s73, 65536
    s_add_u32 s52, s52, 32768
    s_add_u32 m0, s56, 0
    v_mfma_f32_32x32x16_bf16 v[96:111], a[168:171], a[88:91], v[96:111]
    ds_read_b64_tr_b16 a[138:139], v235 offset:33216
    s_waitcnt lgkmcnt(6)
    v_mfma_f32_32x32x16_bf16 v[64:79], a[176:179], a[92:95], v[64:79]
    buffer_load_dwordx4 v160, s[12:15], s52 offen lds
    ds_read_b64_tr_b16 a[144:145], v235 offset:34304
    ds_read_b64_tr_b16 a[146:147], v235 offset:34688
    ds_read_b64_tr_b16 a[148:149], v235 offset:34336
    v_mfma_f32_32x32x16_bf16 v[80:95], a[180:183], a[92:95], v[80:95]
    ds_read_b64_tr_b16 a[150:151], v235 offset:34720
    ds_read_b64_tr_b16 a[152:153], v235 offset:34368
    v_mfma_f32_32x32x16_bf16 v[96:111], a[184:187], a[92:95], v[96:111]
    buffer_load_dwordx4 v161, s[12:15], s52 offen offset:1024 lds
    ds_read_b64_tr_b16 a[154:155], v235 offset:34752
    s_waitcnt lgkmcnt(6)
    s_nop 0
    v_mfma_f32_32x32x16_bf16 v[64:79], a[128:131], a[96:99], v[64:79]
    ds_read_b64_tr_b16 a[160:161], v235 offset:35840
    ds_read_b64_tr_b16 a[162:163], v235 offset:36224
    ds_read_b64_tr_b16 a[164:165], v235 offset:35872
    v_mfma_f32_32x32x16_bf16 v[80:95], a[132:135], a[96:99], v[80:95]
    ds_read_b64_tr_b16 a[166:167], v235 offset:36256
    ds_read_b64_tr_b16 a[168:169], v235 offset:35904
    s_mul_i32 s52, s73, 65536
    s_add_u32 s52, s52, 49152
    s_add_u32 m0, s56, 2048
    v_mfma_f32_32x32x16_bf16 v[96:111], a[136:139], a[96:99], v[96:111]
    ds_read_b64_tr_b16 a[170:171], v235 offset:36288
    s_waitcnt lgkmcnt(6)
    v_mfma_f32_32x32x16_bf16 v[64:79], a[144:147], a[100:103], v[64:79]
    buffer_load_dwordx4 v160, s[12:15], s52 offen lds
    ds_read_b64_tr_b16 a[176:177], v235 offset:37376
    ds_read_b64_tr_b16 a[178:179], v235 offset:37760
    ds_read_b64_tr_b16 a[180:181], v235 offset:37408
    v_mfma_f32_32x32x16_bf16 v[80:95], a[148:151], a[100:103], v[80:95]
    s_waitcnt vmcnt(5)
    s_barrier
    buffer_store_dword v250, v251, s[20:23], s60 offen sc1
    ds_read_b64_tr_b16 a[182:183], v235 offset:37792
    v_mfma_f32_32x32x16_bf16 v[96:111], a[152:155], a[100:103], v[96:111]
    buffer_load_dwordx4 v161, s[12:15], s52 offen offset:1024 lds
    ds_read_b64_tr_b16 a[184:185], v235 offset:37440
    ds_read_b64_tr_b16 a[186:187], v235 offset:37824
    s_waitcnt lgkmcnt(6)
    v_mfma_f32_32x32x16_bf16 v[64:79], a[160:163], a[104:107], v[64:79]
    ds_read_b64_tr_b16 a[128:129], v235 offset:40960
    ds_read_b64_tr_b16 a[130:131], v235 offset:41344
    ds_read_b64_tr_b16 a[132:133], v235 offset:40992
    v_mfma_f32_32x32x16_bf16 v[80:95], a[164:167], a[104:107], v[80:95]
    ds_read_b64_tr_b16 a[134:135], v235 offset:41376
    ds_read_b64_tr_b16 a[136:137], v235 offset:41024
    v_mfma_f32_32x32x16_bf16 v[96:111], a[168:171], a[104:107], v[96:111]
    ds_read_b64_tr_b16 a[138:139], v235 offset:41408
    s_mul_i32 s52, s74, 65536
    s_add_u32 s52, s52, 0
    s_add_u32 m0, s56, 65536
    s_waitcnt lgkmcnt(6)
    v_mfma_f32_32x32x16_bf16 v[64:79], a[176:179], a[108:111], v[64:79]
    ds_read_b64_tr_b16 a[144:145], v235 offset:42496
    ds_read_b64_tr_b16 a[146:147], v235 offset:42880
    ds_read_b64_tr_b16 a[148:149], v235 offset:42528
    v_mfma_f32_32x32x16_bf16 v[80:95], a[180:183], a[108:111], v[80:95]
    buffer_load_dwordx4 v160, s[12:15], s52 offen lds
    ds_read_b64_tr_b16 a[150:151], v235 offset:42912
    ds_read_b64_tr_b16 a[152:153], v235 offset:42560
    v_mfma_f32_32x32x16_bf16 v[96:111], a[184:187], a[108:111], v[96:111]
    ds_read_b64_tr_b16 a[154:155], v235 offset:42944
    s_waitcnt lgkmcnt(6)
    s_nop 0
    v_mfma_f32_32x32x16_bf16 v[64:79], a[128:131], a[112:115], v[64:79]
    buffer_load_dwordx4 v161, s[12:15], s52 offen offset:1024 lds
    ds_read_b64_tr_b16 a[160:161], v235 offset:44032
    ds_read_b64_tr_b16 a[162:163], v235 offset:44416
    ds_read_b64_tr_b16 a[164:165], v235 offset:44064
    v_mfma_f32_32x32x16_bf16 v[80:95], a[132:135], a[112:115], v[80:95]
    ds_read_b64_tr_b16 a[166:167], v235 offset:44448
    ds_read_b64_tr_b16 a[168:169], v235 offset:44096
    v_mfma_f32_32x32x16_bf16 v[96:111], a[136:139], a[112:115], v[96:111]
    ds_read_b64_tr_b16 a[170:171], v235 offset:44480
    s_mul_i32 s52, s74, 65536
    s_add_u32 s52, s52, 16384
    s_add_u32 m0, s56, 67584
    s_waitcnt lgkmcnt(6)
    s_nop 0
    v_mfma_f32_32x32x16_bf16 v[64:79], a[144:147], a[116:119], v[64:79]
    ds_read_b64_tr_b16 a[176:177], v235 offset:45568
    ds_read_b64_tr_b16 a[178:179], v235 offset:45952
    ds_read_b64_tr_b16 a[180:181], v235 offset:45600
    v_mfma_f32_32x32x16_bf16 v[80:95], a[148:151], a[116:119], v[80:95]
    buffer_load_dwordx4 v160, s[12:15], s52 offen lds
    ds_read_b64_tr_b16 a[182:183], v235 offset:45984
    ds_read_b64_tr_b16 a[184:185], v235 offset:45632
    v_mfma_f32_32x32x16_bf16 v[96:111], a[152:155], a[116:119], v[96:111]
    ds_read_b64_tr_b16 a[186:187], v235 offset:46016
    s_waitcnt lgkmcnt(6)
    v_mfma_f32_32x32x16_bf16 v[64:79], a[160:163], a[120:123], v[64:79]
    buffer_load_dwordx4 v161, s[12:15], s52 offen offset:1024 lds
    v_mfma_f32_32x32x16_bf16 v[80:95], a[164:167], a[120:123], v[80:95]
    v_mfma_f32_32x32x16_bf16 v[96:111], a[168:171], a[120:123], v[96:111]
    s_waitcnt lgkmcnt(0)
    v_mfma_f32_32x32x16_bf16 v[64:79], a[176:179], a[124:127], v[64:79]
    s_waitcnt lgkmcnt(0)
    s_barrier
    v_mfma_f32_32x32x16_bf16 v[80:95], a[180:183], a[124:127], v[80:95]
    v_mfma_f32_32x32x16_bf16 v[96:111], a[184:187], a[124:127], v[96:111]
    s_mul_i32 s52, s74, 65536
    s_add_u32 s52, s52, 32768
    s_add_u32 m0, s56, 16384
    s_nop 0
    buffer_load_dwordx4 v160, s[12:15], s52 offen lds
    buffer_load_dwordx4 v161, s[12:15], s52 offen offset:1024 lds
    s_mul_i32 s52, s74, 65536
    s_add_u32 s52, s52, 49152
    s_add_u32 m0, s56, 18432
    s_nop 0
    buffer_load_dwordx4 v160, s[12:15], s52 offen lds
    buffer_load_dwordx4 v161, s[12:15], s52 offen offset:1024 lds
    s_mul_i32 s52, s75, 65536
    s_add_u32 s52, s52, 0
    s_add_u32 m0, s56, 32768
    s_nop 0
    buffer_load_dwordx4 v160, s[12:15], s52 offen lds
    buffer_load_dwordx4 v161, s[12:15], s52 offen offset:1024 lds
    v_pk_fma_f32 v[136:137], v[64:65], v[64:65], v[246:247]
    v_pk_fma_f32 v[138:139], v[66:67], v[66:67], v[246:247]
    v_pk_fma_f32 v[140:141], v[68:69], v[68:69], v[246:247]
    v_pk_fma_f32 v[142:143], v[70:71], v[70:71], v[246:247]
    v_pk_mul_f32 v[136:137], v[136:137], v[64:65]
    v_pk_mul_f32 v[138:139], v[138:139], v[66:67]
    v_pk_mul_f32 v[140:141], v[140:141], v[68:69]
    v_pk_mul_f32 v[142:143], v[142:143], v[70:71]
    v_exp_f32 v136, -v136
    v_exp_f32 v137, -v137
    v_exp_f32 v138, -v138
    v_exp_f32 v139, -v139
    v_exp_f32 v140, -v140
    v_exp_f32 v141, -v141
    v_exp_f32 v142, -v142
    v_exp_f32 v143, -v143
    v_pk_mul_f32 v[64:65], v[64:65], v[72:73]
    v_pk_mul_f32 v[66:67], v[66:67], v[74:75]
    v_pk_mul_f32 v[68:69], v[68:69], v[76:77]
    v_pk_mul_f32 v[70:71], v[70:71], v[78:79]
    v_pk_add_f32 v[136:137], v[136:137], 1.0 op_sel_hi:[1,0]
    v_pk_add_f32 v[138:139], v[138:139], 1.0 op_sel_hi:[1,0]
    v_pk_add_f32 v[140:141], v[140:141], 1.0 op_sel_hi:[1,0]
    v_pk_add_f32 v[142:143], v[142:143], 1.0 op_sel_hi:[1,0]
    v_rcp_f32 v136, v136
    v_rcp_f32 v137, v137
    v_rcp_f32 v138, v138
    v_rcp_f32 v139, v139
    v_rcp_f32 v140, v140
    v_rcp_f32 v141, v141
    v_rcp_f32 v142, v142
    v_rcp_f32 v143, v143
    v_pk_mul_f32 v[64:65], v[64:65], v[136:137]
STUB11:
    s_cbranch_execz WARM_RET
    s_nop 0
    v_pk_mul_f32 v[66:67], v[66:67], v[138:139]
    v_pk_mul_f32 v[68:69], v[68:69], v[140:141]
    v_pk_mul_f32 v[70:71], v[70:71], v[142:143]
    v_cvt_pk_bf16_f32 v152, v64, v65
    v_cvt_pk_bf16_f32 v153, v66, v67
    v_cvt_pk_bf16_f32 v154, v68, v69
    v_cvt_pk_bf16_f32 v155, v70, v71
    buffer_store_dwordx4 v[152:155], v216, s[24:27], s43 offen offset:0 sc1
    s_mul_i32 s52, s75, 65536
    s_add_u32 s52, s52, 16384
    s_add_u32 m0, s56, 34816
    s_nop 0
    buffer_load_dwordx4 v160, s[12:15], s52 offen lds
    buffer_load_dwordx4 v161, s[12:15], s52 offen offset:1024 lds
    s_mul_i32 s52, s75, 65536
    s_add_u32 s52, s52, 32768
    s_add_u32 m0, s56, 81920
    s_nop 0
    buffer_load_dwordx4 v160, s[12:15], s52 offen lds
    buffer_load_dwordx4 v161, s[12:15], s52 offen offset:1024 lds
    s_mul_i32 s52, s75, 65536
    s_add_u32 s52, s52, 49152
    s_add_u32 m0, s56, 83968
    s_nop 0
    s_nop 0
    buffer_load_dwordx4 v160, s[12:15], s52 offen lds
    buffer_load_dwordx4 v161, s[12:15], s52 offen offset:1024 lds
    v_pk_fma_f32 v[144:145], v[80:81], v[80:81], v[246:247]
    v_pk_fma_f32 v[146:147], v[82:83], v[82:83], v[246:247]
    v_pk_fma_f32 v[148:149], v[84:85], v[84:85], v[246:247]
    v_pk_fma_f32 v[150:151], v[86:87], v[86:87], v[246:247]
    v_pk_mul_f32 v[144:145], v[144:145], v[80:81]
    v_pk_mul_f32 v[146:147], v[146:147], v[82:83]
    v_pk_mul_f32 v[148:149], v[148:149], v[84:85]
    v_pk_mul_f32 v[150:151], v[150:151], v[86:87]
    v_exp_f32 v144, -v144
    v_exp_f32 v145, -v145
    v_exp_f32 v146, -v146
    v_exp_f32 v147, -v147
    v_exp_f32 v148, -v148
    v_exp_f32 v149, -v149
    v_exp_f32 v150, -v150
    v_exp_f32 v151, -v151
    v_pk_mul_f32 v[80:81], v[80:81], v[88:89]
    v_pk_mul_f32 v[82:83], v[82:83], v[90:91]
    v_pk_mul_f32 v[84:85], v[84:85], v[92:93]
    v_pk_mul_f32 v[86:87], v[86:87], v[94:95]
    v_pk_add_f32 v[144:145], v[144:145], 1.0 op_sel_hi:[1,0]
    v_pk_add_f32 v[146:147], v[146:147], 1.0 op_sel_hi:[1,0]
    v_pk_add_f32 v[148:149], v[148:149], 1.0 op_sel_hi:[1,0]
    v_pk_add_f32 v[150:151], v[150:151], 1.0 op_sel_hi:[1,0]
    v_rcp_f32 v144, v144
    v_rcp_f32 v145, v145
    v_rcp_f32 v146, v146
    v_rcp_f32 v147, v147
    v_rcp_f32 v148, v148
    v_rcp_f32 v149, v149
    v_rcp_f32 v150, v150
    v_rcp_f32 v151, v151
    v_pk_mul_f32 v[80:81], v[80:81], v[144:145]
    v_pk_mul_f32 v[82:83], v[82:83], v[146:147]
    v_pk_mul_f32 v[84:85], v[84:85], v[148:149]
    v_pk_mul_f32 v[86:87], v[86:87], v[150:151]
    v_cvt_pk_bf16_f32 v156, v80, v81
    v_cvt_pk_bf16_f32 v157, v82, v83
    v_cvt_pk_bf16_f32 v158, v84, v85
    v_cvt_pk_bf16_f32 v159, v86, v87
    buffer_store_dwordx4 v[156:159], v216, s[24:27], s43 offen offset:1024 sc1
    v_pk_fma_f32 v[136:137], v[96:97], v[96:97], v[246:247]
    v_pk_fma_f32 v[138:139], v[98:99], v[98:99], v[246:247]
    v_pk_fma_f32 v[140:141], v[100:101], v[100:101], v[246:247]
    v_pk_fma_f32 v[142:143], v[102:103], v[102:103], v[246:247]
    v_pk_mul_f32 v[136:137], v[136:137], v[96:97]
    v_pk_mul_f32 v[138:139], v[138:139], v[98:99]
    v_pk_mul_f32 v[140:141], v[140:141], v[100:101]
    v_pk_mul_f32 v[142:143], v[142:143], v[102:103]
    v_exp_f32 v136, -v136
    v_exp_f32 v137, -v137
    v_exp_f32 v138, -v138
    v_exp_f32 v139, -v139
    v_exp_f32 v140, -v140
    v_exp_f32 v141, -v141
    v_exp_f32 v142, -v142
    v_exp_f32 v143, -v143
    v_pk_mul_f32 v[96:97], v[96:97], v[104:105]
    v_pk_mul_f32 v[98:99], v[98:99], v[106:107]
    v_pk_mul_f32 v[100:101], v[100:101], v[108:109]
    v_pk_mul_f32 v[102:103], v[102:103], v[110:111]
    v_pk_add_f32 v[136:137], v[136:137], 1.0 op_sel_hi:[1,0]
    v_pk_add_f32 v[138:139], v[138:139], 1.0 op_sel_hi:[1,0]
    v_pk_add_f32 v[140:141], v[140:141], 1.0 op_sel_hi:[1,0]
    v_pk_add_f32 v[142:143], v[142:143], 1.0 op_sel_hi:[1,0]
    v_rcp_f32 v136, v136
    v_rcp_f32 v137, v137
    v_rcp_f32 v138, v138
    v_rcp_f32 v139, v139
    v_rcp_f32 v140, v140
    v_rcp_f32 v141, v141
    v_rcp_f32 v142, v142
    v_rcp_f32 v143, v143
    v_pk_mul_f32 v[96:97], v[96:97], v[136:137]
    v_pk_mul_f32 v[98:99], v[98:99], v[138:139]
    v_pk_mul_f32 v[100:101], v[100:101], v[140:141]
    v_pk_mul_f32 v[102:103], v[102:103], v[142:143]
    v_cvt_pk_bf16_f32 v152, v96, v97
    v_cvt_pk_bf16_f32 v153, v98, v99
    v_cvt_pk_bf16_f32 v154, v100, v101
    v_cvt_pk_bf16_f32 v155, v102, v103
    buffer_store_dwordx4 v[152:155], v216, s[24:27], s43 offen offset:2048 sc1
    s_lshl_b32 s54, s51, 1
    s_and_b32 s55, s28, 1
    s_add_u32 s63, s54, s55
    s_lshr_b32 s64, s28, 1
    s_lshl_b32 s64, s64, 2
    s_lshl_b32 s54, s50, 3
    s_add_u32 s64, s64, s54
    s_lshl_b32 s65, s63, 15
    s_lshl_b32 s55, s64, 9
    s_add_u32 s65, s65, s55
    s_add_u32 s65, s65, 0x1400000
    v_lshlrev_b32 v170, 5, v243
    s_lshl_b32 s55, s64, 5
    s_add_u32 s55, s55, 10240
    s_mov_b64 exec, 0xf
    s_mov_b32 s3, 0
POLL_3:
    buffer_load_dword v249, v248, s[24:27], s59 offen sc1
    s_add_u32 s3, s3, 1
    s_waitcnt vmcnt(0)
    v_cmp_eq_u32_e64 vcc, 0, v249
    s_cmp_gt_u32 s3, 0x8000
    s_cbranch_scc1 POLLED_3
    s_nop 2
    s_cbranch_vccz POLLED_3
    s_sleep 4
    s_branch POLL_3
POLLED_3:
    s_mov_b64 exec, -1
    s_barrier
    buffer_store_dword v250, v251, s[20:23], s62 offen sc1
    s_lshl_b32 s76, s72, 12
    s_add_u32 s76, s76, s57
    s_nop 0
    buffer_load_dwordx4 a[0:3], v216, s[24:27], s76 offen offset:0 sc1
    buffer_load_dwordx4 a[4:7], v168, s[24:27], s76 offen offset:0 sc1
    buffer_load_dwordx4 a[8:11], v216, s[24:27], s76 offen offset:1024 sc1
    buffer_load_dwordx4 a[12:15], v168, s[24:27], s76 offen offset:1024 sc1
    buffer_load_dwordx4 a[16:19], v216, s[24:27], s76 offen offset:2048 sc1
    buffer_load_dwordx4 a[20:23], v168, s[24:27], s76 offen offset:2048 sc1
    buffer_load_dwordx4 a[24:27], v216, s[24:27], s76 offen offset:3072 sc1
    buffer_load_dwordx4 a[28:31], v168, s[24:27], s76 offen offset:3072 sc1
    s_lshl_b32 s77, s73, 12
    s_add_u32 s77, s77, s57
    buffer_load_dwordx4 a[32:35], v216, s[24:27], s77 offen offset:0 sc1
    buffer_load_dwordx4 a[36:39], v168, s[24:27], s77 offen offset:0 sc1
    buffer_load_dwordx4 a[40:43], v216, s[24:27], s77 offen offset:1024 sc1
    buffer_load_dwordx4 a[44:47], v168, s[24:27], s77 offen offset:1024 sc1
    ds_read_b64_tr_b16 a[224:225], v162 offset:49152
    ds_read_b64_tr_b16 a[226:227], v162 offset:49664
    ds_read_b64_tr_b16 a[228:229], v163 offset:49152
    ds_read_b64_tr_b16 a[230:231], v163 offset:49664
    ds_read_b64_tr_b16 a[232:233], v162 offset:51200
    ds_read_b64_tr_b16 a[234:235], v162 offset:51712
    ds_read_b64_tr_b16 a[236:237], v163 offset:51200
    ds_read_b64_tr_b16 a[238:239], v163 offset:51712
    v_add_u32_e64 v173, s56, v216
    v_add_u32 v173, 0x10000, v173
    s_waitcnt vmcnt(11) lgkmcnt(6)
    v_mfma_f32_32x32x16_bf16 v[0:15], a[224:227], a[0:3], 0
    buffer_load_dwordx4 a[48:51], v216, s[24:27], s77 offen offset:2048 sc1
    buffer_load_dwordx4 a[52:55], v168, s[24:27], s77 offen offset:2048 sc1
    ds_read_b64_tr_b16 a[240:241], v164 offset:49152
    ds_read_b64_tr_b16 a[242:243], v164 offset:49664
    s_waitcnt vmcnt(12)
    v_mfma_f32_32x32x16_bf16 v[16:31], a[224:227], a[4:7], 0
    buffer_load_dwordx4 a[56:59], v216, s[24:27], s77 offen offset:3072 sc1
    ds_read_b64_tr_b16 a[244:245], v165 offset:49152
    s_waitcnt lgkmcnt(7)
    v_mfma_f32_32x32x16_bf16 v[32:47], a[228:231], a[0:3], 0
    buffer_load_dwordx4 a[60:63], v168, s[24:27], s77 offen offset:3072 sc1
    ds_read_b64_tr_b16 a[246:247], v165 offset:49664
    v_mfma_f32_32x32x16_bf16 v[48:63], a[228:231], a[4:7], 0
    s_waitcnt vmcnt(12) lgkmcnt(4)
    v_mfma_f32_32x32x16_bf16 v[0:15], a[232:235], a[8:11], v[0:15]
    s_lshl_b32 s78, s74, 12
    s_add_u32 s78, s78, s57
    buffer_load_dwordx4 a[64:67], v216, s[24:27], s78 offen offset:0 sc1
    ds_read_b64_tr_b16 a[248:249], v164 offset:51200
    ds_read_b64_tr_b16 a[250:251], v164 offset:51712
    v_mfma_f32_32x32x16_bf16 v[16:31], a[232:235], a[12:15], v[16:31]
    buffer_load_dwordx4 a[68:71], v168, s[24:27], s78 offen offset:0 sc1
    ds_read_b64_tr_b16 a[252:253], v165 offset:51200
    v_mfma_f32_32x32x16_bf16 v[32:47], a[236:239], a[8:11], v[32:47]
    buffer_load_dwordx4 a[72:75], v216, s[24:27], s78 offen offset:1024 sc1
    ds_read_b64_tr_b16 a[254:255], v165 offset:51712
    v_mfma_f32_32x32x16_bf16 v[48:63], a[236:239], a[12:15], v[48:63]
    buffer_load_dwordx4 a[76:79], v168, s[24:27], s78 offen offset:1024 sc1
    s_waitcnt vmcnt(14) lgkmcnt(4)
    s_nop 0
    v_mfma_f32_32x32x16_bf16 v[0:15], a[240:243], a[16:19], v[0:15]
    buffer_load_dwordx4 a[80:83], v216, s[24:27], s78 offen offset:2048 sc1
    buffer_load_dwordx4 a[84:87], v168, s[24:27], s78 offen offset:2048 sc1
    ds_read_b64_tr_b16 a[224:225], v166 offset:0
    ds_read_b64_tr_b16 a[226:227], v166 offset:512
    v_mfma_f32_32x32x16_bf16 v[16:31], a[240:243], a[20:23], v[16:31]
    buffer_load_dwordx4 a[88:91], v216, s[24:27], s78 offen offset:3072 sc1
    ds_read_b64_tr_b16 a[228:229], v167 offset:0
    v_mfma_f32_32x32x16_bf16 v[32:47], a[244:247], a[16:19], v[32:47]
    buffer_load_dwordx4 a[92:95], v168, s[24:27], s78 offen offset:3072 sc1
    ds_read_b64_tr_b16 a[230:231], v167 offset:512
    v_mfma_f32_32x32x16_bf16 v[48:63], a[244:247], a[20:23], v[48:63]
    s_waitcnt vmcnt(16) lgkmcnt(4)
    v_mfma_f32_32x32x16_bf16 v[0:15], a[248:251], a[24:27], v[0:15]
    s_lshl_b32 s79, s75, 12
    s_add_u32 s79, s79, s57
    s_nop 0
    buffer_load_dwordx4 a[96:99], v216, s[24:27], s79 offen offset:0 sc1
    ds_read_b64_tr_b16 a[232:233], v166 offset:2048
    ds_read_b64_tr_b16 a[234:235], v166 offset:2560
    v_mfma_f32_32x32x16_bf16 v[16:31], a[248:251], a[28:31], v[16:31]
    buffer_load_dwordx4 a[100:103], v168, s[24:27], s79 offen offset:0 sc1
    ds_read_b64_tr_b16 a[236:237], v167 offset:2048
    v_mfma_f32_32x32x16_bf16 v[32:47], a[252:255], a[24:27], v[32:47]
    buffer_load_dwordx4 a[104:107], v216, s[24:27], s79 offen offset:1024 sc1
    ds_read_b64_tr_b16 a[238:239], v167 offset:2560
    v_mfma_f32_32x32x16_bf16 v[48:63], a[252:255], a[28:31], v[48:63]
    buffer_load_dwordx4 a[108:111], v168, s[24:27], s79 offen offset:1024 sc1
    s_waitcnt vmcnt(18) lgkmcnt(4)
    s_nop 0
    v_mfma_f32_32x32x16_bf16 v[0:15], a[224:227], a[32:35], v[0:15]
    buffer_load_dwordx4 a[112:115], v216, s[24:27], s79 offen offset:2048 sc1
    buffer_load_dwordx4 a[116:119], v168, s[24:27], s79 offen offset:2048 sc1
    ds_read_b64_tr_b16 a[240:241], v162 offset:0
    ds_read_b64_tr_b16 a[242:243], v162 offset:512
    v_mfma_f32_32x32x16_bf16 v[16:31], a[224:227], a[36:39], v[16:31]
    buffer_load_dwordx4 a[120:123], v216, s[24:27], s79 offen offset:3072 sc1
    ds_read_b64_tr_b16 a[244:245], v163 offset:0
    v_mfma_f32_32x32x16_bf16 v[32:47], a[228:231], a[32:35], v[32:47]
    buffer_load_dwordx4 a[124:127], v168, s[24:27], s79 offen offset:3072 sc1
    ds_read_b64_tr_b16 a[246:247], v163 offset:512
    v_mfma_f32_32x32x16_bf16 v[48:63], a[228:231], a[36:39], v[48:63]
    s_waitcnt vmcnt(20) lgkmcnt(4)
    v_mfma_f32_32x32x16_bf16 v[0:15], a[232:235], a[40:43], v[0:15]
    s_mul_i32 s52, s72, 49152
    s_add_u32 s52, s52, 1048576
    s_add_u32 m0, s56, 98304
    s_nop 0
    buffer_load_dwordx4 v160, s[12:15], s52 offen lds
    ds_read_b64_tr_b16 a[248:249], v162 offset:2048
    ds_read_b64_tr_b16 a[250:251], v162 offset:2560
    v_mfma_f32_32x32x16_bf16 v[16:31], a[232:235], a[44:47], v[16:31]
    buffer_load_dwordx4 v161, s[12:15], s52 offen offset:1024 lds
    ds_read_b64_tr_b16 a[252:253], v163 offset:2048
    s_mul_i32 s52, s72, 49152
    s_add_u32 s52, s52, 1064960
    s_add_u32 m0, s56, 100352
    v_mfma_f32_32x32x16_bf16 v[32:47], a[236:239], a[40:43], v[32:47]
    buffer_load_dwordx4 v160, s[12:15], s52 offen lds
    ds_read_b64_tr_b16 a[254:255], v163 offset:2560
    v_mfma_f32_32x32x16_bf16 v[48:63], a[236:239], a[44:47], v[48:63]
    buffer_load_dwordx4 v161, s[12:15], s52 offen offset:1024 lds
    s_waitcnt vmcnt(22) lgkmcnt(4)
    v_mfma_f32_32x32x16_bf16 v[0:15], a[240:243], a[48:51], v[0:15]
    s_mul_i32 s52, s72, 49152
    s_add_u32 s52, s52, 1081344
    s_add_u32 m0, s56, 147456
    s_nop 0
    buffer_load_dwordx4 v160, s[12:15], s52 offen lds
    ds_read_b64_tr_b16 a[224:225], v164 offset:0
    ds_read_b64_tr_b16 a[226:227], v164 offset:512
    v_mfma_f32_32x32x16_bf16 v[16:31], a[240:243], a[52:55], v[16:31]
    buffer_load_dwordx4 v161, s[12:15], s52 offen offset:1024 lds
    ds_read_b64_tr_b16 a[228:229], v165 offset:0
    s_mul_i32 s52, s73, 49152
    s_add_u32 s52, s52, 1048576
    s_add_u32 m0, s56, 149504
    v_mfma_f32_32x32x16_bf16 v[32:47], a[244:247], a[48:51], v[32:47]
    buffer_load_dwordx4 v160, s[12:15], s52 offen lds
    buffer_load_dwordx4 v161, s[12:15], s52 offen offset:1024 lds
    ds_read_b64_tr_b16 a[230:231], v165 offset:512
    v_mfma_f32_32x32x16_bf16 v[48:63], a[244:247], a[52:55], v[48:63]
    s_mov_b64 exec, 15
    buffer_load_dword v249, v248, s[24:27], s61 offen sc1
    s_mov_b64 exec, -1
    s_waitcnt vmcnt(25) lgkmcnt(4)
    v_mfma_f32_32x32x16_bf16 v[0:15], a[248:251], a[56:59], v[0:15]
    s_mul_i32 s52, s73, 49152
    s_add_u32 s52, s52, 1064960
    s_add_u32 m0, s56, 49152
    s_nop 0
    buffer_load_dwordx4 v160, s[12:15], s52 offen lds
    ds_read_b64_tr_b16 a[232:233], v164 offset:2048
    ds_read_b64_tr_b16 a[234:235], v164 offset:2560
    v_mfma_f32_32x32x16_bf16 v[16:31], a[248:251], a[60:63], v[16:31]
    buffer_load_dwordx4 v161, s[12:15], s52 offen offset:1024 lds
    ds_read_b64_tr_b16 a[236:237], v165 offset:2048
    s_mul_i32 s52, s73, 49152
    s_add_u32 s52, s52, 1081344
    s_add_u32 m0, s56, 51200
    v_mfma_f32_32x32x16_bf16 v[32:47], a[252:255], a[56:59], v[32:47]
    buffer_load_dwordx4 v160, s[12:15], s52 offen lds
    ds_read_b64_tr_b16 a[238:239], v165 offset:2560
    v_mfma_f32_32x32x16_bf16 v[48:63], a[252:255], a[60:63], v[48:63]
    buffer_load_dwordx4 v161, s[12:15], s52 offen offset:1024 lds
    s_waitcnt vmcnt(27) lgkmcnt(4)
    v_mfma_f32_32x32x16_bf16 v[0:15], a[224:227], a[64:67], v[0:15]
    s_mul_i32 s52, s74, 49152
    s_add_u32 s52, s52, 1048576
    s_add_u32 m0, s56, 114688
    s_nop 0
    buffer_load_dwordx4 v160, s[12:15], s52 offen lds
    ds_read_b64_tr_b16 a[240:241], v162 offset:16384
    ds_read_b64_tr_b16 a[242:243], v162 offset:16896
    v_mfma_f32_32x32x16_bf16 v[16:31], a[224:227], a[68:71], v[16:31]
    buffer_load_dwordx4 v161, s[12:15], s52 offen offset:1024 lds
    ds_read_b64_tr_b16 a[244:245], v163 offset:16384
    s_mul_i32 s52, s74, 49152
    s_add_u32 s52, s52, 1064960
    s_add_u32 m0, s56, 116736
    v_mfma_f32_32x32x16_bf16 v[32:47], a[228:231], a[64:67], v[32:47]
    buffer_load_dwordx4 v160, s[12:15], s52 offen lds
    ds_read_b64_tr_b16 a[246:247], v163 offset:16896
    v_mfma_f32_32x32x16_bf16 v[48:63], a[228:231], a[68:71], v[48:63]
    buffer_load_dwordx4 v161, s[12:15], s52 offen offset:1024 lds
    s_waitcnt vmcnt(29) lgkmcnt(4)
    v_mfma_f32_32x32x16_bf16 v[0:15], a[232:235], a[72:75], v[0:15]
    s_mul_i32 s52, s74, 49152
    s_add_u32 s52, s52, 1081344
    s_add_u32 m0, s56, 131072
    s_nop 0
    buffer_load_dwordx4 v160, s[12:15], s52 offen lds
    ds_read_b64_tr_b16 a[248:249], v162 offset:18432
    ds_read_b64_tr_b16 a[250:251], v162 offset:18944
    v_mfma_f32_32x32x16_bf16 v[16:31], a[232:235], a[76:79], v[16:31]
    buffer_load_dwordx4 v161, s[12:15], s52 offen offset:1024 lds
    ds_read_b64_tr_b16 a[252:253], v163 offset:18432
    s_mul_i32 s52, s75, 49152
    s_add_u32 s52, s52, 1048576
    s_add_u32 m0, s56, 133120
    v_mfma_f32_32x32x16_bf16 v[32:47], a[236:239], a[72:75], v[32:47]
    buffer_load_dwordx4 v160, s[12:15], s52 offen lds
    ds_read_b64_tr_b16 a[254:255], v163 offset:18944
    v_mfma_f32_32x32x16_bf16 v[48:63], a[236:239], a[76:79], v[48:63]
    buffer_load_dwordx4 v161, s[12:15], s52 offen offset:1024 lds
    s_waitcnt vmcnt(31) lgkmcnt(4)
    s_mov_b64 exec, 0xf
    s_mov_b32 s3, 0
    s_branch CHK_4
POLL_4:
    s_waitcnt vmcnt(12)
    buffer_load_dword v249, v248, s[24:27], s61 offen sc1
    s_waitcnt vmcnt(0)
CHK_4:
    s_add_u32 s3, s3, 1
    s_waitcnt vmcnt(12)
    v_cmp_eq_u32_e64 vcc, 0, v249
    s_cmp_gt_u32 s3, 0x8000
    s_cbranch_scc1 POLLED_4
    s_nop 2
    s_cbranch_vccz POLLED_4
    s_sleep 4
    s_branch POLL_4
POLLED_4:
    s_mov_b64 exec, -1
    v_mfma_f32_32x32x16_bf16 v[0:15], a[240:243], a[80:83], v[0:15]
    s_mul_i32 s76, s72, 3072
    s_add_u32 s76, s76, s57
    s_nop 0
    s_add_u32 s76, s76, 65536
    buffer_load_dwordx4 a[128:131], v216, s[24:27], s76 offen offset:0 sc1
    ds_read_b64_tr_b16 a[224:225], v162 offset:32768
    ds_read_b64_tr_b16 a[226:227], v162 offset:33280
    v_mfma_f32_32x32x16_bf16 v[16:31], a[240:243], a[84:87], v[16:31]
    buffer_load_dwordx4 a[132:135], v168, s[24:27], s76 offen offset:0 sc1
    ds_read_b64_tr_b16 a[228:229], v163 offset:32768
    v_mfma_f32_32x32x16_bf16 v[32:47], a[244:247], a[80:83], v[32:47]
    buffer_load_dwordx4 a[136:139], v216, s[24:27], s76 offen offset:1024 sc1
    ds_read_b64_tr_b16 a[230:231], v163 offset:33280
    v_mfma_f32_32x32x16_bf16 v[48:63], a[244:247], a[84:87], v[48:63]
    buffer_load_dwordx4 a[140:143], v168, s[24:27], s76 offen offset:1024 sc1
    s_waitcnt lgkmcnt(4)
    s_nop 0
    v_mfma_f32_32x32x16_bf16 v[0:15], a[248:251], a[88:91], v[0:15]
    buffer_load_dwordx4 a[144:147], v216, s[24:27], s76 offen offset:2048 sc1
    buffer_load_dwordx4 a[148:151], v168, s[24:27], s76 offen offset:2048 sc1
    ds_read_b64_tr_b16 a[232:233], v162 offset:34816
    ds_read_b64_tr_b16 a[234:235], v162 offset:35328
    v_mfma_f32_32x32x16_bf16 v[16:31], a[248:251], a[92:95], v[16:31]
    ds_read_b64_tr_b16 a[236:237], v163 offset:34816
    s_mul_i32 s77, s73, 3072
    s_add_u32 s77, s77, s57
    s_add_u32 s77, s77, 65536
    v_mfma_f32_32x32x16_bf16 v[32:47], a[252:255], a[88:91], v[32:47]
    buffer_load_dwordx4 a[152:155], v216, s[24:27], s77 offen offset:0 sc1
    ds_read_b64_tr_b16 a[238:239], v163 offset:35328
    v_mfma_f32_32x32x16_bf16 v[48:63], a[252:255], a[92:95], v[48:63]
    buffer_load_dwordx4 a[156:159], v168, s[24:27], s77 offen offset:0 sc1
    s_waitcnt lgkmcnt(4)
    v_mfma_f32_32x32x16_bf16 v[0:15], a[224:227], a[96:99], v[0:15]
    buffer_load_dwordx4 a[160:163], v216, s[24:27], s77 offen offset:1024 sc1
    buffer_load_dwordx4 a[164:167], v168, s[24:27], s77 offen offset:1024 sc1
    ds_read_b64_tr_b16 a[240:241], v164 offset:16384
    ds_read_b64_tr_b16 a[242:243], v164 offset:16896
    v_mfma_f32_32x32x16_bf16 v[16:31], a[224:227], a[100:103], v[16:31]
    buffer_load_dwordx4 a[168:171], v216, s[24:27], s77 offen offset:2048 sc1
    ds_read_b64_tr_b16 a[244:245], v165 offset:16384
    v_mfma_f32_32x32x16_bf16 v[32:47], a[228:231], a[96:99], v[32:47]
    buffer_load_dwordx4 a[172:175], v168, s[24:27], s77 offen offset:2048 sc1
    ds_read_b64_tr_b16 a[246:247], v165 offset:16896
    v_mfma_f32_32x32x16_bf16 v[48:63], a[228:231], a[100:103], v[48:63]
    s_waitcnt lgkmcnt(4)
    v_mfma_f32_32x32x16_bf16 v[0:15], a[232:235], a[104:107], v[0:15]
    s_mul_i32 s78, s74, 3072
    s_add_u32 s78, s78, s57
    s_add_u32 s78, s78, 65536
    buffer_load_dwordx4 a[176:179], v216, s[24:27], s78 offen offset:0 sc1
    ds_read_b64_tr_b16 a[248:249], v164 offset:18432
    ds_read_b64_tr_b16 a[250:251], v164 offset:18944
    v_mfma_f32_32x32x16_bf16 v[16:31], a[232:235], a[108:111], v[16:31]
    buffer_load_dwordx4 a[180:183], v168, s[24:27], s78 offen offset:0 sc1
    ds_read_b64_tr_b16 a[252:253], v165 offset:18432
    v_mfma_f32_32x32x16_bf16 v[32:47], a[236:239], a[104:107], v[32:47]
    buffer_load_dwordx4 a[184:187], v216, s[24:27], s78 offen offset:1024 sc1
    ds_read_b64_tr_b16 a[254:255], v165 offset:18944
    v_mfma_f32_32x32x16_bf16 v[48:63], a[236:239], a[108:111], v[48:63]
    buffer_load_dwordx4 a[188:191], v168, s[24:27], s78 offen offset:1024 sc1
    s_waitcnt lgkmcnt(4)
    s_nop 0
    v_mfma_f32_32x32x16_bf16 v[0:15], a[240:243], a[112:115], v[0:15]
    buffer_load_dwordx4 a[192:195], v216, s[24:27], s78 offen offset:2048 sc1
    buffer_load_dwordx4 a[196:199], v168, s[24:27], s78 offen offset:2048 sc1
    ds_read_b64_tr_b16 a[224:225], v164 offset:32768
    ds_read_b64_tr_b16 a[226:227], v164 offset:33280
    v_mfma_f32_32x32x16_bf16 v[16:31], a[240:243], a[116:119], v[16:31]
    ds_read_b64_tr_b16 a[228:229], v165 offset:32768
    s_mul_i32 s79, s75, 3072
    s_add_u32 s79, s79, s57
    s_add_u32 s79, s79, 65536
    v_mfma_f32_32x32x16_bf16 v[32:47], a[244:247], a[112:115], v[32:47]
    buffer_load_dwordx4 a[200:203], v216, s[24:27], s79 offen offset:0 sc1
    ds_read_b64_tr_b16 a[230:231], v165 offset:33280
    v_mfma_f32_32x32x16_bf16 v[48:63], a[244:247], a[116:119], v[48:63]
    buffer_load_dwordx4 a[204:207], v168, s[24:27], s79 offen offset:0 sc1
    s_waitcnt lgkmcnt(4)
    v_mfma_f32_32x32x16_bf16 v[0:15], a[248:251], a[120:123], v[0:15]
    buffer_load_dwordx4 a[208:211], v216, s[24:27], s79 offen offset:1024 sc1
    buffer_load_dwordx4 a[212:215], v168, s[24:27], s79 offen offset:1024 sc1
    ds_read_b64_tr_b16 a[232:233], v164 offset:34816
    ds_read_b64_tr_b16 a[234:235], v164 offset:35328
    v_mfma_f32_32x32x16_bf16 v[16:31], a[248:251], a[124:127], v[16:31]
    buffer_load_dwordx4 a[216:219], v216, s[24:27], s79 offen offset:2048 sc1
    ds_read_b64_tr_b16 a[236:237], v165 offset:34816
    v_mfma_f32_32x32x16_bf16 v[32:47], a[252:255], a[120:123], v[32:47]
    buffer_load_dwordx4 a[220:223], v168, s[24:27], s79 offen offset:2048 sc1
    ds_read_b64_tr_b16 a[238:239], v165 offset:35328
    v_mfma_f32_32x32x16_bf16 v[48:63], a[252:255], a[124:127], v[48:63]
    s_waitcnt vmcnt(22) lgkmcnt(4)
    v_mfma_f32_32x32x16_bf16 v[0:15], a[224:227], a[128:131], v[0:15]
    s_mul_i32 s52, s75, 49152
    s_add_u32 s52, s52, 1064960
    s_add_u32 m0, s56, 0
    s_nop 0
    s_nop 0
    buffer_load_dwordx4 v160, s[12:15], s52 offen lds
    ds_read_b64_tr_b16 a[240:241], v166 offset:16384
    ds_read_b64_tr_b16 a[242:243], v166 offset:16896
    v_mfma_f32_32x32x16_bf16 v[16:31], a[224:227], a[132:135], v[16:31]
    buffer_load_dwordx4 v161, s[12:15], s52 offen offset:1024 lds
    ds_read_b64_tr_b16 a[244:245], v167 offset:16384
    s_mul_i32 s52, s75, 49152
    s_add_u32 s52, s52, 1081344
    s_add_u32 m0, s56, 2048
    v_mfma_f32_32x32x16_bf16 v[32:47], a[228:231], a[128:131], v[32:47]
    buffer_load_dwordx4 v160, s[12:15], s52 offen lds
    ds_read_b64_tr_b16 a[246:247], v167 offset:16896
    v_mfma_f32_32x32x16_bf16 v[48:63], a[228:231], a[132:135], v[48:63]
    buffer_load_dwordx4 v161, s[12:15], s52 offen offset:1024 lds
    s_waitcnt vmcnt(24) lgkmcnt(4)
    s_nop 0
    v_mfma_f32_32x32x16_bf16 v[0:15], a[232:235], a[136:139], v[0:15]
    ds_read_b64_tr_b16 a[248:249], v166 offset:18432
    ds_read_b64_tr_b16 a[250:251], v166 offset:18944
    v_mfma_f32_32x32x16_bf16 v[16:31], a[232:235], a[140:143], v[16:31]
    ds_read_b64_tr_b16 a[252:253], v167 offset:18432
    v_mfma_f32_32x32x16_bf16 v[32:47], a[236:239], a[136:139], v[32:47]
    ds_read_b64_tr_b16 a[254:255], v167 offset:18944
    v_mfma_f32_32x32x16_bf16 v[48:63], a[236:239], a[140:143], v[48:63]
    s_waitcnt vmcnt(22) lgkmcnt(4)
    s_nop 0
    v_mfma_f32_32x32x16_bf16 v[0:15], a[240:243], a[144:147], v[0:15]
    ds_read_b64_tr_b16 a[224:225], v162 offset:49152
    ds_read_b64_tr_b16 a[226:227], v162 offset:49664
    v_mfma_f32_32x32x16_bf16 v[16:31], a[240:243], a[148:151], v[16:31]
    ds_read_b64_tr_b16 a[228:229], v163 offset:49152
    v_mfma_f32_32x32x16_bf16 v[32:47], a[244:247], a[144:147], v[32:47]
    ds_read_b64_tr_b16 a[230:231], v163 offset:49664
    v_mfma_f32_32x32x16_bf16 v[48:63], a[244:247], a[148:151], v[48:63]
    s_waitcnt vmcnt(20) lgkmcnt(4)
    s_nop 0
    v_mfma_f32_32x32x16_bf16 v[0:15], a[248:251], a[152:155], v[0:15]
    ds_read_b64_tr_b16 a[232:233], v162 offset:51200
    ds_read_b64_tr_b16 a[234:235], v162 offset:51712
    v_mfma_f32_32x32x16_bf16 v[16:31], a[248:251], a[156:159], v[16:31]
    ds_read_b64_tr_b16 a[236:237], v163 offset:51200
    v_mfma_f32_32x32x16_bf16 v[32:47], a[252:255], a[152:155], v[32:47]
    ds_read_b64_tr_b16 a[238:239], v163 offset:51712
    v_mfma_f32_32x32x16_bf16 v[48:63], a[252:255], a[156:159], v[48:63]
    s_waitcnt vmcnt(18) lgkmcnt(4)
    s_nop 0
    v_mfma_f32_32x32x16_bf16 v[0:15], a[224:227], a[160:163], v[0:15]
    buffer_load_dwordx4 v[176:179], v216, s[24:27], s65 offen offset:0 sc1
    buffer_load_dwordx4 v[180:183], v216, s[24:27], s65 offen offset:1024 sc1
    ds_read_b64_tr_b16 a[240:241], v164 offset:49152
    ds_read_b64_tr_b16 a[242:243], v164 offset:49664
    v_mfma_f32_32x32x16_bf16 v[16:31], a[224:227], a[164:167], v[16:31]
    buffer_load_dwordx4 v[184:187], v170, s[24:27], s55 offen offset:0 sc1
    buffer_load_dwordx4 v[188:191], v170, s[24:27], s55 offen offset:16 sc1
    ds_read_b64_tr_b16 a[244:245], v165 offset:49152
    v_mfma_f32_32x32x16_bf16 v[32:47], a[228:231], a[160:163], v[32:47]
    buffer_load_dwordx4 v[192:195], v170, s[24:27], s55 offen offset:64 sc1
    ds_read_b64_tr_b16 a[246:247], v165 offset:49664
    v_mfma_f32_32x32x16_bf16 v[48:63], a[228:231], a[164:167], v[48:63]
    buffer_load_dwordx4 v[196:199], v170, s[24:27], s55 offen offset:80 sc1
    s_waitcnt vmcnt(22) lgkmcnt(4)
    s_nop 0
    v_mfma_f32_32x32x16_bf16 v[0:15], a[232:235], a[168:171], v[0:15]
    ds_read_b64_tr_b16 a[248:249], v164 offset:51200
    ds_read_b64_tr_b16 a[250:251], v164 offset:51712
    v_mfma_f32_32x32x16_bf16 v[16:31], a[232:235], a[172:175], v[16:31]
    ds_read_b64_tr_b16 a[252:253], v165 offset:51200
    v_mfma_f32_32x32x16_bf16 v[32:47], a[236:239], a[168:171], v[32:47]
    ds_read_b64_tr_b16 a[254:255], v165 offset:51712
    v_mfma_f32_32x32x16_bf16 v[48:63], a[236:239], a[172:175], v[48:63]
    s_waitcnt vmcnt(20) lgkmcnt(4)
    s_nop 0
    v_mfma_f32_32x32x16_bf16 v[0:15], a[240:243], a[176:179], v[0:15]
    ds_read_b64_tr_b16 a[224:225], v166 offset:0
    ds_read_b64_tr_b16 a[226:227], v166 offset:512
    v_mfma_f32_32x32x16_bf16 v[16:31], a[240:243], a[180:183], v[16:31]
    ds_read_b64_tr_b16 a[228:229], v167 offset:0
    v_mfma_f32_32x32x16_bf16 v[32:47], a[244:247], a[176:179], v[32:47]
    ds_read_b64_tr_b16 a[230:231], v167 offset:512
    v_mfma_f32_32x32x16_bf16 v[48:63], a[244:247], a[180:183], v[48:63]
    s_waitcnt vmcnt(18) lgkmcnt(4)
    s_nop 0
    v_mfma_f32_32x32x16_bf16 v[0:15], a[248:251], a[184:187], v[0:15]
    ds_read_b64_tr_b16 a[232:233], v166 offset:2048
    ds_read_b64_tr_b16 a[234:235], v166 offset:2560
    v_mfma_f32_32x32x16_bf16 v[16:31], a[248:251], a[188:191], v[16:31]
    ds_read_b64_tr_b16 a[236:237], v167 offset:2048
    v_mfma_f32_32x32x16_bf16 v[32:47], a[252:255], a[184:187], v[32:47]
    ds_read_b64_tr_b16 a[238:239], v167 offset:2560
    v_mfma_f32_32x32x16_bf16 v[48:63], a[252:255], a[188:191], v[48:63]
    s_waitcnt vmcnt(16) lgkmcnt(4)
    s_waitcnt vmcnt(8)
    ds_read_b64_tr_b16 a[240:241], v162 offset:0
    ds_read_b64_tr_b16 a[242:243], v162 offset:512
    v_mfma_f32_32x32x16_bf16 v[0:15], a[224:227], a[192:195], v[0:15]
    s_waitcnt vmcnt(6)
    ds_read_b64_tr_b16 a[248:249], v162 offset:2048
    ds_read_b64_tr_b16 a[250:251], v162 offset:2560
    s_waitcnt lgkmcnt(6)
    v_mfma_f32_32x32x16_bf16 v[0:15], a[232:235], a[200:203], v[0:15]
    ds_read_b64_tr_b16 a[244:245], v163 offset:0
    ds_read_b64_tr_b16 a[246:247], v163 offset:512
    s_waitcnt lgkmcnt(4)
    v_mfma_f32_32x32x16_bf16 v[0:15], a[240:243], a[208:211], v[0:15]
    ds_read_b64_tr_b16 a[252:253], v163 offset:2048
    s_waitcnt lgkmcnt(3)
    v_mfma_f32_32x32x16_bf16 v[0:15], a[248:251], a[216:219], v[0:15]
    ds_read_b64_tr_b16 a[254:255], v163 offset:2560
    v_mfma_f32_32x32x16_bf16 v[16:31], a[224:227], a[196:199], v[16:31]
    v_mfma_f32_32x32x16_bf16 v[16:31], a[232:235], a[204:207], v[16:31]
    v_mfma_f32_32x32x16_bf16 v[16:31], a[240:243], a[212:215], v[16:31]
    s_nop 7
    s_nop 0
    ds_write_b128 v173, v[0:3] offset:0
    v_mfma_f32_32x32x16_bf16 v[16:31], a[248:251], a[220:223], v[16:31]
    ds_write_b128 v173, v[4:7] offset:1024
STUB12:
    s_cbranch_execz WARM_RET
    s_nop 0
    v_mfma_f32_32x32x16_bf16 v[32:47], a[228:231], a[192:195], v[32:47]
    ds_write_b128 v173, v[8:11] offset:2048
    v_mfma_f32_32x32x16_bf16 v[32:47], a[236:239], a[200:203], v[32:47]
    ds_write_b128 v173, v[12:15] offset:3072
    s_waitcnt lgkmcnt(6)
    v_mfma_f32_32x32x16_bf16 v[32:47], a[244:247], a[208:211], v[32:47]
    s_nop 4
    ds_write_b128 v173, v[16:19] offset:16384
    s_waitcnt lgkmcnt(5)
    s_nop 0
    v_mfma_f32_32x32x16_bf16 v[32:47], a[252:255], a[216:219], v[32:47]
    ds_write_b128 v173, v[20:23] offset:17408
    v_mfma_f32_32x32x16_bf16 v[48:63], a[228:231], a[196:199], v[48:63]
    ds_write_b128 v173, v[24:27] offset:18432
    v_mfma_f32_32x32x16_bf16 v[48:63], a[236:239], a[204:207], v[48:63]
    ds_write_b128 v173, v[28:31] offset:19456
    v_mfma_f32_32x32x16_bf16 v[48:63], a[244:247], a[212:215], v[48:63]
    s_nop 5
    ds_write_b128 v173, v[32:35] offset:32768
    v_mfma_f32_32x32x16_bf16 v[48:63], a[252:255], a[220:223], v[48:63]
    ds_write_b128 v173, v[36:39] offset:33792
    ds_write_b128 v173, v[40:43] offset:34816
    ds_write_b128 v173, v[44:47] offset:35840
    s_waitcnt vmcnt(5)
    v_lshlrev_b32 v128, 16, v176
    v_and_b32 v129, s67, v176
    v_lshlrev_b32 v130, 16, v177
    v_and_b32 v131, s67, v177
    v_lshlrev_b32 v132, 16, v178
    v_and_b32 v133, s67, v178
    v_lshlrev_b32 v134, 16, v179
    v_and_b32 v135, s67, v179
    s_waitcnt vmcnt(4)
    v_lshlrev_b32 v136, 16, v180
    v_and_b32 v137, s67, v180
    v_lshlrev_b32 v138, 16, v181
    v_and_b32 v139, s67, v181
    v_lshlrev_b32 v140, 16, v182
    v_and_b32 v141, s67, v182
    v_lshlrev_b32 v142, 16, v183
    v_and_b32 v143, s67, v183
    v_and_b32 v172, 31, v220
    v_lshlrev_b32_e64 v172, 10, v172
    v_lshl_add_u32 v172, v243, 4, v172
    s_lshl_b32 s54, s28, 14
    s_add_u32 s54, s54, 0x10000
    v_add_u32 v174, s54, v216
    ds_write_b128 v173, v[48:51] offset:49152
    ds_write_b128 v173, v[52:55] offset:50176
    ds_write_b128 v173, v[56:59] offset:51200
    ds_write_b128 v173, v[60:63] offset:52224
    s_lshl_b32 s54, s63, 15
    s_lshl_b32 s55, s64, 4
    s_add_u32 s54, s54, s55
    s_waitcnt lgkmcnt(0)
    s_barrier
    s_nop 0
    ds_read_b128 v[64:67], v174 offset:0
    ds_read_b128 v[80:83], v174 offset:4096
    ds_read_b128 v[96:99], v174 offset:8192
    ds_read_b128 v[112:115], v174 offset:12288
    ds_read_b128 v[68:71], v174 offset:1024
    ds_read_b128 v[84:87], v174 offset:5120
    ds_read_b128 v[100:103], v174 offset:9216
    ds_read_b128 v[116:119], v174 offset:13312
    ds_read_b128 v[72:75], v174 offset:2048
    ds_read_b128 v[88:91], v174 offset:6144
    ds_read_b128 v[104:107], v174 offset:10240
    ds_read_b128 v[120:123], v174 offset:14336
    ds_read_b128 v[76:79], v174 offset:3072
    ds_read_b128 v[92:95], v174 offset:7168
    ds_read_b128 v[108:111], v174 offset:11264
    ds_read_b128 v[124:127], v174 offset:15360
    s_waitcnt lgkmcnt(14)
    v_pk_add_f32 v[64:65], v[64:65], v[80:81]
    s_waitcnt lgkmcnt(12)
    v_pk_add_f32 v[96:97], v[96:97], v[112:113]
    v_pk_add_f32 v[66:67], v[66:67], v[82:83]
    v_pk_add_f32 v[98:99], v[98:99], v[114:115]
    s_waitcnt lgkmcnt(10)
    v_pk_add_f32 v[68:69], v[68:69], v[84:85]
    s_waitcnt lgkmcnt(8)
    v_pk_add_f32 v[100:101], v[100:101], v[116:117]
    v_pk_add_f32 v[70:71], v[70:71], v[86:87]
    v_pk_add_f32 v[102:103], v[102:103], v[118:119]
    v_pk_add_f32 v[64:65], v[64:65], v[96:97]
    v_pk_add_f32 v[66:67], v[66:67], v[98:99]
    v_pk_add_f32 v[68:69], v[68:69], v[100:101]
    v_pk_add_f32 v[70:71], v[70:71], v[102:103]
    s_waitcnt vmcnt(3)
    v_pk_fma_f32 v[64:65], v[64:65], v[184:185], v[128:129]
    v_pk_fma_f32 v[66:67], v[66:67], v[186:187], v[130:131]
    s_waitcnt vmcnt(2)
    v_pk_fma_f32 v[68:69], v[68:69], v[188:189], v[132:133]
    v_pk_fma_f32 v[70:71], v[70:71], v[190:191], v[134:135]
    v_cvt_pk_bf16_f32 v144, v64, v65
    v_cvt_pk_bf16_f32 v145, v66, v67
    v_cvt_pk_bf16_f32 v146, v68, v69
    v_cvt_pk_bf16_f32 v147, v70, v71
    buffer_store_dwordx4 v[144:147], v172, s[16:19], s54 offen offset:0 sc1
    s_waitcnt lgkmcnt(6)
    v_pk_add_f32 v[72:73], v[72:73], v[88:89]
    s_waitcnt lgkmcnt(4)
    v_pk_add_f32 v[104:105], v[104:105], v[120:121]
    v_pk_add_f32 v[74:75], v[74:75], v[90:91]
    v_pk_add_f32 v[106:107], v[106:107], v[122:123]
    s_waitcnt lgkmcnt(2)
    v_pk_add_f32 v[76:77], v[76:77], v[92:93]
    s_waitcnt lgkmcnt(0)
    v_pk_add_f32 v[108:109], v[108:109], v[124:125]
    v_pk_add_f32 v[78:79], v[78:79], v[94:95]
    v_pk_add_f32 v[110:111], v[110:111], v[126:127]
    v_pk_add_f32 v[72:73], v[72:73], v[104:105]
    v_pk_add_f32 v[74:75], v[74:75], v[106:107]
    v_pk_add_f32 v[76:77], v[76:77], v[108:109]
    v_pk_add_f32 v[78:79], v[78:79], v[110:111]
    s_waitcnt vmcnt(2)
    v_pk_fma_f32 v[72:73], v[72:73], v[192:193], v[136:137]
    v_pk_fma_f32 v[74:75], v[74:75], v[194:195], v[138:139]
    s_waitcnt vmcnt(1)
    v_pk_fma_f32 v[76:77], v[76:77], v[196:197], v[140:141]
    v_pk_fma_f32 v[78:79], v[78:79], v[198:199], v[142:143]
    v_cvt_pk_bf16_f32 v148, v72, v73
    v_cvt_pk_bf16_f32 v149, v74, v75
    v_cvt_pk_bf16_f32 v150, v76, v77
    v_cvt_pk_bf16_f32 v151, v78, v79
    buffer_store_dwordx4 v[148:151], v172, s[16:19], s54 offen offset:32 sc1
END_attn:
    s_endpgm
FALLBACK:
    s_waitcnt vmcnt(0) lgkmcnt(0)
    s_barrier
    s_mov_b32 s39, 1
    s_nop 15
    s_branch RESTART
FB_MAX:
    s_waitcnt vmcnt(0) lgkmcnt(0)
    s_barrier
    v_mov_b32 v240, 0xff800000
    v_mov_b32 v241, 0xff800000
    s_mov_b32 s35, 0
LOOP_adaLN_cond___2:
    s_add_u32 m0, s52, 0
    s_nop 0
    buffer_load_dwordx4 v212, s[12:15], s36 offen lds
    buffer_load_dwordx4 v213, s[12:15], s36 offen offset:1024 lds
    s_add_u32 s36, s36, 8192
    s_and_b32 s36, s36, 0x1ffff
    s_waitcnt vmcnt(0)
    s_barrier
    s_nop 0
    ds_read_b128 a[128:131], v192 offset:0
    ds_read_b128 a[132:135], v193 offset:0
    ds_read_b128 a[136:139], v194 offset:0
    ds_read_b128 a[140:143], v195 offset:0
    ds_read_b128 a[144:147], v196 offset:0
    ds_read_b128 a[148:151], v197 offset:0
    ds_read_b128 a[152:155], v198 offset:0
    ds_read_b128 a[156:159], v199 offset:0
    s_waitcnt lgkmcnt(7)
    v_mfma_f32_32x32x16_bf16 v[0:15], a[128:131], v[128:131], 0
    v_mfma_f32_32x32x16_bf16 v[16:31], a[128:131], v[132:135], 0
    s_waitcnt lgkmcnt(6)
    v_mfma_f32_32x32x16_bf16 v[0:15], a[132:135], v[136:139], v[0:15]
    v_mfma_f32_32x32x16_bf16 v[16:31], a[132:135], v[140:143], v[16:31]
    s_waitcnt lgkmcnt(5)
    v_mfma_f32_32x32x16_bf16 v[0:15], a[136:139], v[144:147], v[0:15]
    v_mfma_f32_32x32x16_bf16 v[16:31], a[136:139], v[148:151], v[16:31]
    s_waitcnt lgkmcnt(4)
    v_mfma_f32_32x32x16_bf16 v[0:15], a[140:143], v[152:155], v[0:15]
    v_mfma_f32_32x32x16_bf16 v[16:31], a[140:143], v[156:159], v[16:31]
    s_waitcnt lgkmcnt(3)
    v_mfma_f32_32x32x16_bf16 v[0:15], a[144:147], v[160:163], v[0:15]
    v_mfma_f32_32x32x16_bf16 v[16:31], a[144:147], v[164:167], v[16:31]
    s_waitcnt lgkmcnt(2)
    v_mfma_f32_32x32x16_bf16 v[0:15], a[148:151], v[168:171], v[0:15]
    v_mfma_f32_32x32x16_bf16 v[16:31], a[148:151], v[172:175], v[16:31]
    s_waitcnt lgkmcnt(1)
    v_mfma_f32_32x32x16_bf16 v[0:15], a[152:155], v[176:179], v[0:15]
    v_mfma_f32_32x32x16_bf16 v[16:31], a[152:155], v[180:183], v[16:31]
    s_waitcnt lgkmcnt(0)
    v_mfma_f32_32x32x16_bf16 v[0:15], a[156:159], v[184:187], v[0:15]
    v_mfma_f32_32x32x16_bf16 v[16:31], a[156:159], v[188:191], v[16:31]
    s_nop 10
    s_nop 0
    v_max3_f32 v236, v0, v1, v2
    v_max3_f32 v237, v16, v17, v18
    v_max3_f32 v236, v236, v3, v4
    v_max3_f32 v237, v237, v19, v20
    v_max3_f32 v236, v236, v5, v6
    v_max3_f32 v237, v237, v21, v22
    v_max3_f32 v236, v236, v7, v8
    v_max3_f32 v237, v237, v23, v24
    v_max3_f32 v236, v236, v9, v10
    v_max3_f32 v237, v237, v25, v26
    v_max3_f32 v236, v236, v11, v12
    v_max3_f32 v237, v237, v27, v28
    v_max3_f32 v236, v236, v13, v14
    v_max3_f32 v237, v237, v29, v30
    v_max_f32 v236, v236, v15
    v_max_f32 v237, v237, v31
    v_max_f32 v240, v240, v236
    v_max_f32 v241, v241, v237
    s_barrier
    s_add_u32 s35, s35, 1
    s_cmp_lt_u32 s35, 16
    s_cbranch_scc1 LOOP_adaLN_cond___2
    v_mov_b32 v238, v240
    v_mov_b32 v239, v241
    s_nop 0
    v_permlane32_swap_b32 v240, v238
    v_permlane32_swap_b32 v241, v239
    v_max_f32 v240, v240, v238
    v_max_f32 v241, v241, v239
    v_sub_f32 v240, 0, v240
    v_sub_f32_e64 v241, 0, v241
    s_add_u32 m0, s52, 24576
    s_nop 0
    buffer_load_dwordx4 v212, s[12:15], s36 offen lds
    buffer_load_dwordx4 v213, s[12:15], s36 offen offset:1024 lds
    s_add_u32 m0, s52, 0
    s_nop 0
    buffer_load_dwordx4 v212, s[12:15], s37 offen lds
    buffer_load_dwordx4 v213, s[12:15], s37 offen offset:1024 lds
    s_add_u32 m0, s52, 8192
    s_nop 0
    buffer_load_dwordx4 v212, s[12:15], s38 offen lds
    buffer_load_dwordx4 v213, s[12:15], s38 offen offset:1024 lds
    s_waitcnt vmcnt(0) lgkmcnt(0)
    s_barrier
    ds_read_b128 a[128:131], v192 offset:24576
    ds_read_b128 a[132:135], v193 offset:24576
    ds_read_b128 a[136:139], v194 offset:24576
    ds_read_b128 a[140:143], v195 offset:24576
    s_waitcnt lgkmcnt(0)
    s_nop 0
    v_mfma_f32_32x32x16_bf16 v[0:15], a[128:131], v[128:131], 0
    ds_read_b128 a[144:147], v196 offset:24576
    v_mfma_f32_32x32x16_bf16 v[16:31], a[128:131], v[132:135], 0
    ds_read_b128 a[148:151], v197 offset:24576
    v_mfma_f32_32x32x16_bf16 v[0:15], a[132:135], v[136:139], v[0:15]
    ds_read_b128 a[152:155], v198 offset:24576
    v_mfma_f32_32x32x16_bf16 v[16:31], a[132:135], v[140:143], v[16:31]
    ds_read_b128 a[156:159], v199 offset:24576
    v_mfma_f32_32x32x16_bf16 v[0:15], a[136:139], v[144:147], v[0:15]
    v_mfma_f32_32x32x16_bf16 v[16:31], a[136:139], v[148:151], v[16:31]
    v_mfma_f32_32x32x16_bf16 v[0:15], a[140:143], v[152:155], v[0:15]
    v_mfma_f32_32x32x16_bf16 v[16:31], a[140:143], v[156:159], v[16:31]
    s_waitcnt lgkmcnt(0)
    s_nop 0
    v_mfma_f32_32x32x16_bf16 v[0:15], a[144:147], v[160:163], v[0:15]
    ds_read_b128 a[128:131], v192 offset:0
    v_mfma_f32_32x32x16_bf16 v[16:31], a[144:147], v[164:167], v[16:31]
    ds_read_b128 a[132:135], v193 offset:0
    v_mfma_f32_32x32x16_bf16 v[0:15], a[148:151], v[168:171], v[0:15]
    ds_read_b128 a[136:139], v194 offset:0
    v_mfma_f32_32x32x16_bf16 v[16:31], a[148:151], v[172:175], v[16:31]
    ds_read_b128 a[140:143], v195 offset:0
    v_mfma_f32_32x32x16_bf16 v[0:15], a[152:155], v[176:179], v[0:15]
    v_mfma_f32_32x32x16_bf16 v[16:31], a[152:155], v[180:183], v[16:31]
    v_mfma_f32_32x32x16_bf16 v[0:15], a[156:159], v[184:187], v[0:15]
    v_mfma_f32_32x32x16_bf16 v[16:31], a[156:159], v[188:191], v[16:31]
    s_waitcnt lgkmcnt(0)
    s_waitcnt vmcnt(0) lgkmcnt(0)
    s_branch IT0
CODE_END:
.section .rodata,"a"
.p2align 6
.amdhsa_kernel adaLN_cond__sliding_block_cached__geglu_ffn__prompt_kernel
  .amdhsa_next_free_vgpr 512
  .amdhsa_next_free_sgpr 82
  .amdhsa_accum_offset 256
  .amdhsa_group_segment_fixed_size 0
  .amdhsa_kernarg_size 112
  .amdhsa_user_sgpr_count 2
  .amdhsa_user_sgpr_kernarg_segment_ptr 1
  .amdhsa_system_sgpr_workgroup_id_x 1
  .amdhsa_float_denorm_mode_32 3
  .amdhsa_float_denorm_mode_16_64 3
.end_amdhsa_kernel
```
